```python
import torch

def _softmax(x, axis=-1):
    return torch.softmax(x, dim=axis)
def _gelu(x):
    return torch.nn.functional.gelu(x, approximate="tanh")
def _silu(x):
    return torch.nn.functional.silu(x)
def _sigmoid(x):
    return torch.sigmoid(x)
def _layernorm(x, axis=-1, eps=1e-5):
    m = x.mean(dim=axis, keepdim=True)
    v = x.var(dim=axis, keepdim=True, unbiased=False)
    return (x - m) / torch.sqrt(v + eps)
def _scatter_add(tgt, idx, src, axis=0):
    return tgt.clone().index_add_(axis, idx, src)
def _segment_sum(src, seg, n):
    out = torch.zeros((n,) + src.shape[1:], dtype=src.dtype)
    return out.index_add_(0, seg, src)
def _pad(x, pw):
    flat = tuple(v for pair in reversed(pw) for v in pair)
    return torch.nn.functional.pad(x, flat)

kernel_name = 'concat_heads__gqa_block_cached__mha_block_cached__near_ridge'

def setup_inputs():

    _w = (lambda a: (lambda t: t.to(torch.bfloat16) if t.is_floating_point() else t)(torch.as_tensor(a)))
    def _A_setup():
        B, Sq, D = 32, 96, 576
        Hq, Hkv, Sk, Dh = 32, 16, 512, 128
        assert Hq % Hkv == 0, (Hq, Hkv)
        return {
            "x": _w((lambda *s: torch.randn(*s, dtype=torch.bfloat16) * 0.8)(B, Sq, D)),
            "k_cache": _w((lambda *s: torch.randn(*s, dtype=torch.bfloat16) * 0.8)(B, Hkv, Sk, Dh)),
            "v_cache": _w((lambda *s: torch.randn(*s, dtype=torch.bfloat16) * 0.05)(B, Hkv, Sk, Dh)),
            "wq": _w((lambda *s: torch.randn(*s, dtype=torch.bfloat16) * 0.8)(D, Hq * Dh) * (D ** -0.5)),
            "wo": _w((lambda *s: torch.randn(*s, dtype=torch.bfloat16) * 0.05)(Hq * Dh, D) * ((Hq * Dh) ** -0.5)),
        }
    _A_in = _A_setup()

    def _B_setup():
        B, Sq, D = 32, 96, 576
        H, Sk, Dh = 32, 512, 128
        return {
            "x": _w((lambda *s: torch.randn(*s, dtype=torch.bfloat16) * 0.8)(B, Sq, D)),
            "k_cache": _w((lambda *s: torch.randn(*s, dtype=torch.bfloat16) * 0.8)(B, H, Sk, Dh)),
            "v_cache": _w((lambda *s: torch.randn(*s, dtype=torch.bfloat16) * 0.05)(B, H, Sk, Dh)),
            "wq": _w((lambda *s: torch.randn(*s, dtype=torch.bfloat16) * 0.8)(D, H * Dh) * (D ** -0.5)),
            "wo": _w((lambda *s: torch.randn(*s, dtype=torch.bfloat16) * 0.05)(H * Dh, D) * ((H * Dh) ** -0.5)),
        }
    _B_in = _B_setup()

    return {
        "A_x": _A_in["x"],
        "A_k_cache": _A_in["k_cache"],
        "A_v_cache": _A_in["v_cache"],
        "A_wq": _A_in["wq"],
        "A_wo": _A_in["wo"],
        "B_x": _B_in["x"],
        "B_k_cache": _B_in["k_cache"],
        "B_v_cache": _B_in["v_cache"],
        "B_wq": _B_in["wq"],
        "B_wo": _B_in["wo"],
    }

def reference(A_x, A_k_cache, A_v_cache, A_wq, A_wo, B_x, B_k_cache, B_v_cache, B_wq, B_wo):
    def _A_ref(x, k_cache, v_cache, wq, wo):
        B, Sq, D = x.shape
        Hq, Dh = 32, 128
        Hkv = k_cache.shape[1]
        rep = Hq // Hkv
        q = (lambda x, *d: x.permute(*d))((x @ wq).reshape(B, Sq, Hq, Dh), 0, 2, 1, 3)
        k = (lambda x, n, axis: torch.repeat_interleave(x, n, dim=axis))(k_cache, rep, axis=1)
        v = (lambda x, n, axis: torch.repeat_interleave(x, n, dim=axis))(v_cache, rep, axis=1)
        scores = torch.einsum("bhqd,bhkd->bhqk", q, k) * (Dh ** -0.5)
        p = _softmax(scores, axis=-1)
        o = torch.einsum("bhqk,bhkd->bhqd", p, v)
        return (lambda x, *d: x.permute(*d))(o, 0, 2, 1, 3).reshape(B, Sq, Hq * Dh) @ wo

    def _B_ref(x, k_cache, v_cache, wq, wo):
        B, Sq, D = x.shape
        H, Dh = 32, 128
        q = (lambda x, *d: x.permute(*d))((x @ wq).reshape(B, Sq, H, Dh), 0, 2, 1, 3)
        scores = torch.einsum("bhqd,bhkd->bhqk", q, k_cache) * (Dh ** -0.5)
        p = _softmax(scores, axis=-1)
        o = torch.einsum("bhqk,bhkd->bhqd", p, v_cache)
        return (lambda x, *d: x.permute(*d))(o, 0, 2, 1, 3).reshape(B, Sq, H * Dh) @ wo

    a = _A_ref(A_x, A_k_cache, A_v_cache, A_wq, A_wo)
    b = _B_ref(B_x, B_k_cache, B_v_cache, B_wq, B_wo)
    return torch.concatenate([a, b], axis=-1)
```

```asm
; @launch grid=(256,1,1) block=(512,1,1) lds=163840
.amdgcn_target "amdgcn-amd-amdhsa--gfx950"
.text
.globl concat_heads__gqa_block_cached__mha_block_cached__near_ridge_kernel
.p2align 8
.type concat_heads__gqa_block_cached__mha_block_cached__near_ridge_kernel,@function
concat_heads__gqa_block_cached__mha_block_cached__near_ridge_kernel:
    s_cmp_ge_u32 s2, 256
    s_cbranch_scc1 L_END
    s_load_dwordx16 s[40:55], s[0:1], 0
    s_load_dwordx4 s[8:11], s[0:1], 64
    s_load_dwordx4 s[12:15], s[0:1], 80
    s_load_dwordx2 s[68:69], s[0:1], 96
    v_lshrrev_b32 v1, 6, v0
    v_and_b32 v252, 63, v0
    v_readfirstlane_b32 s3, v1
    s_and_b32 s34, s2, 7
    s_lshr_b32 s35, s2, 3
    s_and_b32 s4, s35, 1
    s_lshr_b32 s7, s35, 1
    s_and_b32 s6, s34, 3
    s_lshr_b32 s34, s34, 2
    s_lshl_b32 s34, s34, 4
    s_add_u32 s5, s34, s7
    s_and_b32 s36, s3, 3
    s_and_b32 s37, s3, 1
    s_mov_b32 s16, s5
    s_mov_b32 s17, s6
    s_mul_i32 s62, s16, 110592
    s_lshl_b32 s63, s17, 11
    s_mul_i32 s64, s17, 1179648
    s_lshl_b32 s65, s16, 2
    s_add_u32 s65, s65, s17
    v_lshrrev_b32 v240, 3, v252
    v_and_b32 v241, 7, v252
    v_lshlrev_b32 v241, 4, v241
    v_and_b32 v250, 3, v240
    v_lshlrev_b32 v250, 1, v250
    v_lshrrev_b32 v242, 2, v240
    v_add_u32 v250, v250, v242
    v_lshlrev_b32 v250, 15, v250
    s_lshl_b32 s74, s36, 7
    v_add3_u32 v250, v250, v241, s74
    s_mul_i32 s34, s36, 1152
    v_mul_u32_u24 v249, 4608, v240
    v_add3_u32 v249, v249, v241, s34
    v_min_u32 v242, 35, v252
    s_mul_i32 s34, s7, 36
    v_add_u32 v248, s34, v242
    v_lshlrev_b32 v248, 13, v248
    v_add_u32 v248, s74, v248
    s_mul_i32 s76, s36, 4224
    s_add_u32 s76, s76, 38656
    s_mul_i32 s77, s36, 1056
    s_add_u32 s77, s77, 640
    s_cmp_eq_u32 s4, 0
    s_cselect_b32 s60, 0, 0
    s_cselect_b32 s61, 4, 4
    s_cselect_b32 s75, 0, 0
    s_sub_u32 s22, 4718592, s63
    s_mov_b32 s23, 0x20000
    s_mov_b32 s18, 110592
    s_mov_b32 s19, 0x20000
    s_cmp_eq_u32 s4, 0
    s_waitcnt lgkmcnt(0)
    s_cselect_b64 s[16:17], s[40:41], s[50:51]
    s_cselect_b64 s[20:21], s[46:47], s[8:9]
    s_add_u32 s20, s20, s63
    s_addc_u32 s21, s21, 0
    s_and_b32 s21, s21, 0xffff
    s_add_u32 s16, s16, s62
    s_addc_u32 s17, s17, 0
    s_and_b32 s17, s17, 0xffff
    s_cmp_lt_u32 s3, 4
    s_cbranch_scc1 L_TOUCH
    s_add_u32 s35, s75, 0
    s_add_u32 m0, s76, 0
    s_nop 0
    buffer_load_dwordx4 v250, s[20:23], s35 offen lds
    s_add_u32 s35, s75, 8192
    s_add_u32 m0, s76, 1032
    s_nop 0
    buffer_load_dwordx4 v250, s[20:23], s35 offen lds
    s_add_u32 s35, s75, 16384
    s_add_u32 m0, s76, 2112
    s_nop 0
    buffer_load_dwordx4 v250, s[20:23], s35 offen lds
    s_add_u32 s35, s75, 24576
    s_add_u32 m0, s76, 3144
    s_nop 0
    buffer_load_dwordx4 v250, s[20:23], s35 offen lds
    s_mov_b32 s35, 0
    s_add_u32 m0, s77, 0
    s_nop 0
    buffer_load_dwordx4 v249, s[16:19], s35 offen lds
    s_mov_b32 s35, 36864
    s_add_u32 m0, s77, 4224
    s_nop 0
    buffer_load_dwordx4 v249, s[16:19], s35 offen lds
    s_mov_b32 s35, 73728
    s_add_u32 m0, s77, 8448
    s_nop 0
    buffer_load_dwordx4 v249, s[16:19], s35 offen lds
    s_add_u32 s35, s75, 262144
    s_add_u32 m0, s76, 16896
    s_nop 0
    buffer_load_dwordx4 v250, s[20:23], s35 offen lds
    s_add_u32 s35, s75, 270336
    s_add_u32 m0, s76, 17928
    s_nop 0
    buffer_load_dwordx4 v250, s[20:23], s35 offen lds
    s_add_u32 s35, s75, 278528
    s_add_u32 m0, s76, 19008
    s_nop 0
    buffer_load_dwordx4 v250, s[20:23], s35 offen lds
    s_add_u32 s35, s75, 286720
    s_add_u32 m0, s76, 20040
    s_nop 0
    buffer_load_dwordx4 v250, s[20:23], s35 offen lds
    s_branch L_REST
L_TOUCH:
    buffer_load_dword v241, v248, s[20:23], s75 offen
L_REST:
    s_mov_b64 s[70:71], s[12:13]
    s_mov_b64 s[72:73], s[14:15]
    s_mov_b32 s84, 0
    s_mov_b32 s85, 0
    s_cmp_eq_u32 s4, 0
    s_cselect_b64 s[42:43], s[42:43], s[52:53]
    s_cselect_b64 s[44:45], s[44:45], s[54:55]
    s_cselect_b64 s[48:49], s[48:49], s[10:11]
    s_add_u32 s35, s4, 19
    s_lshl_b32 s34, s65, s35
    s_lshl_b32 s66, 1, s35
    s_add_u32 s8, s42, s34
    s_addc_u32 s9, s43, 0
    s_and_b32 s9, s9, 0xffff
    s_mov_b32 s10, s66
    s_mov_b32 s11, 0x20000
    s_add_u32 s12, s44, s34
    s_addc_u32 s13, s45, 0
    s_and_b32 s13, s13, 0xffff
    s_mov_b32 s14, s66
    s_mov_b32 s15, 0x20000
    s_add_u32 s24, s48, s64
    s_addc_u32 s25, s49, 0
    s_and_b32 s25, s25, 0xffff
    s_mov_b32 s26, 1179648
    s_mov_b32 s27, 0x20000
    s_lshl_b32 s90, s6, 8
    s_add_u32 s91, s90, 128
    s_cmp_eq_u32 s91, 1152
    s_cselect_b32 s91, 0, s91
    s_add_u32 s92, s91, 128
    s_cmp_eq_u32 s92, 1152
    s_cselect_b32 s92, 0, s92
    s_add_u32 s93, s92, 128
    s_cmp_eq_u32 s93, 1152
    s_cselect_b32 s93, 0, s93
    s_add_u32 s94, s93, 128
    s_cmp_eq_u32 s94, 1152
    s_cselect_b32 s94, 0, s94
    s_add_u32 s95, s94, 128
    s_cmp_eq_u32 s95, 1152
    s_cselect_b32 s95, 0, s95
    s_add_u32 s96, s95, 128
    s_cmp_eq_u32 s96, 1152
    s_cselect_b32 s96, 0, s96
    s_add_u32 s97, s96, 128
    s_cmp_eq_u32 s97, 1152
    s_cselect_b32 s97, 0, s97
    s_add_u32 s98, s97, 128
    s_cmp_eq_u32 s98, 1152
    s_cselect_b32 s98, 0, s98
    s_mov_b32 s47, s75
    s_cmp_lt_u32 s3, 4
    s_cbranch_scc1 LA_START
    s_cmp_eq_u32 s4, 0
    s_cbranch_scc1 LP_A
    s_branch LP_B
LA_START:
    s_setprio 1
    v_min_u32 v242, 35, v252
    s_mul_i32 s34, s7, 144
    s_mul_i32 s35, s36, 36
    s_add_u32 s34, s34, s35
    v_add_u32 v249, s34, v242
    v_lshlrev_b32 v249, 7, v249
    s_getpc_b64 s[48:49]
LA_pc:
    s_sub_u32 s48, s48, LA_pc-concat_heads__gqa_block_cached__mha_block_cached__near_ridge_kernel
    s_subb_u32 s49, s49, 0
    s_lshr_b32 s34, s2, 3
    s_lshl_b32 s34, s34, 2
    s_add_u32 s34, s34, s36
    s_mul_i32 s34, s34, 4
    v_min_u32 v242, 3, v252
    v_add_u32 v242, s34, v242
    v_lshlrev_b32 v242, 7, v242
    v_min_u32 v242, L_CODE_END-concat_heads__gqa_block_cached__mha_block_cached__near_ridge_kernel-4, v242
    global_load_dword v241, v242, s[48:49]
    v_and_b32 v242, 3, v252
    v_mul_u32_u24 v242, 1056, v242
    v_bfe_u32 v243, v252, 2, 2
    v_lshrrev_b32 v244, 4, v252
    v_lshl_add_u32 v237, v243, 7, v242
    v_lshl_add_u32 v237, v244, 4, v237
    v_mul_u32_u24 v251, 1056, v243
    v_lshl_add_u32 v251, v244, 7, v251
    v_and_b32 v242, 3, v252
    v_lshl_add_u32 v251, v242, 3, v251
    s_lshr_b32 s34, s36, 1
    s_mul_i32 s34, s34, 8448
    s_lshl_b32 s35, s37, 9
    s_add_u32 s35, s35, 640
    v_add_u32 v239, s35, v237
    s_mul_i32 s35, s34, s4
    s_add_u32 s35, s35, 38656
    v_add_u32 v237, s35, v237
    v_add_u32 v251, s35, v251
    s_add_u32 s34, s34, 38656
    v_bfe_u32 v242, v252, 2, 2
    v_lshlrev_b32 v238, 10, v242
    v_and_b32 v243, 1, v242
    v_lshl_add_u32 v238, v243, 3, v238
    v_lshrrev_b32 v243, 1, v242
    v_lshl_add_u32 v238, v243, 6, v238
    v_lshrrev_b32 v243, 4, v252
    v_lshl_add_u32 v238, v243, 7, v238
    v_and_b32 v243, 3, v252
    v_lshl_add_u32 v238, v243, 4, v238
    v_add_u32 v238, s34, v238
    s_lshr_b32 s34, s36, 1
    s_mul_i32 s34, s34, 24
    s_add_u32 s34, s34, s37
    s_lshl_b32 s34, s34, 10
    s_add_u32 s34, s34, 106240
    v_lshlrev_b32 v250, 4, v252
    v_add_u32 v240, s34, v250
    s_mul_i32 s34, s36, 12288
    v_add_u32 v250, s34, v250
    s_mov_b32 s38, 0x3e0293ee
    s_mov_b32 s39, 0x3e0293ee
    s_mov_b32 s46, 0x53800000
    s_mov_b64 s[44:45], 0
    s_mov_b32 s41, 0
    s_mov_b32 s40, 0
    v_mov_b32 v236, v238
    v_mov_b32 v235, v239
    s_or_b32 s48, s2, s3
    s_cmp_lg_u32 s48, 0
    s_cbranch_scc1 L_nopub
    s_memrealtime s[48:49]
    s_mov_b32 s28, s72
    s_and_b32 s29, s73, 0xffff
    s_mov_b32 s30, 256
    s_mov_b32 s31, 0x20000
    s_waitcnt lgkmcnt(0)
    s_or_b32 s48, s48, 1
    v_mov_b32 v242, s48
    v_mov_b32 v243, s49
    v_mov_b32 v244, 0
    s_mov_b64 exec, 1
    buffer_store_dwordx2 v[242:243], v244, s[28:31], 0 offen sc1
    s_mov_b64 exec, -1
L_nopub:
    s_mov_b32 s32, 0
LA_Q0:
    s_barrier
    ds_read_b64_tr_b16 v[204:205], v236 offset:0
    ds_read_b64_tr_b16 v[206:207], v236 offset:512
    ds_read_b128 v[180:183], v235 offset:0
    ds_read_b128 v[184:187], v235 offset:4224
    ds_read_b128 v[188:191], v235 offset:8448
    ds_read_b64_tr_b16 v[208:209], v236 offset:8
    ds_read_b64_tr_b16 v[210:211], v236 offset:520
    ds_read_b64_tr_b16 v[212:213], v236 offset:64
    ds_read_b64_tr_b16 v[214:215], v236 offset:576
    ds_read_b64_tr_b16 v[216:217], v236 offset:72
    ds_read_b64_tr_b16 v[218:219], v236 offset:584
    s_waitcnt lgkmcnt(6)
    v_mfma_f32_16x16x32_bf16 v[0:3], v[204:207], v[180:183], 0
    v_mfma_f32_16x16x32_bf16 v[4:7], v[204:207], v[184:187], 0
    v_mfma_f32_16x16x32_bf16 v[8:11], v[204:207], v[188:191], 0
    ds_read_b64_tr_b16 v[204:205], v236 offset:4224
    s_waitcnt lgkmcnt(5)
    v_mfma_f32_16x16x32_bf16 v[12:15], v[208:211], v[180:183], 0
    ds_read_b64_tr_b16 v[206:207], v236 offset:4736
    v_mfma_f32_16x16x32_bf16 v[16:19], v[208:211], v[184:187], 0
    s_add_u32 s40, s40, 16896
    v_mfma_f32_16x16x32_bf16 v[20:23], v[208:211], v[188:191], 0
    ds_read_b64_tr_b16 v[208:209], v236 offset:4232
    s_waitcnt lgkmcnt(5)
    v_mfma_f32_16x16x32_bf16 v[24:27], v[212:215], v[180:183], 0
    ds_read_b64_tr_b16 v[210:211], v236 offset:4744
    v_mfma_f32_16x16x32_bf16 v[28:31], v[212:215], v[184:187], 0
    s_cmp_eq_u32 s40, 50688
    v_mfma_f32_16x16x32_bf16 v[32:35], v[212:215], v[188:191], 0
    ds_read_b64_tr_b16 v[212:213], v236 offset:4288
    s_waitcnt lgkmcnt(5)
    v_mfma_f32_16x16x32_bf16 v[36:39], v[216:219], v[180:183], 0
    ds_read_b64_tr_b16 v[214:215], v236 offset:4800
    v_mfma_f32_16x16x32_bf16 v[40:43], v[216:219], v[184:187], 0
    s_cselect_b32 s40, 0, s40
    v_mfma_f32_16x16x32_bf16 v[44:47], v[216:219], v[188:191], 0
    ds_read_b64_tr_b16 v[216:217], v236 offset:4296
    s_waitcnt lgkmcnt(5)
    v_mfma_f32_16x16x32_bf16 v[48:51], v[204:207], v[180:183], 0
    ds_read_b64_tr_b16 v[218:219], v236 offset:4808
    v_mfma_f32_16x16x32_bf16 v[52:55], v[204:207], v[184:187], 0
    v_add_u32 v236, s40, v238
    v_mfma_f32_16x16x32_bf16 v[56:59], v[204:207], v[188:191], 0
    s_waitcnt lgkmcnt(4)
    v_mfma_f32_16x16x32_bf16 v[60:63], v[208:211], v[180:183], 0
    v_mfma_f32_16x16x32_bf16 v[64:67], v[208:211], v[184:187], 0
    v_mfma_f32_16x16x32_bf16 v[68:71], v[208:211], v[188:191], 0
    s_cmp_lg_u32 s32, 0
    s_cbranch_scc1 LA_xl_1
    v_min_u32 v242, 53, v252
    v_lshlrev_b32 v242, 7, v242
    s_lshl_b32 s34, s6, 2
    s_add_u32 s34, s34, s36
    s_mul_i32 s34, s34, 6912
    buffer_load_dword v241, v242, s[16:19], s34 offen
LA_xl_1:
    s_waitcnt lgkmcnt(0)
    s_barrier
    v_mfma_f32_16x16x32_bf16 v[72:75], v[212:215], v[180:183], 0
    ds_read_b64_tr_b16 v[204:205], v236 offset:0
    ds_read_b64_tr_b16 v[206:207], v236 offset:512
    v_mfma_f32_16x16x32_bf16 v[76:79], v[212:215], v[184:187], 0
    ds_read_b128 v[192:195], v235 offset:64
    ds_read_b128 v[196:199], v235 offset:4288
    v_mfma_f32_16x16x32_bf16 v[80:83], v[212:215], v[188:191], 0
    ds_read_b128 v[200:203], v235 offset:8512
    v_mfma_f32_16x16x32_bf16 v[84:87], v[216:219], v[180:183], 0
    ds_read_b64_tr_b16 v[208:209], v236 offset:8
    ds_read_b64_tr_b16 v[210:211], v236 offset:520
    v_mfma_f32_16x16x32_bf16 v[88:91], v[216:219], v[184:187], 0
    ds_read_b64_tr_b16 v[212:213], v236 offset:64
    ds_read_b64_tr_b16 v[214:215], v236 offset:576
    v_mfma_f32_16x16x32_bf16 v[92:95], v[216:219], v[188:191], 0
    ds_read_b64_tr_b16 v[216:217], v236 offset:72
    s_waitcnt lgkmcnt(5)
    v_mfma_f32_16x16x32_bf16 v[0:3], v[204:207], v[192:195], v[0:3]
    ds_read_b64_tr_b16 v[218:219], v236 offset:584
    v_mfma_f32_16x16x32_bf16 v[4:7], v[204:207], v[196:199], v[4:7]
    s_add_u32 s40, s40, 16896
    v_mfma_f32_16x16x32_bf16 v[8:11], v[204:207], v[200:203], v[8:11]
    ds_read_b64_tr_b16 v[204:205], v236 offset:4224
    s_waitcnt lgkmcnt(5)
    v_mfma_f32_16x16x32_bf16 v[12:15], v[208:211], v[192:195], v[12:15]
    ds_read_b64_tr_b16 v[206:207], v236 offset:4736
    v_mfma_f32_16x16x32_bf16 v[16:19], v[208:211], v[196:199], v[16:19]
    s_cmp_eq_u32 s40, 50688
    v_mfma_f32_16x16x32_bf16 v[20:23], v[208:211], v[200:203], v[20:23]
    ds_read_b64_tr_b16 v[208:209], v236 offset:4232
    s_waitcnt lgkmcnt(5)
    v_mfma_f32_16x16x32_bf16 v[24:27], v[212:215], v[192:195], v[24:27]
    ds_read_b64_tr_b16 v[210:211], v236 offset:4744
    v_mfma_f32_16x16x32_bf16 v[28:31], v[212:215], v[196:199], v[28:31]
    s_cselect_b32 s40, 0, s40
    v_mfma_f32_16x16x32_bf16 v[32:35], v[212:215], v[200:203], v[32:35]
    ds_read_b64_tr_b16 v[212:213], v236 offset:4288
    s_waitcnt lgkmcnt(5)
    v_mfma_f32_16x16x32_bf16 v[36:39], v[216:219], v[192:195], v[36:39]
    ds_read_b64_tr_b16 v[214:215], v236 offset:4800
    v_mfma_f32_16x16x32_bf16 v[40:43], v[216:219], v[196:199], v[40:43]
    s_add_u32 s41, s41, 12672
    v_mfma_f32_16x16x32_bf16 v[44:47], v[216:219], v[200:203], v[44:47]
    ds_read_b64_tr_b16 v[216:217], v236 offset:4296
    s_waitcnt lgkmcnt(5)
    v_mfma_f32_16x16x32_bf16 v[48:51], v[204:207], v[192:195], v[48:51]
    ds_read_b64_tr_b16 v[218:219], v236 offset:4808
    v_mfma_f32_16x16x32_bf16 v[52:55], v[204:207], v[196:199], v[52:55]
    s_cmp_eq_u32 s41, 38016
    v_add_u32 v236, s40, v238
    v_mfma_f32_16x16x32_bf16 v[56:59], v[204:207], v[200:203], v[56:59]
    s_cselect_b32 s41, 0, s41
    v_add_u32 v235, s41, v239
    s_waitcnt lgkmcnt(4)
    v_mfma_f32_16x16x32_bf16 v[60:63], v[208:211], v[192:195], v[60:63]
    v_mfma_f32_16x16x32_bf16 v[64:67], v[208:211], v[196:199], v[64:67]
    v_mfma_f32_16x16x32_bf16 v[68:71], v[208:211], v[200:203], v[68:71]
    s_waitcnt lgkmcnt(0)
    s_mov_b32 s33, 8
LA_Q:
    s_barrier
    v_mfma_f32_16x16x32_bf16 v[72:75], v[212:215], v[192:195], v[72:75]
    ds_read_b64_tr_b16 v[204:205], v236 offset:0
    ds_read_b64_tr_b16 v[206:207], v236 offset:512
    v_mfma_f32_16x16x32_bf16 v[76:79], v[212:215], v[196:199], v[76:79]
    ds_read_b128 v[180:183], v235 offset:0
    ds_read_b128 v[184:187], v235 offset:4224
    v_mfma_f32_16x16x32_bf16 v[80:83], v[212:215], v[200:203], v[80:83]
    ds_read_b128 v[188:191], v235 offset:8448
    v_mfma_f32_16x16x32_bf16 v[84:87], v[216:219], v[192:195], v[84:87]
    ds_read_b64_tr_b16 v[208:209], v236 offset:8
    ds_read_b64_tr_b16 v[210:211], v236 offset:520
    v_mfma_f32_16x16x32_bf16 v[88:91], v[216:219], v[196:199], v[88:91]
    ds_read_b64_tr_b16 v[212:213], v236 offset:64
    ds_read_b64_tr_b16 v[214:215], v236 offset:576
    v_mfma_f32_16x16x32_bf16 v[92:95], v[216:219], v[200:203], v[92:95]
    ds_read_b64_tr_b16 v[216:217], v236 offset:72
    s_waitcnt lgkmcnt(5)
    v_mfma_f32_16x16x32_bf16 v[0:3], v[204:207], v[180:183], v[0:3]
    ds_read_b64_tr_b16 v[218:219], v236 offset:584
    v_mfma_f32_16x16x32_bf16 v[4:7], v[204:207], v[184:187], v[4:7]
    s_add_u32 s40, s40, 16896
    v_mfma_f32_16x16x32_bf16 v[8:11], v[204:207], v[188:191], v[8:11]
    ds_read_b64_tr_b16 v[204:205], v236 offset:4224
    s_waitcnt lgkmcnt(5)
    v_mfma_f32_16x16x32_bf16 v[12:15], v[208:211], v[180:183], v[12:15]
    ds_read_b64_tr_b16 v[206:207], v236 offset:4736
    v_mfma_f32_16x16x32_bf16 v[16:19], v[208:211], v[184:187], v[16:19]
    s_cmp_eq_u32 s40, 50688
    v_mfma_f32_16x16x32_bf16 v[20:23], v[208:211], v[188:191], v[20:23]
    ds_read_b64_tr_b16 v[208:209], v236 offset:4232
    s_waitcnt lgkmcnt(5)
    v_mfma_f32_16x16x32_bf16 v[24:27], v[212:215], v[180:183], v[24:27]
    ds_read_b64_tr_b16 v[210:211], v236 offset:4744
    v_mfma_f32_16x16x32_bf16 v[28:31], v[212:215], v[184:187], v[28:31]
    s_cselect_b32 s40, 0, s40
    v_mfma_f32_16x16x32_bf16 v[32:35], v[212:215], v[188:191], v[32:35]
    ds_read_b64_tr_b16 v[212:213], v236 offset:4288
    s_waitcnt lgkmcnt(5)
    v_mfma_f32_16x16x32_bf16 v[36:39], v[216:219], v[180:183], v[36:39]
    ds_read_b64_tr_b16 v[214:215], v236 offset:4800
    v_mfma_f32_16x16x32_bf16 v[40:43], v[216:219], v[184:187], v[40:43]
    v_mfma_f32_16x16x32_bf16 v[44:47], v[216:219], v[188:191], v[44:47]
    ds_read_b64_tr_b16 v[216:217], v236 offset:4296
    s_waitcnt lgkmcnt(5)
    v_mfma_f32_16x16x32_bf16 v[48:51], v[204:207], v[180:183], v[48:51]
    ds_read_b64_tr_b16 v[218:219], v236 offset:4808
    v_mfma_f32_16x16x32_bf16 v[52:55], v[204:207], v[184:187], v[52:55]
    v_add_u32 v236, s40, v238
    v_mfma_f32_16x16x32_bf16 v[56:59], v[204:207], v[188:191], v[56:59]
    s_waitcnt lgkmcnt(4)
    v_mfma_f32_16x16x32_bf16 v[60:63], v[208:211], v[180:183], v[60:63]
    v_mfma_f32_16x16x32_bf16 v[64:67], v[208:211], v[184:187], v[64:67]
    v_mfma_f32_16x16x32_bf16 v[68:71], v[208:211], v[188:191], v[68:71]
    s_waitcnt lgkmcnt(0)
    s_barrier
    v_mfma_f32_16x16x32_bf16 v[72:75], v[212:215], v[180:183], v[72:75]
    ds_read_b64_tr_b16 v[204:205], v236 offset:0
    ds_read_b64_tr_b16 v[206:207], v236 offset:512
    v_mfma_f32_16x16x32_bf16 v[76:79], v[212:215], v[184:187], v[76:79]
    ds_read_b128 v[192:195], v235 offset:64
    ds_read_b128 v[196:199], v235 offset:4288
    v_mfma_f32_16x16x32_bf16 v[80:83], v[212:215], v[188:191], v[80:83]
    ds_read_b128 v[200:203], v235 offset:8512
    v_mfma_f32_16x16x32_bf16 v[84:87], v[216:219], v[180:183], v[84:87]
    ds_read_b64_tr_b16 v[208:209], v236 offset:8
    ds_read_b64_tr_b16 v[210:211], v236 offset:520
    v_mfma_f32_16x16x32_bf16 v[88:91], v[216:219], v[184:187], v[88:91]
    ds_read_b64_tr_b16 v[212:213], v236 offset:64
    ds_read_b64_tr_b16 v[214:215], v236 offset:576
    v_mfma_f32_16x16x32_bf16 v[92:95], v[216:219], v[188:191], v[92:95]
    ds_read_b64_tr_b16 v[216:217], v236 offset:72
    s_waitcnt lgkmcnt(5)
    v_mfma_f32_16x16x32_bf16 v[0:3], v[204:207], v[192:195], v[0:3]
    ds_read_b64_tr_b16 v[218:219], v236 offset:584
    v_mfma_f32_16x16x32_bf16 v[4:7], v[204:207], v[196:199], v[4:7]
    s_add_u32 s40, s40, 16896
    v_mfma_f32_16x16x32_bf16 v[8:11], v[204:207], v[200:203], v[8:11]
    ds_read_b64_tr_b16 v[204:205], v236 offset:4224
    s_waitcnt lgkmcnt(5)
    v_mfma_f32_16x16x32_bf16 v[12:15], v[208:211], v[192:195], v[12:15]
    ds_read_b64_tr_b16 v[206:207], v236 offset:4736
    v_mfma_f32_16x16x32_bf16 v[16:19], v[208:211], v[196:199], v[16:19]
    s_cmp_eq_u32 s40, 50688
    v_mfma_f32_16x16x32_bf16 v[20:23], v[208:211], v[200:203], v[20:23]
    ds_read_b64_tr_b16 v[208:209], v236 offset:4232
    s_waitcnt lgkmcnt(5)
    v_mfma_f32_16x16x32_bf16 v[24:27], v[212:215], v[192:195], v[24:27]
    ds_read_b64_tr_b16 v[210:211], v236 offset:4744
    v_mfma_f32_16x16x32_bf16 v[28:31], v[212:215], v[196:199], v[28:31]
    s_cselect_b32 s40, 0, s40
    v_mfma_f32_16x16x32_bf16 v[32:35], v[212:215], v[200:203], v[32:35]
    ds_read_b64_tr_b16 v[212:213], v236 offset:4288
    s_waitcnt lgkmcnt(5)
    v_mfma_f32_16x16x32_bf16 v[36:39], v[216:219], v[192:195], v[36:39]
    ds_read_b64_tr_b16 v[214:215], v236 offset:4800
    v_mfma_f32_16x16x32_bf16 v[40:43], v[216:219], v[196:199], v[40:43]
    s_add_u32 s41, s41, 12672
    v_mfma_f32_16x16x32_bf16 v[44:47], v[216:219], v[200:203], v[44:47]
    ds_read_b64_tr_b16 v[216:217], v236 offset:4296
    s_waitcnt lgkmcnt(5)
    v_mfma_f32_16x16x32_bf16 v[48:51], v[204:207], v[192:195], v[48:51]
    ds_read_b64_tr_b16 v[218:219], v236 offset:4808
    v_mfma_f32_16x16x32_bf16 v[52:55], v[204:207], v[196:199], v[52:55]
    s_cmp_eq_u32 s41, 38016
    v_add_u32 v236, s40, v238
    v_mfma_f32_16x16x32_bf16 v[56:59], v[204:207], v[200:203], v[56:59]
    s_cselect_b32 s41, 0, s41
    v_add_u32 v235, s41, v239
    s_waitcnt lgkmcnt(4)
    v_mfma_f32_16x16x32_bf16 v[60:63], v[208:211], v[192:195], v[60:63]
    v_mfma_f32_16x16x32_bf16 v[64:67], v[208:211], v[196:199], v[64:67]
    v_mfma_f32_16x16x32_bf16 v[68:71], v[208:211], v[200:203], v[68:71]
    s_waitcnt lgkmcnt(0)
    s_sub_u32 s33, s33, 1
    s_cmp_lg_u32 s33, 0
    s_cbranch_scc1 LA_Q
    s_barrier
    v_mfma_f32_16x16x32_bf16 v[72:75], v[212:215], v[192:195], v[72:75]
    ds_read_b128 v[204:207], v237 offset:50688
    v_mfma_f32_16x16x32_bf16 v[76:79], v[212:215], v[196:199], v[76:79]
    ds_read_b128 v[208:211], v237 offset:50752
    v_mfma_f32_16x16x32_bf16 v[80:83], v[212:215], v[200:203], v[80:83]
    ds_read_b128 v[212:215], v237 offset:54912
    v_mfma_f32_16x16x32_bf16 v[84:87], v[216:219], v[192:195], v[84:87]
    v_mfma_f32_16x16x32_bf16 v[88:91], v[216:219], v[196:199], v[88:91]
    v_mfma_f32_16x16x32_bf16 v[92:95], v[216:219], v[200:203], v[92:95]
    ds_read_b128 v[216:219], v237 offset:54976
    v_pk_mul_f32 v[0:1], v[0:1], s[38:39]
    v_pk_mul_f32 v[2:3], v[2:3], s[38:39]
    v_pk_mul_f32 v[12:13], v[12:13], s[38:39]
    v_pk_mul_f32 v[14:15], v[14:15], s[38:39]
    v_pk_mul_f32 v[4:5], v[4:5], s[38:39]
    v_pk_mul_f32 v[6:7], v[6:7], s[38:39]
    v_pk_mul_f32 v[16:17], v[16:17], s[38:39]
    v_pk_mul_f32 v[18:19], v[18:19], s[38:39]
    v_pk_mul_f32 v[8:9], v[8:9], s[38:39]
    v_pk_mul_f32 v[10:11], v[10:11], s[38:39]
    v_pk_mul_f32 v[20:21], v[20:21], s[38:39]
    v_pk_mul_f32 v[22:23], v[22:23], s[38:39]
    v_cvt_pk_bf16_f32 v96, v0, v1
    v_cvt_pk_bf16_f32 v97, v2, v3
    v_cvt_pk_bf16_f32 v98, v12, v13
    v_cvt_pk_bf16_f32 v99, v14, v15
    v_cvt_pk_bf16_f32 v100, v4, v5
    v_cvt_pk_bf16_f32 v101, v6, v7
    v_cvt_pk_bf16_f32 v102, v16, v17
    v_cvt_pk_bf16_f32 v103, v18, v19
    v_cvt_pk_bf16_f32 v104, v8, v9
    v_cvt_pk_bf16_f32 v105, v10, v11
    v_cvt_pk_bf16_f32 v106, v20, v21
    v_cvt_pk_bf16_f32 v107, v22, v23
    v_pk_mul_f32 v[24:25], v[24:25], s[38:39]
    v_pk_mul_f32 v[26:27], v[26:27], s[38:39]
    v_pk_mul_f32 v[36:37], v[36:37], s[38:39]
    v_pk_mul_f32 v[38:39], v[38:39], s[38:39]
    v_pk_mul_f32 v[28:29], v[28:29], s[38:39]
    v_pk_mul_f32 v[30:31], v[30:31], s[38:39]
    v_pk_mul_f32 v[40:41], v[40:41], s[38:39]
    v_pk_mul_f32 v[42:43], v[42:43], s[38:39]
    v_pk_mul_f32 v[32:33], v[32:33], s[38:39]
    v_pk_mul_f32 v[34:35], v[34:35], s[38:39]
    v_pk_mul_f32 v[44:45], v[44:45], s[38:39]
    v_pk_mul_f32 v[46:47], v[46:47], s[38:39]
    v_cvt_pk_bf16_f32 v108, v24, v25
    v_cvt_pk_bf16_f32 v109, v26, v27
    v_cvt_pk_bf16_f32 v110, v36, v37
    v_cvt_pk_bf16_f32 v111, v38, v39
    v_cvt_pk_bf16_f32 v112, v28, v29
    v_cvt_pk_bf16_f32 v113, v30, v31
    v_cvt_pk_bf16_f32 v114, v40, v41
    v_cvt_pk_bf16_f32 v115, v42, v43
    v_cvt_pk_bf16_f32 v116, v32, v33
    v_cvt_pk_bf16_f32 v117, v34, v35
    v_cvt_pk_bf16_f32 v118, v44, v45
    v_cvt_pk_bf16_f32 v119, v46, v47
    v_pk_mul_f32 v[48:49], v[48:49], s[38:39]
    v_pk_mul_f32 v[50:51], v[50:51], s[38:39]
    v_pk_mul_f32 v[60:61], v[60:61], s[38:39]
    v_pk_mul_f32 v[62:63], v[62:63], s[38:39]
    v_pk_mul_f32 v[52:53], v[52:53], s[38:39]
    v_pk_mul_f32 v[54:55], v[54:55], s[38:39]
    v_pk_mul_f32 v[64:65], v[64:65], s[38:39]
    v_pk_mul_f32 v[66:67], v[66:67], s[38:39]
    v_pk_mul_f32 v[56:57], v[56:57], s[38:39]
    v_pk_mul_f32 v[58:59], v[58:59], s[38:39]
    v_pk_mul_f32 v[68:69], v[68:69], s[38:39]
    v_pk_mul_f32 v[70:71], v[70:71], s[38:39]
    v_cvt_pk_bf16_f32 v120, v48, v49
    v_cvt_pk_bf16_f32 v121, v50, v51
    v_cvt_pk_bf16_f32 v122, v60, v61
    v_cvt_pk_bf16_f32 v123, v62, v63
    v_cvt_pk_bf16_f32 v124, v52, v53
    v_cvt_pk_bf16_f32 v125, v54, v55
    v_cvt_pk_bf16_f32 v126, v64, v65
    v_cvt_pk_bf16_f32 v127, v66, v67
    v_cvt_pk_bf16_f32 v128, v56, v57
    v_cvt_pk_bf16_f32 v129, v58, v59
    v_cvt_pk_bf16_f32 v130, v68, v69
    v_cvt_pk_bf16_f32 v131, v70, v71
    v_pk_mul_f32 v[72:73], v[72:73], s[38:39]
    v_pk_mul_f32 v[74:75], v[74:75], s[38:39]
    v_pk_mul_f32 v[84:85], v[84:85], s[38:39]
    v_pk_mul_f32 v[86:87], v[86:87], s[38:39]
    v_pk_mul_f32 v[76:77], v[76:77], s[38:39]
    v_pk_mul_f32 v[78:79], v[78:79], s[38:39]
    v_pk_mul_f32 v[88:89], v[88:89], s[38:39]
    v_pk_mul_f32 v[90:91], v[90:91], s[38:39]
    v_pk_mul_f32 v[80:81], v[80:81], s[38:39]
    v_pk_mul_f32 v[82:83], v[82:83], s[38:39]
    v_pk_mul_f32 v[92:93], v[92:93], s[38:39]
    v_pk_mul_f32 v[94:95], v[94:95], s[38:39]
    v_cvt_pk_bf16_f32 v132, v72, v73
    v_cvt_pk_bf16_f32 v133, v74, v75
    v_cvt_pk_bf16_f32 v134, v84, v85
    v_cvt_pk_bf16_f32 v135, v86, v87
    v_cvt_pk_bf16_f32 v136, v76, v77
    v_cvt_pk_bf16_f32 v137, v78, v79
    v_cvt_pk_bf16_f32 v138, v88, v89
    v_cvt_pk_bf16_f32 v139, v90, v91
    v_cvt_pk_bf16_f32 v140, v80, v81
    v_cvt_pk_bf16_f32 v141, v82, v83
    v_cvt_pk_bf16_f32 v142, v92, v93
    v_cvt_pk_bf16_f32 v143, v94, v95
    s_waitcnt lgkmcnt(3)
    v_mfma_f32_16x16x32_bf16 v[144:147], v[204:207], v[96:99], 0
    v_mov_b32 v72, 0
    v_mov_b32 v73, 0
    v_mfma_f32_16x16x32_bf16 v[148:151], v[204:207], v[100:103], 0
    v_mov_b32 v74, 0
    v_mfma_f32_16x16x32_bf16 v[152:155], v[204:207], v[104:107], 0
    ds_read_b128 v[204:207], v237 offset:51200
    v_mov_b32 v75, 0
    s_waitcnt lgkmcnt(3)
    v_mfma_f32_16x16x32_bf16 v[144:147], v[208:211], v[108:111], v[144:147]
    v_mov_b32 v76, 0
    v_mov_b32 v77, 0
    v_mfma_f32_16x16x32_bf16 v[148:151], v[208:211], v[112:115], v[148:151]
    v_mov_b32 v78, 0
    v_mfma_f32_16x16x32_bf16 v[152:155], v[208:211], v[116:119], v[152:155]
    ds_read_b128 v[208:211], v237 offset:51264
    v_mov_b32 v79, 0
    s_waitcnt lgkmcnt(3)
    v_mfma_f32_16x16x32_bf16 v[144:147], v[212:215], v[120:123], v[144:147]
    v_mov_b32 v80, 0
    v_mov_b32 v81, 0
    v_mfma_f32_16x16x32_bf16 v[148:151], v[212:215], v[124:127], v[148:151]
    v_mov_b32 v82, 0
    v_mfma_f32_16x16x32_bf16 v[152:155], v[212:215], v[128:131], v[152:155]
    ds_read_b128 v[212:215], v237 offset:55424
    v_mov_b32 v83, 0
    s_waitcnt lgkmcnt(3)
    v_mfma_f32_16x16x32_bf16 v[144:147], v[216:219], v[132:135], v[144:147]
    v_mov_b32 v84, 0
    v_mfma_f32_16x16x32_bf16 v[148:151], v[216:219], v[136:139], v[148:151]
    v_mov_b32 v85, 0
    v_mov_b32 v86, 0
    v_mfma_f32_16x16x32_bf16 v[152:155], v[216:219], v[140:143], v[152:155]
    ds_read_b128 v[216:219], v237 offset:55488
    v_mov_b32 v87, 0
    s_waitcnt lgkmcnt(3)
    v_mfma_f32_16x16x32_bf16 v[156:159], v[204:207], v[96:99], 0
    v_mov_b32 v88, 0
    v_mfma_f32_16x16x32_bf16 v[160:163], v[204:207], v[100:103], 0
    v_mov_b32 v89, 0
    v_mov_b32 v90, 0
    v_mfma_f32_16x16x32_bf16 v[164:167], v[204:207], v[104:107], 0
    v_mov_b32 v91, 0
    v_mov_b32 v92, 0
    s_waitcnt lgkmcnt(2)
    v_mfma_f32_16x16x32_bf16 v[156:159], v[208:211], v[108:111], v[156:159]
    v_mov_b32 v93, 0
    v_mfma_f32_16x16x32_bf16 v[160:163], v[208:211], v[112:115], v[160:163]
    v_mov_b32 v94, 0
    v_mov_b32 v95, 0
    v_mfma_f32_16x16x32_bf16 v[164:167], v[208:211], v[116:119], v[164:167]
    s_waitcnt lgkmcnt(0)
LA_H19:
    s_barrier
    v_mfma_f32_16x16x32_bf16 v[156:159], v[212:215], v[120:123], v[156:159]
    ds_read_b128 v[204:207], v237 offset:0
    v_mfma_f32_16x16x32_bf16 v[160:163], v[212:215], v[124:127], v[160:163]
    ds_read_b128 v[208:211], v237 offset:64
    v_mfma_f32_16x16x32_bf16 v[164:167], v[212:215], v[128:131], v[164:167]
    ds_read_b128 v[212:215], v237 offset:4224
    v_mfma_f32_16x16x32_bf16 v[156:159], v[216:219], v[132:135], v[156:159]
    v_mfma_f32_16x16x32_bf16 v[160:163], v[216:219], v[136:139], v[160:163]
    v_mfma_f32_16x16x32_bf16 v[164:167], v[216:219], v[140:143], v[164:167]
    ds_read_b128 v[216:219], v237 offset:4288
    s_nop 3
    v_max3_f32 v242, v144, v145, v146
    v_max3_f32 v243, v148, v149, v150
    v_max3_f32 v244, v152, v153, v154
    v_max3_f32 v242, v242, v147, v156
    v_max3_f32 v243, v243, v151, v160
    v_max3_f32 v244, v244, v155, v164
    v_max3_f32 v242, v242, v157, v158
    v_max3_f32 v243, v243, v161, v162
    v_max3_f32 v244, v244, v165, v166
    v_max_f32 v242, v242, v159
    v_max_f32 v243, v243, v163
    v_max_f32 v244, v244, v167
    v_mov_b32 v245, v242
    v_mov_b32 v246, v243
    v_mov_b32 v247, v244
    s_nop 0
    v_permlane32_swap_b32 v242, v245
    v_permlane32_swap_b32 v243, v246
    v_permlane32_swap_b32 v244, v247
    v_max_f32 v242, v242, v245
    v_max_f32 v243, v243, v246
    v_max_f32 v244, v244, v247
    v_mov_b32 v245, v242
    v_mov_b32 v246, v243
    v_mov_b32 v247, v244
    s_nop 0
    v_permlane16_swap_b32 v242, v245
    v_permlane16_swap_b32 v243, v246
    v_permlane16_swap_b32 v244, v247
    v_max_f32 v242, v242, v245
    v_max_f32 v243, v243, v246
    v_max_f32 v244, v244, v247
    v_xor_b32 v168, 0x80000000, v242
    v_mov_b32 v232, 0
    v_xor_b32 v172, 0x80000000, v243
    v_mov_b32 v233, 0
    v_xor_b32 v176, 0x80000000, v244
    v_mov_b32 v234, 0
    v_mov_b32 v169, v168
    v_mov_b32 v170, v168
    v_mov_b32 v171, v168
    v_mov_b32 v173, v172
    v_mov_b32 v174, v172
    v_mov_b32 v175, v172
    v_mov_b32 v177, v176
    v_mov_b32 v178, v176
    v_mov_b32 v179, v176
    v_pk_add_f32 v[144:145], v[144:145], v[168:169]
    v_pk_add_f32 v[146:147], v[146:147], v[168:169]
    v_pk_add_f32 v[148:149], v[148:149], v[172:173]
    v_pk_add_f32 v[150:151], v[150:151], v[172:173]
    v_pk_add_f32 v[152:153], v[152:153], v[176:177]
    v_pk_add_f32 v[154:155], v[154:155], v[176:177]
    v_pk_add_f32 v[156:157], v[156:157], v[168:169]
    v_pk_add_f32 v[158:159], v[158:159], v[168:169]
    v_pk_add_f32 v[160:161], v[160:161], v[172:173]
    v_pk_add_f32 v[162:163], v[162:163], v[172:173]
    v_pk_add_f32 v[164:165], v[164:165], v[176:177]
    v_pk_add_f32 v[166:167], v[166:167], v[176:177]
    v_exp_f32 v220, v144
    v_exp_f32 v221, v145
    v_exp_f32 v222, v146
    v_exp_f32 v223, v147
    v_exp_f32 v224, v148
    v_exp_f32 v225, v149
    v_exp_f32 v226, v150
    v_exp_f32 v227, v151
    v_exp_f32 v228, v152
    v_add_f32 v232, v232, v220
    v_exp_f32 v229, v153
    v_add_f32 v232, v232, v221
    v_cvt_pk_bf16_f32 v180, v220, v221
    v_exp_f32 v230, v154
    v_add_f32 v232, v232, v222
    v_exp_f32 v231, v155
    v_add_f32 v232, v232, v223
    v_cvt_pk_bf16_f32 v181, v222, v223
    v_add_f32 v233, v233, v224
    v_add_f32 v233, v233, v225
    v_cvt_pk_bf16_f32 v184, v224, v225
    v_add_f32 v233, v233, v226
    v_add_f32 v233, v233, v227
    v_cvt_pk_bf16_f32 v185, v226, v227
    v_add_f32 v234, v234, v228
    v_add_f32 v234, v234, v229
    v_cvt_pk_bf16_f32 v188, v228, v229
    v_add_f32 v234, v234, v230
    v_add_f32 v234, v234, v231
    v_cvt_pk_bf16_f32 v189, v230, v231
    s_waitcnt lgkmcnt(3)
    v_mfma_f32_16x16x32_bf16 v[144:147], v[204:207], v[96:99], v[168:171]
    v_exp_f32 v220, v156
    v_mfma_f32_16x16x32_bf16 v[148:151], v[204:207], v[100:103], v[172:175]
    v_exp_f32 v221, v157
    v_exp_f32 v222, v158
    v_mfma_f32_16x16x32_bf16 v[152:155], v[204:207], v[104:107], v[176:179]
    ds_read_b128 v[204:207], v237 offset:512
    v_exp_f32 v223, v159
    s_waitcnt lgkmcnt(3)
    v_mfma_f32_16x16x32_bf16 v[144:147], v[208:211], v[108:111], v[144:147]
    v_exp_f32 v224, v160
    v_mfma_f32_16x16x32_bf16 v[148:151], v[208:211], v[112:115], v[148:151]
    v_exp_f32 v225, v161
    v_mfma_f32_16x16x32_bf16 v[152:155], v[208:211], v[116:119], v[152:155]
    ds_read_b128 v[208:211], v237 offset:576
    v_exp_f32 v226, v162
    s_waitcnt lgkmcnt(3)
    v_mfma_f32_16x16x32_bf16 v[144:147], v[212:215], v[120:123], v[144:147]
    v_exp_f32 v227, v163
    v_mfma_f32_16x16x32_bf16 v[148:151], v[212:215], v[124:127], v[148:151]
    v_exp_f32 v228, v164
    v_add_f32 v232, v232, v220
    v_mfma_f32_16x16x32_bf16 v[152:155], v[212:215], v[128:131], v[152:155]
    ds_read_b128 v[212:215], v237 offset:4736
    v_exp_f32 v229, v165
    s_waitcnt lgkmcnt(3)
    v_mfma_f32_16x16x32_bf16 v[144:147], v[216:219], v[132:135], v[144:147]
    v_add_f32 v232, v232, v221
    v_cvt_pk_bf16_f32 v182, v220, v221
    v_exp_f32 v230, v166
    v_mfma_f32_16x16x32_bf16 v[148:151], v[216:219], v[136:139], v[148:151]
    v_add_f32 v232, v232, v222
    v_mfma_f32_16x16x32_bf16 v[152:155], v[216:219], v[140:143], v[152:155]
    ds_read_b128 v[216:219], v237 offset:4800
    v_exp_f32 v231, v167
    s_waitcnt lgkmcnt(3)
    v_mfma_f32_16x16x32_bf16 v[156:159], v[204:207], v[96:99], v[168:171]
    v_add_f32 v232, v232, v223
    v_cvt_pk_bf16_f32 v183, v222, v223
    v_add_f32 v233, v233, v224
    v_mfma_f32_16x16x32_bf16 v[160:163], v[204:207], v[100:103], v[172:175]
    v_add_f32 v233, v233, v225
    v_cvt_pk_bf16_f32 v186, v224, v225
    v_add_f32 v233, v233, v226
    v_mfma_f32_16x16x32_bf16 v[164:167], v[204:207], v[104:107], v[176:179]
    v_add_f32 v233, v233, v227
    v_cvt_pk_bf16_f32 v187, v226, v227
    v_add_f32 v234, v234, v228
    s_waitcnt lgkmcnt(2)
    v_mfma_f32_16x16x32_bf16 v[156:159], v[208:211], v[108:111], v[156:159]
    v_add_f32 v234, v234, v229
    v_cvt_pk_bf16_f32 v190, v228, v229
    v_mfma_f32_16x16x32_bf16 v[160:163], v[208:211], v[112:115], v[160:163]
    v_add_f32 v234, v234, v230
    v_add_f32 v234, v234, v231
    v_cvt_pk_bf16_f32 v191, v230, v231
    v_mfma_f32_16x16x32_bf16 v[164:167], v[208:211], v[116:119], v[164:167]
    s_waitcnt lgkmcnt(0)
    s_barrier
    v_mfma_f32_16x16x32_bf16 v[156:159], v[212:215], v[120:123], v[156:159]
    ds_read_b64_tr_b16 v[204:205], v251 offset:16896
    ds_read_b64_tr_b16 v[206:207], v251 offset:17408
    v_mfma_f32_16x16x32_bf16 v[160:163], v[212:215], v[124:127], v[160:163]
    ds_read_b64_tr_b16 v[208:209], v251 offset:16928
    ds_read_b64_tr_b16 v[210:211], v251 offset:17440
    v_mfma_f32_16x16x32_bf16 v[164:167], v[212:215], v[128:131], v[164:167]
    ds_read_b64_tr_b16 v[212:213], v251 offset:16960
    v_mfma_f32_16x16x32_bf16 v[156:159], v[216:219], v[132:135], v[156:159]
    ds_read_b64_tr_b16 v[214:215], v251 offset:17472
    v_mfma_f32_16x16x32_bf16 v[160:163], v[216:219], v[136:139], v[160:163]
    v_mfma_f32_16x16x32_bf16 v[164:167], v[216:219], v[140:143], v[164:167]
    ds_read_b64_tr_b16 v[216:217], v251 offset:16992
    s_waitcnt lgkmcnt(5)
    v_mfma_f32_16x16x32_bf16 v[0:3], v[204:207], v[180:183], 0
    ds_read_b64_tr_b16 v[218:219], v251 offset:17504
    v_mfma_f32_16x16x32_bf16 v[4:7], v[204:207], v[184:187], 0
    v_exp_f32 v220, v144
    v_exp_f32 v221, v145
    v_mfma_f32_16x16x32_bf16 v[8:11], v[204:207], v[188:191], 0
    ds_read_b64_tr_b16 v[204:205], v251 offset:21120
    v_exp_f32 v222, v146
    s_waitcnt lgkmcnt(5)
    v_mfma_f32_16x16x32_bf16 v[12:15], v[208:211], v[180:183], 0
    ds_read_b64_tr_b16 v[206:207], v251 offset:21632
    v_exp_f32 v223, v147
    v_mfma_f32_16x16x32_bf16 v[16:19], v[208:211], v[184:187], 0
    v_exp_f32 v224, v148
    v_mfma_f32_16x16x32_bf16 v[20:23], v[208:211], v[188:191], 0
    ds_read_b64_tr_b16 v[208:209], v251 offset:21152
    v_exp_f32 v225, v149
    s_waitcnt lgkmcnt(5)
    v_mfma_f32_16x16x32_bf16 v[24:27], v[212:215], v[180:183], 0
    ds_read_b64_tr_b16 v[210:211], v251 offset:21664
    v_exp_f32 v226, v150
    v_mfma_f32_16x16x32_bf16 v[28:31], v[212:215], v[184:187], 0
    v_exp_f32 v227, v151
    v_exp_f32 v228, v152
    v_mfma_f32_16x16x32_bf16 v[32:35], v[212:215], v[188:191], 0
    ds_read_b64_tr_b16 v[212:213], v251 offset:21184
    v_add_f32 v232, v232, v220
    v_exp_f32 v229, v153
    s_waitcnt lgkmcnt(5)
    v_mfma_f32_16x16x32_bf16 v[36:39], v[216:219], v[180:183], 0
    ds_read_b64_tr_b16 v[214:215], v251 offset:21696
    v_add_f32 v232, v232, v221
    v_mfma_f32_16x16x32_bf16 v[40:43], v[216:219], v[184:187], 0
    v_cvt_pk_bf16_f32 v192, v220, v221
    v_exp_f32 v230, v154
    v_mfma_f32_16x16x32_bf16 v[44:47], v[216:219], v[188:191], 0
    ds_read_b64_tr_b16 v[216:217], v251 offset:21216
    v_add_f32 v232, v232, v222
    v_exp_f32 v231, v155
    s_waitcnt lgkmcnt(5)
    v_mfma_f32_16x16x32_bf16 v[48:51], v[204:207], v[180:183], 0
    ds_read_b64_tr_b16 v[218:219], v251 offset:21728
    v_add_f32 v232, v232, v223
    v_cvt_pk_bf16_f32 v193, v222, v223
    v_mfma_f32_16x16x32_bf16 v[52:55], v[204:207], v[184:187], 0
    v_add_f32 v233, v233, v224
    v_add_f32 v233, v233, v225
    v_cvt_pk_bf16_f32 v196, v224, v225
    v_mfma_f32_16x16x32_bf16 v[56:59], v[204:207], v[188:191], 0
    v_add_f32 v233, v233, v226
    v_add_f32 v233, v233, v227
    v_cvt_pk_bf16_f32 v197, v226, v227
    s_waitcnt lgkmcnt(4)
    v_mfma_f32_16x16x32_bf16 v[60:63], v[208:211], v[180:183], 0
    v_add_f32 v234, v234, v228
    v_add_f32 v234, v234, v229
    v_cvt_pk_bf16_f32 v200, v228, v229
    v_mfma_f32_16x16x32_bf16 v[64:67], v[208:211], v[184:187], 0
    v_add_f32 v234, v234, v230
    v_add_f32 v234, v234, v231
    v_cvt_pk_bf16_f32 v201, v230, v231
    v_mfma_f32_16x16x32_bf16 v[68:71], v[208:211], v[188:191], 0
    s_add_u32 s34, s32, 1
    s_cmp_ge_u32 s34, s61
    s_cbranch_scc1 LA_tw_2
    s_lshl_b32 s34, s34, 9
    buffer_load_dword v241, v248, s[20:23], s34 offen
LA_tw_2:
    s_waitcnt lgkmcnt(0)
    s_mov_b32 s33, 7
LA_T:
    s_barrier
    v_mfma_f32_16x16x32_bf16 v[72:75], v[212:215], v[180:183], v[72:75]
    ds_read_b128 v[204:207], v237 offset:33792
    v_mfma_f32_16x16x32_bf16 v[76:79], v[212:215], v[184:187], v[76:79]
    ds_read_b128 v[208:211], v237 offset:33856
    v_mfma_f32_16x16x32_bf16 v[80:83], v[212:215], v[188:191], v[80:83]
    ds_read_b128 v[212:215], v237 offset:38016
    v_mfma_f32_16x16x32_bf16 v[84:87], v[216:219], v[180:183], v[84:87]
    v_mfma_f32_16x16x32_bf16 v[88:91], v[216:219], v[184:187], v[88:91]
    v_mfma_f32_16x16x32_bf16 v[92:95], v[216:219], v[188:191], v[92:95]
    ds_read_b128 v[216:219], v237 offset:38080
    s_waitcnt lgkmcnt(3)
    v_mfma_f32_16x16x32_bf16 v[144:147], v[204:207], v[96:99], v[168:171]
    v_mfma_f32_16x16x32_bf16 v[148:151], v[204:207], v[100:103], v[172:175]
    v_exp_f32 v220, v156
    v_mfma_f32_16x16x32_bf16 v[152:155], v[204:207], v[104:107], v[176:179]
    ds_read_b128 v[204:207], v237 offset:34304
    v_exp_f32 v221, v157
    s_waitcnt lgkmcnt(3)
    v_mfma_f32_16x16x32_bf16 v[144:147], v[208:211], v[108:111], v[144:147]
    v_exp_f32 v222, v158
    v_exp_f32 v223, v159
    v_mfma_f32_16x16x32_bf16 v[148:151], v[208:211], v[112:115], v[148:151]
    v_exp_f32 v224, v160
    v_mfma_f32_16x16x32_bf16 v[152:155], v[208:211], v[116:119], v[152:155]
    ds_read_b128 v[208:211], v237 offset:34368
    v_exp_f32 v225, v161
    s_waitcnt lgkmcnt(3)
    v_mfma_f32_16x16x32_bf16 v[144:147], v[212:215], v[120:123], v[144:147]
    v_exp_f32 v226, v162
    v_exp_f32 v227, v163
    v_mfma_f32_16x16x32_bf16 v[148:151], v[212:215], v[124:127], v[148:151]
    v_exp_f32 v228, v164
    v_mfma_f32_16x16x32_bf16 v[152:155], v[212:215], v[128:131], v[152:155]
    ds_read_b128 v[212:215], v237 offset:38528
    v_add_f32 v232, v232, v220
    v_exp_f32 v229, v165
    s_waitcnt lgkmcnt(3)
    v_mfma_f32_16x16x32_bf16 v[144:147], v[216:219], v[132:135], v[144:147]
    v_add_f32 v232, v232, v221
    v_cvt_pk_bf16_f32 v194, v220, v221
    v_mfma_f32_16x16x32_bf16 v[148:151], v[216:219], v[136:139], v[148:151]
    v_exp_f32 v230, v166
    v_add_f32 v232, v232, v222
    v_mfma_f32_16x16x32_bf16 v[152:155], v[216:219], v[140:143], v[152:155]
    ds_read_b128 v[216:219], v237 offset:38592
    v_exp_f32 v231, v167
    s_waitcnt lgkmcnt(3)
    v_mfma_f32_16x16x32_bf16 v[156:159], v[204:207], v[96:99], v[168:171]
    v_add_f32 v232, v232, v223
    v_cvt_pk_bf16_f32 v195, v222, v223
    v_add_f32 v233, v233, v224
    v_mfma_f32_16x16x32_bf16 v[160:163], v[204:207], v[100:103], v[172:175]
    v_add_f32 v233, v233, v225
    v_cvt_pk_bf16_f32 v198, v224, v225
    v_mfma_f32_16x16x32_bf16 v[164:167], v[204:207], v[104:107], v[176:179]
    v_add_f32 v233, v233, v226
    v_add_f32 v233, v233, v227
    v_cvt_pk_bf16_f32 v199, v226, v227
    s_waitcnt lgkmcnt(2)
    v_mfma_f32_16x16x32_bf16 v[156:159], v[208:211], v[108:111], v[156:159]
    v_add_f32 v234, v234, v228
    v_add_f32 v234, v234, v229
    v_cvt_pk_bf16_f32 v202, v228, v229
    v_mfma_f32_16x16x32_bf16 v[160:163], v[208:211], v[112:115], v[160:163]
    v_add_f32 v234, v234, v230
    v_add_f32 v234, v234, v231
    v_cvt_pk_bf16_f32 v203, v230, v231
    v_mfma_f32_16x16x32_bf16 v[164:167], v[208:211], v[116:119], v[164:167]
    s_waitcnt lgkmcnt(0)
    s_barrier
    v_mfma_f32_16x16x32_bf16 v[156:159], v[212:215], v[120:123], v[156:159]
    ds_read_b64_tr_b16 v[204:205], v251 offset:50688
    ds_read_b64_tr_b16 v[206:207], v251 offset:51200
    v_mfma_f32_16x16x32_bf16 v[160:163], v[212:215], v[124:127], v[160:163]
    ds_read_b64_tr_b16 v[208:209], v251 offset:50720
    ds_read_b64_tr_b16 v[210:211], v251 offset:51232
    v_mfma_f32_16x16x32_bf16 v[164:167], v[212:215], v[128:131], v[164:167]
    ds_read_b64_tr_b16 v[212:213], v251 offset:50752
    v_mfma_f32_16x16x32_bf16 v[156:159], v[216:219], v[132:135], v[156:159]
    ds_read_b64_tr_b16 v[214:215], v251 offset:51264
    v_mfma_f32_16x16x32_bf16 v[160:163], v[216:219], v[136:139], v[160:163]
    v_mfma_f32_16x16x32_bf16 v[164:167], v[216:219], v[140:143], v[164:167]
    ds_read_b64_tr_b16 v[216:217], v251 offset:50784
    s_waitcnt lgkmcnt(5)
    v_mfma_f32_16x16x32_bf16 v[0:3], v[204:207], v[192:195], v[0:3]
    ds_read_b64_tr_b16 v[218:219], v251 offset:51296
    v_mfma_f32_16x16x32_bf16 v[4:7], v[204:207], v[196:199], v[4:7]
    v_exp_f32 v220, v144
    v_exp_f32 v221, v145
    v_mfma_f32_16x16x32_bf16 v[8:11], v[204:207], v[200:203], v[8:11]
    ds_read_b64_tr_b16 v[204:205], v251 offset:54912
    v_exp_f32 v222, v146
    s_waitcnt lgkmcnt(5)
    v_mfma_f32_16x16x32_bf16 v[12:15], v[208:211], v[192:195], v[12:15]
    ds_read_b64_tr_b16 v[206:207], v251 offset:55424
    v_exp_f32 v223, v147
    v_mfma_f32_16x16x32_bf16 v[16:19], v[208:211], v[196:199], v[16:19]
    v_exp_f32 v224, v148
    v_mfma_f32_16x16x32_bf16 v[20:23], v[208:211], v[200:203], v[20:23]
    ds_read_b64_tr_b16 v[208:209], v251 offset:54944
    v_exp_f32 v225, v149
    s_waitcnt lgkmcnt(5)
    v_mfma_f32_16x16x32_bf16 v[24:27], v[212:215], v[192:195], v[24:27]
    ds_read_b64_tr_b16 v[210:211], v251 offset:55456
    v_exp_f32 v226, v150
    v_mfma_f32_16x16x32_bf16 v[28:31], v[212:215], v[196:199], v[28:31]
    v_exp_f32 v227, v151
    v_exp_f32 v228, v152
    v_mfma_f32_16x16x32_bf16 v[32:35], v[212:215], v[200:203], v[32:35]
    ds_read_b64_tr_b16 v[212:213], v251 offset:54976
    v_add_f32 v232, v232, v220
    v_exp_f32 v229, v153
    s_waitcnt lgkmcnt(5)
    v_mfma_f32_16x16x32_bf16 v[36:39], v[216:219], v[192:195], v[36:39]
    ds_read_b64_tr_b16 v[214:215], v251 offset:55488
    v_add_f32 v232, v232, v221
    v_mfma_f32_16x16x32_bf16 v[40:43], v[216:219], v[196:199], v[40:43]
    v_cvt_pk_bf16_f32 v180, v220, v221
    v_exp_f32 v230, v154
    v_mfma_f32_16x16x32_bf16 v[44:47], v[216:219], v[200:203], v[44:47]
    ds_read_b64_tr_b16 v[216:217], v251 offset:55008
    v_add_f32 v232, v232, v222
    v_exp_f32 v231, v155
    s_waitcnt lgkmcnt(5)
    v_mfma_f32_16x16x32_bf16 v[48:51], v[204:207], v[192:195], v[48:51]
    ds_read_b64_tr_b16 v[218:219], v251 offset:55520
    v_add_f32 v232, v232, v223
    v_cvt_pk_bf16_f32 v181, v222, v223
    v_mfma_f32_16x16x32_bf16 v[52:55], v[204:207], v[196:199], v[52:55]
    v_add_f32 v233, v233, v224
    v_add_f32 v233, v233, v225
    v_cvt_pk_bf16_f32 v184, v224, v225
    v_mfma_f32_16x16x32_bf16 v[56:59], v[204:207], v[200:203], v[56:59]
    v_add_f32 v233, v233, v226
    v_add_f32 v233, v233, v227
    v_cvt_pk_bf16_f32 v185, v226, v227
    s_waitcnt lgkmcnt(4)
    v_mfma_f32_16x16x32_bf16 v[60:63], v[208:211], v[192:195], v[60:63]
    v_add_f32 v234, v234, v228
    v_add_f32 v234, v234, v229
    v_cvt_pk_bf16_f32 v188, v228, v229
    v_mfma_f32_16x16x32_bf16 v[64:67], v[208:211], v[196:199], v[64:67]
    v_add_f32 v234, v234, v230
    v_add_f32 v234, v234, v231
    v_cvt_pk_bf16_f32 v189, v230, v231
    v_mfma_f32_16x16x32_bf16 v[68:71], v[208:211], v[200:203], v[68:71]
    s_waitcnt lgkmcnt(0)
    s_barrier
    v_mfma_f32_16x16x32_bf16 v[72:75], v[212:215], v[192:195], v[72:75]
    ds_read_b128 v[204:207], v237 offset:0
    v_mfma_f32_16x16x32_bf16 v[76:79], v[212:215], v[196:199], v[76:79]
    ds_read_b128 v[208:211], v237 offset:64
    v_mfma_f32_16x16x32_bf16 v[80:83], v[212:215], v[200:203], v[80:83]
    ds_read_b128 v[212:215], v237 offset:4224
    v_mfma_f32_16x16x32_bf16 v[84:87], v[216:219], v[192:195], v[84:87]
    v_mfma_f32_16x16x32_bf16 v[88:91], v[216:219], v[196:199], v[88:91]
    v_mfma_f32_16x16x32_bf16 v[92:95], v[216:219], v[200:203], v[92:95]
    ds_read_b128 v[216:219], v237 offset:4288
    s_waitcnt lgkmcnt(3)
    v_mfma_f32_16x16x32_bf16 v[144:147], v[204:207], v[96:99], v[168:171]
    v_mfma_f32_16x16x32_bf16 v[148:151], v[204:207], v[100:103], v[172:175]
    v_exp_f32 v220, v156
    v_mfma_f32_16x16x32_bf16 v[152:155], v[204:207], v[104:107], v[176:179]
    ds_read_b128 v[204:207], v237 offset:512
    v_exp_f32 v221, v157
    s_waitcnt lgkmcnt(3)
    v_mfma_f32_16x16x32_bf16 v[144:147], v[208:211], v[108:111], v[144:147]
    v_exp_f32 v222, v158
    v_exp_f32 v223, v159
    v_mfma_f32_16x16x32_bf16 v[148:151], v[208:211], v[112:115], v[148:151]
    v_exp_f32 v224, v160
    v_mfma_f32_16x16x32_bf16 v[152:155], v[208:211], v[116:119], v[152:155]
    ds_read_b128 v[208:211], v237 offset:576
    v_exp_f32 v225, v161
    s_waitcnt lgkmcnt(3)
    v_mfma_f32_16x16x32_bf16 v[144:147], v[212:215], v[120:123], v[144:147]
    v_exp_f32 v226, v162
    v_exp_f32 v227, v163
    v_mfma_f32_16x16x32_bf16 v[148:151], v[212:215], v[124:127], v[148:151]
    v_exp_f32 v228, v164
    v_mfma_f32_16x16x32_bf16 v[152:155], v[212:215], v[128:131], v[152:155]
    ds_read_b128 v[212:215], v237 offset:4736
    v_add_f32 v232, v232, v220
    v_exp_f32 v229, v165
    s_waitcnt lgkmcnt(3)
    v_mfma_f32_16x16x32_bf16 v[144:147], v[216:219], v[132:135], v[144:147]
    v_add_f32 v232, v232, v221
    v_cvt_pk_bf16_f32 v182, v220, v221
    v_mfma_f32_16x16x32_bf16 v[148:151], v[216:219], v[136:139], v[148:151]
    v_exp_f32 v230, v166
    v_add_f32 v232, v232, v222
    v_mfma_f32_16x16x32_bf16 v[152:155], v[216:219], v[140:143], v[152:155]
    ds_read_b128 v[216:219], v237 offset:4800
    v_exp_f32 v231, v167
    s_waitcnt lgkmcnt(3)
    v_mfma_f32_16x16x32_bf16 v[156:159], v[204:207], v[96:99], v[168:171]
    v_add_f32 v232, v232, v223
    v_cvt_pk_bf16_f32 v183, v222, v223
    v_add_f32 v233, v233, v224
    v_mfma_f32_16x16x32_bf16 v[160:163], v[204:207], v[100:103], v[172:175]
    v_add_f32 v233, v233, v225
    v_cvt_pk_bf16_f32 v186, v224, v225
    v_mfma_f32_16x16x32_bf16 v[164:167], v[204:207], v[104:107], v[176:179]
    v_add_f32 v233, v233, v226
    v_add_f32 v233, v233, v227
    v_cvt_pk_bf16_f32 v187, v226, v227
    s_waitcnt lgkmcnt(2)
    v_mfma_f32_16x16x32_bf16 v[156:159], v[208:211], v[108:111], v[156:159]
    v_add_f32 v234, v234, v228
    v_add_f32 v234, v234, v229
    v_cvt_pk_bf16_f32 v190, v228, v229
    v_mfma_f32_16x16x32_bf16 v[160:163], v[208:211], v[112:115], v[160:163]
    v_add_f32 v234, v234, v230
    v_add_f32 v234, v234, v231
    v_cvt_pk_bf16_f32 v191, v230, v231
    v_mfma_f32_16x16x32_bf16 v[164:167], v[208:211], v[116:119], v[164:167]
    s_waitcnt lgkmcnt(0)
    s_barrier
    v_mfma_f32_16x16x32_bf16 v[156:159], v[212:215], v[120:123], v[156:159]
    ds_read_b64_tr_b16 v[204:205], v251 offset:16896
    ds_read_b64_tr_b16 v[206:207], v251 offset:17408
    v_mfma_f32_16x16x32_bf16 v[160:163], v[212:215], v[124:127], v[160:163]
    ds_read_b64_tr_b16 v[208:209], v251 offset:16928
    ds_read_b64_tr_b16 v[210:211], v251 offset:17440
    v_mfma_f32_16x16x32_bf16 v[164:167], v[212:215], v[128:131], v[164:167]
    ds_read_b64_tr_b16 v[212:213], v251 offset:16960
    v_mfma_f32_16x16x32_bf16 v[156:159], v[216:219], v[132:135], v[156:159]
    ds_read_b64_tr_b16 v[214:215], v251 offset:17472
    v_mfma_f32_16x16x32_bf16 v[160:163], v[216:219], v[136:139], v[160:163]
    v_mfma_f32_16x16x32_bf16 v[164:167], v[216:219], v[140:143], v[164:167]
    ds_read_b64_tr_b16 v[216:217], v251 offset:16992
    s_waitcnt lgkmcnt(5)
    v_mfma_f32_16x16x32_bf16 v[0:3], v[204:207], v[180:183], v[0:3]
    ds_read_b64_tr_b16 v[218:219], v251 offset:17504
    v_mfma_f32_16x16x32_bf16 v[4:7], v[204:207], v[184:187], v[4:7]
    v_exp_f32 v220, v144
    v_exp_f32 v221, v145
    v_mfma_f32_16x16x32_bf16 v[8:11], v[204:207], v[188:191], v[8:11]
    ds_read_b64_tr_b16 v[204:205], v251 offset:21120
    v_exp_f32 v222, v146
    s_waitcnt lgkmcnt(5)
    v_mfma_f32_16x16x32_bf16 v[12:15], v[208:211], v[180:183], v[12:15]
    ds_read_b64_tr_b16 v[206:207], v251 offset:21632
    v_exp_f32 v223, v147
    v_mfma_f32_16x16x32_bf16 v[16:19], v[208:211], v[184:187], v[16:19]
    v_exp_f32 v224, v148
    v_mfma_f32_16x16x32_bf16 v[20:23], v[208:211], v[188:191], v[20:23]
    ds_read_b64_tr_b16 v[208:209], v251 offset:21152
    v_exp_f32 v225, v149
    s_waitcnt lgkmcnt(5)
    v_mfma_f32_16x16x32_bf16 v[24:27], v[212:215], v[180:183], v[24:27]
    ds_read_b64_tr_b16 v[210:211], v251 offset:21664
    v_exp_f32 v226, v150
    v_mfma_f32_16x16x32_bf16 v[28:31], v[212:215], v[184:187], v[28:31]
    v_exp_f32 v227, v151
    v_exp_f32 v228, v152
    v_mfma_f32_16x16x32_bf16 v[32:35], v[212:215], v[188:191], v[32:35]
    ds_read_b64_tr_b16 v[212:213], v251 offset:21184
    v_add_f32 v232, v232, v220
    v_exp_f32 v229, v153
    s_waitcnt lgkmcnt(5)
    v_mfma_f32_16x16x32_bf16 v[36:39], v[216:219], v[180:183], v[36:39]
    ds_read_b64_tr_b16 v[214:215], v251 offset:21696
    v_add_f32 v232, v232, v221
    v_mfma_f32_16x16x32_bf16 v[40:43], v[216:219], v[184:187], v[40:43]
    v_cvt_pk_bf16_f32 v192, v220, v221
    v_exp_f32 v230, v154
    v_mfma_f32_16x16x32_bf16 v[44:47], v[216:219], v[188:191], v[44:47]
    ds_read_b64_tr_b16 v[216:217], v251 offset:21216
    v_add_f32 v232, v232, v222
    v_exp_f32 v231, v155
    s_waitcnt lgkmcnt(5)
    v_mfma_f32_16x16x32_bf16 v[48:51], v[204:207], v[180:183], v[48:51]
    ds_read_b64_tr_b16 v[218:219], v251 offset:21728
    v_add_f32 v232, v232, v223
    v_cvt_pk_bf16_f32 v193, v222, v223
    v_mfma_f32_16x16x32_bf16 v[52:55], v[204:207], v[184:187], v[52:55]
    v_add_f32 v233, v233, v224
    v_add_f32 v233, v233, v225
    v_cvt_pk_bf16_f32 v196, v224, v225
    v_mfma_f32_16x16x32_bf16 v[56:59], v[204:207], v[188:191], v[56:59]
    v_add_f32 v233, v233, v226
    v_add_f32 v233, v233, v227
    v_cvt_pk_bf16_f32 v197, v226, v227
    s_waitcnt lgkmcnt(4)
    v_mfma_f32_16x16x32_bf16 v[60:63], v[208:211], v[180:183], v[60:63]
    v_add_f32 v234, v234, v228
    v_add_f32 v234, v234, v229
    v_cvt_pk_bf16_f32 v200, v228, v229
    v_mfma_f32_16x16x32_bf16 v[64:67], v[208:211], v[184:187], v[64:67]
    v_add_f32 v234, v234, v230
    v_add_f32 v234, v234, v231
    v_cvt_pk_bf16_f32 v201, v230, v231
    v_mfma_f32_16x16x32_bf16 v[68:71], v[208:211], v[188:191], v[68:71]
    s_waitcnt lgkmcnt(0)
    s_sub_u32 s33, s33, 1
    s_cmp_lg_u32 s33, 0
    s_cbranch_scc1 LA_T
    s_barrier
    s_mul_i32 s34, s32, 294912
    buffer_load_dword v241, v249, s[24:27], s34 offen
    v_mfma_f32_16x16x32_bf16 v[72:75], v[212:215], v[180:183], v[72:75]
    ds_read_b64_tr_b16 v[204:205], v251 offset:33792
    ds_read_b64_tr_b16 v[206:207], v251 offset:34304
    v_mfma_f32_16x16x32_bf16 v[76:79], v[212:215], v[184:187], v[76:79]
    ds_read_b64_tr_b16 v[208:209], v251 offset:33824
    ds_read_b64_tr_b16 v[210:211], v251 offset:34336
    v_mfma_f32_16x16x32_bf16 v[80:83], v[212:215], v[188:191], v[80:83]
    ds_read_b64_tr_b16 v[212:213], v251 offset:33856
    v_mfma_f32_16x16x32_bf16 v[84:87], v[216:219], v[180:183], v[84:87]
    ds_read_b64_tr_b16 v[214:215], v251 offset:34368
    v_mfma_f32_16x16x32_bf16 v[88:91], v[216:219], v[184:187], v[88:91]
    v_mfma_f32_16x16x32_bf16 v[92:95], v[216:219], v[188:191], v[92:95]
    ds_read_b64_tr_b16 v[216:217], v251 offset:33888
    ds_read_b64_tr_b16 v[218:219], v251 offset:34400
    v_exp_f32 v220, v156
    v_exp_f32 v221, v157
    v_exp_f32 v222, v158
    v_exp_f32 v223, v159
    v_exp_f32 v224, v160
    v_exp_f32 v225, v161
    v_exp_f32 v226, v162
    v_exp_f32 v227, v163
    v_exp_f32 v228, v164
    v_add_f32 v232, v232, v220
    v_exp_f32 v229, v165
    v_add_f32 v232, v232, v221
    v_cvt_pk_bf16_f32 v194, v220, v221
    v_exp_f32 v230, v166
    v_add_f32 v232, v232, v222
    v_exp_f32 v231, v167
    v_add_f32 v232, v232, v223
    v_cvt_pk_bf16_f32 v195, v222, v223
    v_add_f32 v233, v233, v224
    v_add_f32 v233, v233, v225
    v_cvt_pk_bf16_f32 v198, v224, v225
    v_add_f32 v233, v233, v226
    v_add_f32 v233, v233, v227
    v_cvt_pk_bf16_f32 v199, v226, v227
    v_add_f32 v234, v234, v228
    v_add_f32 v234, v234, v229
    v_cvt_pk_bf16_f32 v202, v228, v229
    v_add_f32 v234, v234, v230
    v_add_f32 v234, v234, v231
    v_cvt_pk_bf16_f32 v203, v230, v231
    s_waitcnt lgkmcnt(6)
    v_mfma_f32_16x16x32_bf16 v[0:3], v[204:207], v[192:195], v[0:3]
    s_mov_b32 s40, 0
    v_mov_b32 v245, v232
    v_mov_b32 v246, v233
    v_mov_b32 v247, v234
    s_nop 0
    v_mfma_f32_16x16x32_bf16 v[4:7], v[204:207], v[196:199], v[4:7]
    s_mov_b32 s41, 0
    v_permlane32_swap_b32 v232, v245
    v_permlane32_swap_b32 v233, v246
    v_permlane32_swap_b32 v234, v247
    v_add_f32 v232, v232, v245
    v_add_f32 v233, v233, v246
    v_mfma_f32_16x16x32_bf16 v[8:11], v[204:207], v[200:203], v[8:11]
    ds_read_b64_tr_b16 v[204:205], v251 offset:38016
    v_add_f32 v234, v234, v247
    v_mov_b32 v245, v232
    v_mov_b32 v246, v233
    v_mov_b32 v247, v234
    s_waitcnt lgkmcnt(5)
    v_mfma_f32_16x16x32_bf16 v[12:15], v[208:211], v[192:195], v[12:15]
    ds_read_b64_tr_b16 v[206:207], v251 offset:38528
    s_nop 0
    v_permlane16_swap_b32 v232, v245
    v_permlane16_swap_b32 v233, v246
    v_permlane16_swap_b32 v234, v247
    v_add_f32 v232, v232, v245
    v_mfma_f32_16x16x32_bf16 v[16:19], v[208:211], v[196:199], v[16:19]
    v_add_f32 v233, v233, v246
    v_add_f32 v234, v234, v247
    v_cmp_ngt_f32 vcc, s46, v232
    v_rcp_f32 v242, v232
    v_mfma_f32_16x16x32_bf16 v[20:23], v[208:211], v[200:203], v[20:23]
    ds_read_b64_tr_b16 v[208:209], v251 offset:38048
    s_nop 0
    s_or_b64 s[44:45], s[44:45], vcc
    v_cmp_ngt_f32 vcc, s46, v233
    v_rcp_f32 v244, v233
    s_waitcnt lgkmcnt(5)
    v_mfma_f32_16x16x32_bf16 v[24:27], v[212:215], v[192:195], v[24:27]
    ds_read_b64_tr_b16 v[210:211], v251 offset:38560
    s_nop 0
    s_or_b64 s[44:45], s[44:45], vcc
    v_cmp_ngt_f32 vcc, s46, v234
    v_rcp_f32 v246, v234
    v_mfma_f32_16x16x32_bf16 v[28:31], v[212:215], v[196:199], v[28:31]
    s_nop 0
    s_or_b64 s[44:45], s[44:45], vcc
    v_mfma_f32_16x16x32_bf16 v[32:35], v[212:215], v[200:203], v[32:35]
    ds_read_b64_tr_b16 v[212:213], v251 offset:38080
    v_mul_f32 v0, v242, v0
    v_mul_f32 v1, v242, v1
    v_mul_f32 v2, v242, v2
    v_mul_f32 v3, v242, v3
    v_cvt_pk_bf16_f32 v0, v0, v1
    v_cvt_pk_bf16_f32 v1, v2, v3
    v_mul_f32 v12, v242, v12
    s_waitcnt lgkmcnt(5)
    v_mfma_f32_16x16x32_bf16 v[36:39], v[216:219], v[192:195], v[36:39]
    ds_read_b64_tr_b16 v[214:215], v251 offset:38592
    v_mul_f32 v13, v242, v13
    v_mul_f32 v14, v242, v14
    v_mul_f32 v15, v242, v15
    v_cvt_pk_bf16_f32 v2, v12, v13
    v_mfma_f32_16x16x32_bf16 v[40:43], v[216:219], v[196:199], v[40:43]
    v_cvt_pk_bf16_f32 v3, v14, v15
    ds_write_b128 v240, v[0:3] offset:0
    v_mul_f32 v4, v244, v4
    v_mul_f32 v5, v244, v5
    v_mul_f32 v6, v244, v6
    v_mul_f32 v7, v244, v7
    v_mfma_f32_16x16x32_bf16 v[44:47], v[216:219], v[200:203], v[44:47]
    ds_read_b64_tr_b16 v[216:217], v251 offset:38112
    v_cvt_pk_bf16_f32 v4, v4, v5
    v_cvt_pk_bf16_f32 v5, v6, v7
    v_mul_f32 v16, v244, v16
    v_mul_f32 v17, v244, v17
    s_waitcnt lgkmcnt(6)
    v_mfma_f32_16x16x32_bf16 v[48:51], v[204:207], v[192:195], v[48:51]
    ds_read_b64_tr_b16 v[218:219], v251 offset:38624
    v_mul_f32 v18, v244, v18
    v_mul_f32 v19, v244, v19
    v_cvt_pk_bf16_f32 v6, v16, v17
    v_cvt_pk_bf16_f32 v7, v18, v19
    ds_write_b128 v240, v[4:7] offset:2048
    v_mfma_f32_16x16x32_bf16 v[52:55], v[204:207], v[196:199], v[52:55]
    v_mov_b32 v236, v238
    v_mul_f32 v8, v246, v8
    v_mul_f32 v9, v246, v9
    v_mul_f32 v10, v246, v10
    v_mul_f32 v11, v246, v11
    v_mfma_f32_16x16x32_bf16 v[56:59], v[204:207], v[200:203], v[56:59]
    v_mov_b32 v235, v239
    v_cvt_pk_bf16_f32 v8, v8, v9
    v_cvt_pk_bf16_f32 v9, v10, v11
    v_mul_f32 v20, v246, v20
    v_mul_f32 v21, v246, v21
    v_mul_f32 v22, v246, v22
    s_waitcnt lgkmcnt(6)
    v_mfma_f32_16x16x32_bf16 v[60:63], v[208:211], v[192:195], v[60:63]
    v_mul_f32 v23, v246, v23
    v_cvt_pk_bf16_f32 v10, v20, v21
    v_cvt_pk_bf16_f32 v11, v22, v23
    ds_write_b128 v240, v[8:11] offset:4096
    v_mul_f32 v24, v242, v24
    v_mfma_f32_16x16x32_bf16 v[64:67], v[208:211], v[196:199], v[64:67]
    v_mul_f32 v25, v242, v25
    v_mul_f32 v26, v242, v26
    v_mul_f32 v27, v242, v27
    v_cvt_pk_bf16_f32 v24, v24, v25
    v_cvt_pk_bf16_f32 v25, v26, v27
    v_mfma_f32_16x16x32_bf16 v[68:71], v[208:211], v[200:203], v[68:71]
    v_mul_f32 v36, v242, v36
    v_mul_f32 v37, v242, v37
    v_mul_f32 v38, v242, v38
    v_mul_f32 v39, v242, v39
    v_cvt_pk_bf16_f32 v26, v36, v37
    v_cvt_pk_bf16_f32 v27, v38, v39
    s_waitcnt lgkmcnt(5)
    v_mfma_f32_16x16x32_bf16 v[72:75], v[212:215], v[192:195], v[72:75]
    ds_write_b128 v240, v[24:27] offset:6144
    v_mul_f32 v28, v244, v28
    v_mul_f32 v29, v244, v29
    v_mul_f32 v30, v244, v30
    v_mul_f32 v31, v244, v31
    v_mfma_f32_16x16x32_bf16 v[76:79], v[212:215], v[196:199], v[76:79]
    v_cvt_pk_bf16_f32 v28, v28, v29
    v_cvt_pk_bf16_f32 v29, v30, v31
    v_mul_f32 v40, v244, v40
    v_mul_f32 v41, v244, v41
    v_mul_f32 v42, v244, v42
    v_mul_f32 v43, v244, v43
    v_mfma_f32_16x16x32_bf16 v[80:83], v[212:215], v[200:203], v[80:83]
    v_cvt_pk_bf16_f32 v30, v40, v41
    v_cvt_pk_bf16_f32 v31, v42, v43
    ds_write_b128 v240, v[28:31] offset:8192
    v_mul_f32 v32, v246, v32
    v_mul_f32 v33, v246, v33
    s_waitcnt lgkmcnt(4)
    v_mfma_f32_16x16x32_bf16 v[84:87], v[216:219], v[192:195], v[84:87]
    v_mul_f32 v34, v246, v34
    v_mul_f32 v35, v246, v35
    v_cvt_pk_bf16_f32 v32, v32, v33
    v_cvt_pk_bf16_f32 v33, v34, v35
    v_mul_f32 v44, v246, v44
    v_mul_f32 v45, v246, v45
    v_mfma_f32_16x16x32_bf16 v[88:91], v[216:219], v[196:199], v[88:91]
    v_mul_f32 v46, v246, v46
    v_mul_f32 v47, v246, v47
    v_cvt_pk_bf16_f32 v34, v44, v45
    v_cvt_pk_bf16_f32 v35, v46, v47
    ds_write_b128 v240, v[32:35] offset:10240
    v_mfma_f32_16x16x32_bf16 v[92:95], v[216:219], v[200:203], v[92:95]
    s_nop 7
    v_pk_mul_f32 v[48:49], v[48:49], v[242:243] op_sel_hi:[1,0]
    v_pk_mul_f32 v[50:51], v[50:51], v[242:243] op_sel_hi:[1,0]
    v_cvt_pk_bf16_f32 v48, v48, v49
    v_cvt_pk_bf16_f32 v49, v50, v51
    v_pk_mul_f32 v[60:61], v[60:61], v[242:243] op_sel_hi:[1,0]
    v_pk_mul_f32 v[62:63], v[62:63], v[242:243] op_sel_hi:[1,0]
    v_cvt_pk_bf16_f32 v50, v60, v61
    v_cvt_pk_bf16_f32 v51, v62, v63
    ds_write_b128 v240, v[48:51] offset:12288
    v_pk_mul_f32 v[52:53], v[52:53], v[244:245] op_sel_hi:[1,0]
    v_pk_mul_f32 v[54:55], v[54:55], v[244:245] op_sel_hi:[1,0]
    v_cvt_pk_bf16_f32 v52, v52, v53
    v_cvt_pk_bf16_f32 v53, v54, v55
    v_pk_mul_f32 v[64:65], v[64:65], v[244:245] op_sel_hi:[1,0]
    v_pk_mul_f32 v[66:67], v[66:67], v[244:245] op_sel_hi:[1,0]
    v_cvt_pk_bf16_f32 v54, v64, v65
    v_cvt_pk_bf16_f32 v55, v66, v67
    ds_write_b128 v240, v[52:55] offset:14336
    v_pk_mul_f32 v[56:57], v[56:57], v[246:247] op_sel_hi:[1,0]
    v_pk_mul_f32 v[58:59], v[58:59], v[246:247] op_sel_hi:[1,0]
    v_cvt_pk_bf16_f32 v56, v56, v57
    v_cvt_pk_bf16_f32 v57, v58, v59
    v_pk_mul_f32 v[68:69], v[68:69], v[246:247] op_sel_hi:[1,0]
    v_pk_mul_f32 v[70:71], v[70:71], v[246:247] op_sel_hi:[1,0]
    v_cvt_pk_bf16_f32 v58, v68, v69
    v_cvt_pk_bf16_f32 v59, v70, v71
    ds_write_b128 v240, v[56:59] offset:16384
    v_pk_mul_f32 v[72:73], v[72:73], v[242:243] op_sel_hi:[1,0]
    v_pk_mul_f32 v[74:75], v[74:75], v[242:243] op_sel_hi:[1,0]
    v_cvt_pk_bf16_f32 v72, v72, v73
    v_cvt_pk_bf16_f32 v73, v74, v75
    v_pk_mul_f32 v[84:85], v[84:85], v[242:243] op_sel_hi:[1,0]
    v_pk_mul_f32 v[86:87], v[86:87], v[242:243] op_sel_hi:[1,0]
    v_cvt_pk_bf16_f32 v74, v84, v85
    v_cvt_pk_bf16_f32 v75, v86, v87
    ds_write_b128 v240, v[72:75] offset:18432
    v_pk_mul_f32 v[76:77], v[76:77], v[244:245] op_sel_hi:[1,0]
    v_pk_mul_f32 v[78:79], v[78:79], v[244:245] op_sel_hi:[1,0]
    v_cvt_pk_bf16_f32 v76, v76, v77
    v_cvt_pk_bf16_f32 v77, v78, v79
    v_pk_mul_f32 v[88:89], v[88:89], v[244:245] op_sel_hi:[1,0]
    v_pk_mul_f32 v[90:91], v[90:91], v[244:245] op_sel_hi:[1,0]
    v_cvt_pk_bf16_f32 v78, v88, v89
    v_cvt_pk_bf16_f32 v79, v90, v91
    ds_write_b128 v240, v[76:79] offset:20480
    v_pk_mul_f32 v[80:81], v[80:81], v[246:247] op_sel_hi:[1,0]
    v_pk_mul_f32 v[82:83], v[82:83], v[246:247] op_sel_hi:[1,0]
    v_cvt_pk_bf16_f32 v80, v80, v81
    v_cvt_pk_bf16_f32 v81, v82, v83
    v_pk_mul_f32 v[92:93], v[92:93], v[246:247] op_sel_hi:[1,0]
    v_pk_mul_f32 v[94:95], v[94:95], v[246:247] op_sel_hi:[1,0]
    v_cvt_pk_bf16_f32 v82, v92, v93
    v_cvt_pk_bf16_f32 v83, v94, v95
    ds_write_b128 v240, v[80:83] offset:22528
    s_add_u32 s32, s32, 1
    s_cmp_eq_u32 s32, 4
    s_waitcnt lgkmcnt(0)
    s_cbranch_scc1 LA_END
    s_branch LA_Q0
LA_END:
    s_cmp_lg_u64 s[44:45], 0
    s_cselect_b32 s34, 1, 0
    v_mov_b32 v243, s34
    s_lshl_b32 s34, s36, 2
    v_mov_b32 v244, s34
    ds_write_b32 v244, v243
    v_mbcnt_lo_u32_b32 v243, -1, 0
    v_mbcnt_hi_u32_b32 v243, -1, v243
    v_lshrrev_b32 v244, 3, v243
    v_and_b32 v243, 7, v243
    v_lshlrev_b32 v243, 4, v243
    s_mul_i32 s34, s36, 1152
    v_mul_u32_u24 v242, 4608, v244
    v_add3_u32 v242, v242, v243, s34
    s_mul_i32 s48, s36, 1056
    s_add_u32 s48, s48, 640
    s_mov_b32 s47, 921600
    s_waitcnt lgkmcnt(0)
    s_barrier
    v_mov_b32 v4, 0
    ds_read_b128 v[0:3], v4
    s_waitcnt lgkmcnt(0)
    v_or_b32 v0, v0, v1
    v_or3_b32 v0, v0, v2, v3
    s_nop 0
    v_readfirstlane_b32 s34, v0
    s_nop 1
    s_cmp_lg_u32 s34, 0
    s_cbranch_scc1 LA_SAFE
    s_add_u32 s35, s47, s90
    s_add_u32 m0, s48, 21120
    s_nop 0
    buffer_load_dwordx4 v242, s[24:27], s35 offen lds
    s_add_u32 s35, s47, s91
    s_add_u32 m0, s48, 25344
    s_nop 0
    buffer_load_dwordx4 v242, s[24:27], s35 offen lds
    s_add_u32 s35, s47, s92
    s_add_u32 m0, s48, 29568
    s_nop 0
    buffer_load_dwordx4 v242, s[24:27], s35 offen lds
    s_add_u32 s35, s47, s93
    s_add_u32 m0, s48, 33792
    s_nop 0
    buffer_load_dwordx4 v242, s[24:27], s35 offen lds
    s_add_u32 s35, s47, s94
    s_add_u32 m0, s48, 38016
    s_nop 0
    buffer_load_dwordx4 v242, s[24:27], s35 offen lds
    s_add_u32 s35, s47, s95
    s_add_u32 m0, s48, 42240
    s_nop 0
    buffer_load_dwordx4 v242, s[24:27], s35 offen lds
    s_add_u32 s35, s47, s96
    s_add_u32 m0, s48, 46464
    s_nop 0
    buffer_load_dwordx4 v242, s[24:27], s35 offen lds
    s_add_u32 s35, s47, s97
    s_add_u32 m0, s48, 50688
    s_nop 0
    buffer_load_dwordx4 v242, s[24:27], s35 offen lds
    s_add_u32 s35, s47, s98
    s_add_u32 m0, s48, 54912
    s_nop 0
    buffer_load_dwordx4 v242, s[24:27], s35 offen lds
    s_add_u32 s47, s47, 36864
    s_waitcnt vmcnt(0)
    s_barrier
    s_add_u32 s35, s47, s90
    s_add_u32 m0, s48, 0
    s_nop 0
    buffer_load_dwordx4 v242, s[24:27], s35 offen lds
    s_add_u32 s35, s47, s91
    s_add_u32 m0, s48, 4224
    s_nop 0
    buffer_load_dwordx4 v242, s[24:27], s35 offen lds
    s_add_u32 s35, s47, s92
    s_add_u32 m0, s48, 8448
    s_nop 0
    buffer_load_dwordx4 v242, s[24:27], s35 offen lds
    s_add_u32 s35, s47, s93
    s_add_u32 m0, s48, 12672
    s_nop 0
    buffer_load_dwordx4 v242, s[24:27], s35 offen lds
    s_add_u32 s35, s47, s94
    s_add_u32 m0, s48, 16896
    s_nop 0
    buffer_load_dwordx4 v242, s[24:27], s35 offen lds
    s_add_u32 s35, s47, s95
    s_add_u32 m0, s48, 88704
    s_nop 0
    buffer_load_dwordx4 v242, s[24:27], s35 offen lds
    s_add_u32 s35, s47, s96
    s_add_u32 m0, s48, 92928
    s_nop 0
    buffer_load_dwordx4 v242, s[24:27], s35 offen lds
    s_add_u32 s35, s47, s97
    s_add_u32 m0, s48, 97152
    s_nop 0
    buffer_load_dwordx4 v242, s[24:27], s35 offen lds
    s_add_u32 s35, s47, s98
    s_add_u32 m0, s48, 101376
    s_nop 0
    buffer_load_dwordx4 v242, s[24:27], s35 offen lds
    s_add_u32 s47, s47, 36864
    s_waitcnt vmcnt(0)
    s_barrier
    s_add_u32 s35, s47, s90
    s_add_u32 m0, s48, 21120
    s_nop 0
    buffer_load_dwordx4 v242, s[24:27], s35 offen lds
    s_add_u32 s35, s47, s91
    s_add_u32 m0, s48, 25344
    s_nop 0
    buffer_load_dwordx4 v242, s[24:27], s35 offen lds
    s_add_u32 s35, s47, s92
    s_add_u32 m0, s48, 29568
    s_nop 0
    buffer_load_dwordx4 v242, s[24:27], s35 offen lds
    s_add_u32 s35, s47, s93
    s_add_u32 m0, s48, 33792
    s_nop 0
    buffer_load_dwordx4 v242, s[24:27], s35 offen lds
    s_add_u32 s35, s47, s94
    s_add_u32 m0, s48, 38016
    s_nop 0
    buffer_load_dwordx4 v242, s[24:27], s35 offen lds
    s_add_u32 s35, s47, s95
    s_add_u32 m0, s48, 42240
    s_nop 0
    buffer_load_dwordx4 v242, s[24:27], s35 offen lds
    s_add_u32 s35, s47, s96
    s_add_u32 m0, s48, 46464
    s_nop 0
    buffer_load_dwordx4 v242, s[24:27], s35 offen lds
    s_add_u32 s35, s47, s97
    s_add_u32 m0, s48, 50688
    s_nop 0
    buffer_load_dwordx4 v242, s[24:27], s35 offen lds
    s_add_u32 s35, s47, s98
    s_add_u32 m0, s48, 54912
    s_nop 0
    buffer_load_dwordx4 v242, s[24:27], s35 offen lds
    s_add_u32 s47, s47, 36864
    s_waitcnt vmcnt(0)
    s_barrier
    s_add_u32 s35, s47, s90
    s_add_u32 m0, s48, 0
    s_nop 0
    buffer_load_dwordx4 v242, s[24:27], s35 offen lds
    s_add_u32 s35, s47, s91
    s_add_u32 m0, s48, 4224
    s_nop 0
    buffer_load_dwordx4 v242, s[24:27], s35 offen lds
    s_add_u32 s35, s47, s92
    s_add_u32 m0, s48, 8448
    s_nop 0
    buffer_load_dwordx4 v242, s[24:27], s35 offen lds
    s_add_u32 s35, s47, s93
    s_add_u32 m0, s48, 12672
    s_nop 0
    buffer_load_dwordx4 v242, s[24:27], s35 offen lds
    s_add_u32 s35, s47, s94
    s_add_u32 m0, s48, 16896
    s_nop 0
    buffer_load_dwordx4 v242, s[24:27], s35 offen lds
    s_add_u32 s35, s47, s95
    s_add_u32 m0, s48, 88704
    s_nop 0
    buffer_load_dwordx4 v242, s[24:27], s35 offen lds
    s_add_u32 s35, s47, s96
    s_add_u32 m0, s48, 92928
    s_nop 0
    buffer_load_dwordx4 v242, s[24:27], s35 offen lds
    s_add_u32 s35, s47, s97
    s_add_u32 m0, s48, 97152
    s_nop 0
    buffer_load_dwordx4 v242, s[24:27], s35 offen lds
    s_add_u32 s35, s47, s98
    s_add_u32 m0, s48, 101376
    s_nop 0
    buffer_load_dwordx4 v242, s[24:27], s35 offen lds
    s_add_u32 s47, s47, 36864
    s_waitcnt vmcnt(0)
    s_barrier
    s_add_u32 s35, s47, s90
    s_add_u32 m0, s48, 21120
    s_nop 0
    buffer_load_dwordx4 v242, s[24:27], s35 offen lds
    s_add_u32 s35, s47, s91
    s_add_u32 m0, s48, 25344
    s_nop 0
    buffer_load_dwordx4 v242, s[24:27], s35 offen lds
    s_add_u32 s35, s47, s92
    s_add_u32 m0, s48, 29568
    s_nop 0
    buffer_load_dwordx4 v242, s[24:27], s35 offen lds
    s_add_u32 s35, s47, s93
    s_add_u32 m0, s48, 33792
    s_nop 0
    buffer_load_dwordx4 v242, s[24:27], s35 offen lds
    s_add_u32 s35, s47, s94
    s_add_u32 m0, s48, 38016
    s_nop 0
    buffer_load_dwordx4 v242, s[24:27], s35 offen lds
    s_add_u32 s35, s47, s95
    s_add_u32 m0, s48, 42240
    s_nop 0
    buffer_load_dwordx4 v242, s[24:27], s35 offen lds
    s_add_u32 s35, s47, s96
    s_add_u32 m0, s48, 46464
    s_nop 0
    buffer_load_dwordx4 v242, s[24:27], s35 offen lds
    s_add_u32 s35, s47, s97
    s_add_u32 m0, s48, 50688
    s_nop 0
    buffer_load_dwordx4 v242, s[24:27], s35 offen lds
    s_add_u32 s35, s47, s98
    s_add_u32 m0, s48, 54912
    s_nop 0
    buffer_load_dwordx4 v242, s[24:27], s35 offen lds
    s_add_u32 s47, s47, 36864
    s_waitcnt vmcnt(0)
    s_barrier
    s_add_u32 s35, s47, s90
    s_add_u32 m0, s48, 0
    s_nop 0
    buffer_load_dwordx4 v242, s[24:27], s35 offen lds
    s_add_u32 s35, s47, s91
    s_add_u32 m0, s48, 4224
    s_nop 0
    buffer_load_dwordx4 v242, s[24:27], s35 offen lds
    s_add_u32 s35, s47, s92
    s_add_u32 m0, s48, 8448
    s_nop 0
    buffer_load_dwordx4 v242, s[24:27], s35 offen lds
    s_add_u32 s35, s47, s93
    s_add_u32 m0, s48, 12672
    s_nop 0
    buffer_load_dwordx4 v242, s[24:27], s35 offen lds
    s_add_u32 s35, s47, s94
    s_add_u32 m0, s48, 16896
    s_nop 0
    buffer_load_dwordx4 v242, s[24:27], s35 offen lds
    s_add_u32 s35, s47, s95
    s_add_u32 m0, s48, 88704
    s_nop 0
    buffer_load_dwordx4 v242, s[24:27], s35 offen lds
    s_add_u32 s35, s47, s96
    s_add_u32 m0, s48, 92928
    s_nop 0
    buffer_load_dwordx4 v242, s[24:27], s35 offen lds
    s_add_u32 s35, s47, s97
    s_add_u32 m0, s48, 97152
    s_nop 0
    buffer_load_dwordx4 v242, s[24:27], s35 offen lds
    s_add_u32 s35, s47, s98
    s_add_u32 m0, s48, 101376
    s_nop 0
    buffer_load_dwordx4 v242, s[24:27], s35 offen lds
    s_add_u32 s47, s47, 36864
    s_waitcnt vmcnt(0)
    s_barrier
    s_add_u32 s35, s47, s90
    s_add_u32 m0, s48, 21120
    s_nop 0
    buffer_load_dwordx4 v242, s[24:27], s35 offen lds
    s_add_u32 s35, s47, s91
    s_add_u32 m0, s48, 25344
    s_nop 0
    buffer_load_dwordx4 v242, s[24:27], s35 offen lds
    s_add_u32 s35, s47, s92
    s_add_u32 m0, s48, 29568
    s_nop 0
    buffer_load_dwordx4 v242, s[24:27], s35 offen lds
    s_add_u32 s35, s47, s93
    s_add_u32 m0, s48, 33792
    s_nop 0
    buffer_load_dwordx4 v242, s[24:27], s35 offen lds
    s_add_u32 s35, s47, s94
    s_add_u32 m0, s48, 38016
    s_nop 0
    buffer_load_dwordx4 v242, s[24:27], s35 offen lds
    s_add_u32 s35, s47, s95
    s_add_u32 m0, s48, 42240
    s_nop 0
    buffer_load_dwordx4 v242, s[24:27], s35 offen lds
    s_add_u32 s35, s47, s96
    s_add_u32 m0, s48, 46464
    s_nop 0
    buffer_load_dwordx4 v242, s[24:27], s35 offen lds
    s_add_u32 s35, s47, s97
    s_add_u32 m0, s48, 50688
    s_nop 0
    buffer_load_dwordx4 v242, s[24:27], s35 offen lds
    s_add_u32 s35, s47, s98
    s_add_u32 m0, s48, 54912
    s_nop 0
    buffer_load_dwordx4 v242, s[24:27], s35 offen lds
    s_add_u32 s47, s47, 36864
    s_waitcnt vmcnt(0)
    s_barrier
    s_barrier
    s_endpgm
LA_SAFE:
    s_lshr_b32 s34, s36, 1
    s_mul_i32 s34, s34, 8448
    s_xor_b32 s35, s4, 1
    s_mul_i32 s34, s34, s35
    v_add_u32 v237, s34, v237
    v_add_u32 v251, s34, v251
    s_mov_b32 s32, 0
LS_AR:
    s_nop 7
    v_mov_b32 v0, 0
    v_mov_b32 v1, 0
    v_mov_b32 v2, 0
    v_mov_b32 v3, 0
    v_mov_b32 v4, 0
    v_mov_b32 v5, 0
    v_mov_b32 v6, 0
    v_mov_b32 v7, 0
    v_mov_b32 v8, 0
    v_mov_b32 v9, 0
    v_mov_b32 v10, 0
    v_mov_b32 v11, 0
    v_mov_b32 v12, 0
    v_mov_b32 v13, 0
    v_mov_b32 v14, 0
    v_mov_b32 v15, 0
    v_mov_b32 v16, 0
    v_mov_b32 v17, 0
    v_mov_b32 v18, 0
    v_mov_b32 v19, 0
    v_mov_b32 v20, 0
    v_mov_b32 v21, 0
    v_mov_b32 v22, 0
    v_mov_b32 v23, 0
    v_mov_b32 v24, 0
    v_mov_b32 v25, 0
    v_mov_b32 v26, 0
    v_mov_b32 v27, 0
    v_mov_b32 v28, 0
    v_mov_b32 v29, 0
    v_mov_b32 v30, 0
    v_mov_b32 v31, 0
    v_mov_b32 v32, 0
    v_mov_b32 v33, 0
    v_mov_b32 v34, 0
    v_mov_b32 v35, 0
    v_mov_b32 v36, 0
    v_mov_b32 v37, 0
    v_mov_b32 v38, 0
    v_mov_b32 v39, 0
    v_mov_b32 v40, 0
    v_mov_b32 v41, 0
    v_mov_b32 v42, 0
    v_mov_b32 v43, 0
    v_mov_b32 v44, 0
    v_mov_b32 v45, 0
    v_mov_b32 v46, 0
    v_mov_b32 v47, 0
    v_mov_b32 v48, 0
    v_mov_b32 v49, 0
    v_mov_b32 v50, 0
    v_mov_b32 v51, 0
    v_mov_b32 v52, 0
    v_mov_b32 v53, 0
    v_mov_b32 v54, 0
    v_mov_b32 v55, 0
    v_mov_b32 v56, 0
    v_mov_b32 v57, 0
    v_mov_b32 v58, 0
    v_mov_b32 v59, 0
    v_mov_b32 v60, 0
    v_mov_b32 v61, 0
    v_mov_b32 v62, 0
    v_mov_b32 v63, 0
    v_mov_b32 v64, 0
    v_mov_b32 v65, 0
    v_mov_b32 v66, 0
    v_mov_b32 v67, 0
    v_mov_b32 v68, 0
    v_mov_b32 v69, 0
    v_mov_b32 v70, 0
    v_mov_b32 v71, 0
    v_mov_b32 v72, 0
    v_mov_b32 v73, 0
    v_mov_b32 v74, 0
    v_mov_b32 v75, 0
    v_mov_b32 v76, 0
    v_mov_b32 v77, 0
    v_mov_b32 v78, 0
    v_mov_b32 v79, 0
    v_mov_b32 v80, 0
    v_mov_b32 v81, 0
    v_mov_b32 v82, 0
    v_mov_b32 v83, 0
    v_mov_b32 v84, 0
    v_mov_b32 v85, 0
    v_mov_b32 v86, 0
    v_mov_b32 v87, 0
    v_mov_b32 v88, 0
    v_mov_b32 v89, 0
    v_mov_b32 v90, 0
    v_mov_b32 v91, 0
    v_mov_b32 v92, 0
    v_mov_b32 v93, 0
    v_mov_b32 v94, 0
    v_mov_b32 v95, 0
    s_nop 1
    s_mov_b32 s33, 9
LS_AQ:
    s_barrier
    ds_read_b128 v[180:183], v239 offset:0
    ds_read_b128 v[184:187], v239 offset:4224
    ds_read_b128 v[188:191], v239 offset:8448
    ds_read_b64_tr_b16 v[204:205], v238 offset:0
    ds_read_b64_tr_b16 v[206:207], v238 offset:512
    ds_read_b64_tr_b16 v[208:209], v238 offset:8
    ds_read_b64_tr_b16 v[210:211], v238 offset:520
    ds_read_b64_tr_b16 v[212:213], v238 offset:64
    ds_read_b64_tr_b16 v[214:215], v238 offset:576
    ds_read_b64_tr_b16 v[216:217], v238 offset:72
    ds_read_b64_tr_b16 v[218:219], v238 offset:584
    s_waitcnt lgkmcnt(0)
    v_mfma_f32_16x16x32_bf16 v[0:3], v[204:207], v[180:183], v[0:3]
    v_mfma_f32_16x16x32_bf16 v[4:7], v[204:207], v[184:187], v[4:7]
    v_mfma_f32_16x16x32_bf16 v[8:11], v[204:207], v[188:191], v[8:11]
    v_mfma_f32_16x16x32_bf16 v[12:15], v[208:211], v[180:183], v[12:15]
    v_mfma_f32_16x16x32_bf16 v[16:19], v[208:211], v[184:187], v[16:19]
    v_mfma_f32_16x16x32_bf16 v[20:23], v[208:211], v[188:191], v[20:23]
    v_mfma_f32_16x16x32_bf16 v[24:27], v[212:215], v[180:183], v[24:27]
    v_mfma_f32_16x16x32_bf16 v[28:31], v[212:215], v[184:187], v[28:31]
    v_mfma_f32_16x16x32_bf16 v[32:35], v[212:215], v[188:191], v[32:35]
    v_mfma_f32_16x16x32_bf16 v[36:39], v[216:219], v[180:183], v[36:39]
    v_mfma_f32_16x16x32_bf16 v[40:43], v[216:219], v[184:187], v[40:43]
    v_mfma_f32_16x16x32_bf16 v[44:47], v[216:219], v[188:191], v[44:47]
    ds_read_b64_tr_b16 v[204:205], v238 offset:4224
    ds_read_b64_tr_b16 v[206:207], v238 offset:4736
    ds_read_b64_tr_b16 v[208:209], v238 offset:4232
    ds_read_b64_tr_b16 v[210:211], v238 offset:4744
    ds_read_b64_tr_b16 v[212:213], v238 offset:4288
    ds_read_b64_tr_b16 v[214:215], v238 offset:4800
    ds_read_b64_tr_b16 v[216:217], v238 offset:4296
    ds_read_b64_tr_b16 v[218:219], v238 offset:4808
    s_waitcnt lgkmcnt(0)
    v_mfma_f32_16x16x32_bf16 v[48:51], v[204:207], v[180:183], v[48:51]
    v_mfma_f32_16x16x32_bf16 v[52:55], v[204:207], v[184:187], v[52:55]
    v_mfma_f32_16x16x32_bf16 v[56:59], v[204:207], v[188:191], v[56:59]
    v_mfma_f32_16x16x32_bf16 v[60:63], v[208:211], v[180:183], v[60:63]
    v_mfma_f32_16x16x32_bf16 v[64:67], v[208:211], v[184:187], v[64:67]
    v_mfma_f32_16x16x32_bf16 v[68:71], v[208:211], v[188:191], v[68:71]
    v_mfma_f32_16x16x32_bf16 v[72:75], v[212:215], v[180:183], v[72:75]
    v_mfma_f32_16x16x32_bf16 v[76:79], v[212:215], v[184:187], v[76:79]
    v_mfma_f32_16x16x32_bf16 v[80:83], v[212:215], v[188:191], v[80:83]
    v_mfma_f32_16x16x32_bf16 v[84:87], v[216:219], v[180:183], v[84:87]
    v_mfma_f32_16x16x32_bf16 v[88:91], v[216:219], v[184:187], v[88:91]
    v_mfma_f32_16x16x32_bf16 v[92:95], v[216:219], v[188:191], v[92:95]
    ds_read_b128 v[192:195], v239 offset:64
    ds_read_b128 v[196:199], v239 offset:4288
    ds_read_b128 v[200:203], v239 offset:8512
    ds_read_b64_tr_b16 v[204:205], v238 offset:16896
    ds_read_b64_tr_b16 v[206:207], v238 offset:17408
    ds_read_b64_tr_b16 v[208:209], v238 offset:16904
    ds_read_b64_tr_b16 v[210:211], v238 offset:17416
    ds_read_b64_tr_b16 v[212:213], v238 offset:16960
    ds_read_b64_tr_b16 v[214:215], v238 offset:17472
    ds_read_b64_tr_b16 v[216:217], v238 offset:16968
    ds_read_b64_tr_b16 v[218:219], v238 offset:17480
    s_waitcnt lgkmcnt(0)
    v_mfma_f32_16x16x32_bf16 v[0:3], v[204:207], v[192:195], v[0:3]
    v_mfma_f32_16x16x32_bf16 v[4:7], v[204:207], v[196:199], v[4:7]
    v_mfma_f32_16x16x32_bf16 v[8:11], v[204:207], v[200:203], v[8:11]
    v_mfma_f32_16x16x32_bf16 v[12:15], v[208:211], v[192:195], v[12:15]
    v_mfma_f32_16x16x32_bf16 v[16:19], v[208:211], v[196:199], v[16:19]
    v_mfma_f32_16x16x32_bf16 v[20:23], v[208:211], v[200:203], v[20:23]
    v_mfma_f32_16x16x32_bf16 v[24:27], v[212:215], v[192:195], v[24:27]
    v_mfma_f32_16x16x32_bf16 v[28:31], v[212:215], v[196:199], v[28:31]
    v_mfma_f32_16x16x32_bf16 v[32:35], v[212:215], v[200:203], v[32:35]
    v_mfma_f32_16x16x32_bf16 v[36:39], v[216:219], v[192:195], v[36:39]
    v_mfma_f32_16x16x32_bf16 v[40:43], v[216:219], v[196:199], v[40:43]
    v_mfma_f32_16x16x32_bf16 v[44:47], v[216:219], v[200:203], v[44:47]
    ds_read_b64_tr_b16 v[204:205], v238 offset:21120
    ds_read_b64_tr_b16 v[206:207], v238 offset:21632
    ds_read_b64_tr_b16 v[208:209], v238 offset:21128
    ds_read_b64_tr_b16 v[210:211], v238 offset:21640
    ds_read_b64_tr_b16 v[212:213], v238 offset:21184
    ds_read_b64_tr_b16 v[214:215], v238 offset:21696
    ds_read_b64_tr_b16 v[216:217], v238 offset:21192
    ds_read_b64_tr_b16 v[218:219], v238 offset:21704
    s_waitcnt lgkmcnt(0)
    v_mfma_f32_16x16x32_bf16 v[48:51], v[204:207], v[192:195], v[48:51]
    v_mfma_f32_16x16x32_bf16 v[52:55], v[204:207], v[196:199], v[52:55]
    v_mfma_f32_16x16x32_bf16 v[56:59], v[204:207], v[200:203], v[56:59]
    v_mfma_f32_16x16x32_bf16 v[60:63], v[208:211], v[192:195], v[60:63]
    v_mfma_f32_16x16x32_bf16 v[64:67], v[208:211], v[196:199], v[64:67]
    v_mfma_f32_16x16x32_bf16 v[68:71], v[208:211], v[200:203], v[68:71]
    v_mfma_f32_16x16x32_bf16 v[72:75], v[212:215], v[192:195], v[72:75]
    v_mfma_f32_16x16x32_bf16 v[76:79], v[212:215], v[196:199], v[76:79]
    v_mfma_f32_16x16x32_bf16 v[80:83], v[212:215], v[200:203], v[80:83]
    v_mfma_f32_16x16x32_bf16 v[84:87], v[216:219], v[192:195], v[84:87]
    v_mfma_f32_16x16x32_bf16 v[88:91], v[216:219], v[196:199], v[88:91]
    v_mfma_f32_16x16x32_bf16 v[92:95], v[216:219], v[200:203], v[92:95]
    s_barrier
    s_sub_u32 s33, s33, 1
    s_cmp_lg_u32 s33, 0
    s_cbranch_scc1 LS_AQ
    s_nop 7
    v_pk_mul_f32 v[0:1], v[0:1], s[38:39]
    v_pk_mul_f32 v[2:3], v[2:3], s[38:39]
    v_pk_mul_f32 v[12:13], v[12:13], s[38:39]
    v_pk_mul_f32 v[14:15], v[14:15], s[38:39]
    v_pk_mul_f32 v[4:5], v[4:5], s[38:39]
    v_pk_mul_f32 v[6:7], v[6:7], s[38:39]
    v_pk_mul_f32 v[16:17], v[16:17], s[38:39]
    v_pk_mul_f32 v[18:19], v[18:19], s[38:39]
    v_pk_mul_f32 v[8:9], v[8:9], s[38:39]
    v_pk_mul_f32 v[10:11], v[10:11], s[38:39]
    v_pk_mul_f32 v[20:21], v[20:21], s[38:39]
    v_pk_mul_f32 v[22:23], v[22:23], s[38:39]
    v_cvt_pk_bf16_f32 v96, v0, v1
    v_cvt_pk_bf16_f32 v97, v2, v3
    v_cvt_pk_bf16_f32 v98, v12, v13
    v_cvt_pk_bf16_f32 v99, v14, v15
    v_cvt_pk_bf16_f32 v100, v4, v5
    v_cvt_pk_bf16_f32 v101, v6, v7
    v_cvt_pk_bf16_f32 v102, v16, v17
    v_cvt_pk_bf16_f32 v103, v18, v19
    v_cvt_pk_bf16_f32 v104, v8, v9
    v_cvt_pk_bf16_f32 v105, v10, v11
    v_cvt_pk_bf16_f32 v106, v20, v21
    v_cvt_pk_bf16_f32 v107, v22, v23
    v_pk_mul_f32 v[24:25], v[24:25], s[38:39]
    v_pk_mul_f32 v[26:27], v[26:27], s[38:39]
    v_pk_mul_f32 v[36:37], v[36:37], s[38:39]
    v_pk_mul_f32 v[38:39], v[38:39], s[38:39]
    v_pk_mul_f32 v[28:29], v[28:29], s[38:39]
    v_pk_mul_f32 v[30:31], v[30:31], s[38:39]
    v_pk_mul_f32 v[40:41], v[40:41], s[38:39]
    v_pk_mul_f32 v[42:43], v[42:43], s[38:39]
    v_pk_mul_f32 v[32:33], v[32:33], s[38:39]
    v_pk_mul_f32 v[34:35], v[34:35], s[38:39]
    v_pk_mul_f32 v[44:45], v[44:45], s[38:39]
    v_pk_mul_f32 v[46:47], v[46:47], s[38:39]
    v_cvt_pk_bf16_f32 v108, v24, v25
    v_cvt_pk_bf16_f32 v109, v26, v27
    v_cvt_pk_bf16_f32 v110, v36, v37
    v_cvt_pk_bf16_f32 v111, v38, v39
    v_cvt_pk_bf16_f32 v112, v28, v29
    v_cvt_pk_bf16_f32 v113, v30, v31
    v_cvt_pk_bf16_f32 v114, v40, v41
    v_cvt_pk_bf16_f32 v115, v42, v43
    v_cvt_pk_bf16_f32 v116, v32, v33
    v_cvt_pk_bf16_f32 v117, v34, v35
    v_cvt_pk_bf16_f32 v118, v44, v45
    v_cvt_pk_bf16_f32 v119, v46, v47
    v_pk_mul_f32 v[48:49], v[48:49], s[38:39]
    v_pk_mul_f32 v[50:51], v[50:51], s[38:39]
    v_pk_mul_f32 v[60:61], v[60:61], s[38:39]
    v_pk_mul_f32 v[62:63], v[62:63], s[38:39]
    v_pk_mul_f32 v[52:53], v[52:53], s[38:39]
    v_pk_mul_f32 v[54:55], v[54:55], s[38:39]
    v_pk_mul_f32 v[64:65], v[64:65], s[38:39]
    v_pk_mul_f32 v[66:67], v[66:67], s[38:39]
    v_pk_mul_f32 v[56:57], v[56:57], s[38:39]
    v_pk_mul_f32 v[58:59], v[58:59], s[38:39]
    v_pk_mul_f32 v[68:69], v[68:69], s[38:39]
    v_pk_mul_f32 v[70:71], v[70:71], s[38:39]
    v_cvt_pk_bf16_f32 v120, v48, v49
    v_cvt_pk_bf16_f32 v121, v50, v51
    v_cvt_pk_bf16_f32 v122, v60, v61
    v_cvt_pk_bf16_f32 v123, v62, v63
    v_cvt_pk_bf16_f32 v124, v52, v53
    v_cvt_pk_bf16_f32 v125, v54, v55
    v_cvt_pk_bf16_f32 v126, v64, v65
    v_cvt_pk_bf16_f32 v127, v66, v67
    v_cvt_pk_bf16_f32 v128, v56, v57
    v_cvt_pk_bf16_f32 v129, v58, v59
    v_cvt_pk_bf16_f32 v130, v68, v69
    v_cvt_pk_bf16_f32 v131, v70, v71
    v_pk_mul_f32 v[72:73], v[72:73], s[38:39]
    v_pk_mul_f32 v[74:75], v[74:75], s[38:39]
    v_pk_mul_f32 v[84:85], v[84:85], s[38:39]
    v_pk_mul_f32 v[86:87], v[86:87], s[38:39]
    v_pk_mul_f32 v[76:77], v[76:77], s[38:39]
    v_pk_mul_f32 v[78:79], v[78:79], s[38:39]
    v_pk_mul_f32 v[88:89], v[88:89], s[38:39]
    v_pk_mul_f32 v[90:91], v[90:91], s[38:39]
    v_pk_mul_f32 v[80:81], v[80:81], s[38:39]
    v_pk_mul_f32 v[82:83], v[82:83], s[38:39]
    v_pk_mul_f32 v[92:93], v[92:93], s[38:39]
    v_pk_mul_f32 v[94:95], v[94:95], s[38:39]
    v_cvt_pk_bf16_f32 v132, v72, v73
    v_cvt_pk_bf16_f32 v133, v74, v75
    v_cvt_pk_bf16_f32 v134, v84, v85
    v_cvt_pk_bf16_f32 v135, v86, v87
    v_cvt_pk_bf16_f32 v136, v76, v77
    v_cvt_pk_bf16_f32 v137, v78, v79
    v_cvt_pk_bf16_f32 v138, v88, v89
    v_cvt_pk_bf16_f32 v139, v90, v91
    v_cvt_pk_bf16_f32 v140, v80, v81
    v_cvt_pk_bf16_f32 v141, v82, v83
    v_cvt_pk_bf16_f32 v142, v92, v93
    v_cvt_pk_bf16_f32 v143, v94, v95
    v_mov_b32 v242, 0xff800000
    v_mov_b32 v243, 0xff800000
    v_mov_b32 v244, 0xff800000
    s_mov_b32 s33, 16
LS_AM:
    s_barrier
    ds_read_b128 v[204:207], v237 offset:0
    ds_read_b128 v[208:211], v237 offset:64
    ds_read_b128 v[212:215], v237 offset:4224
    ds_read_b128 v[216:219], v237 offset:4288
    s_waitcnt lgkmcnt(0)
    v_mfma_f32_16x16x32_bf16 v[144:147], v[204:207], v[96:99], 0
    v_mfma_f32_16x16x32_bf16 v[148:151], v[204:207], v[100:103], 0
    v_mfma_f32_16x16x32_bf16 v[152:155], v[204:207], v[104:107], 0
    v_mfma_f32_16x16x32_bf16 v[144:147], v[208:211], v[108:111], v[144:147]
    v_mfma_f32_16x16x32_bf16 v[148:151], v[208:211], v[112:115], v[148:151]
    v_mfma_f32_16x16x32_bf16 v[152:155], v[208:211], v[116:119], v[152:155]
    v_mfma_f32_16x16x32_bf16 v[144:147], v[212:215], v[120:123], v[144:147]
    v_mfma_f32_16x16x32_bf16 v[148:151], v[212:215], v[124:127], v[148:151]
    v_mfma_f32_16x16x32_bf16 v[152:155], v[212:215], v[128:131], v[152:155]
    v_mfma_f32_16x16x32_bf16 v[144:147], v[216:219], v[132:135], v[144:147]
    v_mfma_f32_16x16x32_bf16 v[148:151], v[216:219], v[136:139], v[148:151]
    v_mfma_f32_16x16x32_bf16 v[152:155], v[216:219], v[140:143], v[152:155]
    ds_read_b128 v[204:207], v237 offset:512
    ds_read_b128 v[208:211], v237 offset:576
    ds_read_b128 v[212:215], v237 offset:4736
    ds_read_b128 v[216:219], v237 offset:4800
    s_waitcnt lgkmcnt(0)
    v_mfma_f32_16x16x32_bf16 v[156:159], v[204:207], v[96:99], 0
    v_mfma_f32_16x16x32_bf16 v[160:163], v[204:207], v[100:103], 0
    v_mfma_f32_16x16x32_bf16 v[164:167], v[204:207], v[104:107], 0
    v_mfma_f32_16x16x32_bf16 v[156:159], v[208:211], v[108:111], v[156:159]
    v_mfma_f32_16x16x32_bf16 v[160:163], v[208:211], v[112:115], v[160:163]
    v_mfma_f32_16x16x32_bf16 v[164:167], v[208:211], v[116:119], v[164:167]
    v_mfma_f32_16x16x32_bf16 v[156:159], v[212:215], v[120:123], v[156:159]
    v_mfma_f32_16x16x32_bf16 v[160:163], v[212:215], v[124:127], v[160:163]
    v_mfma_f32_16x16x32_bf16 v[164:167], v[212:215], v[128:131], v[164:167]
    v_mfma_f32_16x16x32_bf16 v[156:159], v[216:219], v[132:135], v[156:159]
    v_mfma_f32_16x16x32_bf16 v[160:163], v[216:219], v[136:139], v[160:163]
    v_mfma_f32_16x16x32_bf16 v[164:167], v[216:219], v[140:143], v[164:167]
    s_nop 7
    v_max3_f32 v242, v242, v144, v145
    v_max_f32 v242, v242, v146
    v_max3_f32 v243, v243, v148, v149
    v_max_f32 v243, v243, v150
    v_max3_f32 v244, v244, v152, v153
    v_max_f32 v244, v244, v154
    v_max3_f32 v242, v242, v147, v156
    v_max3_f32 v243, v243, v151, v160
    v_max3_f32 v244, v244, v155, v164
    v_max3_f32 v242, v242, v157, v158
    v_max3_f32 v243, v243, v161, v162
    v_max3_f32 v244, v244, v165, v166
    v_max_f32 v242, v242, v159
    v_max_f32 v243, v243, v163
    v_max_f32 v244, v244, v167
    s_barrier
    s_sub_u32 s33, s33, 1
    s_cmp_lg_u32 s33, 0
    s_cbranch_scc1 LS_AM
    v_mov_b32 v245, v242
    v_mov_b32 v246, v243
    v_mov_b32 v247, v244
    s_nop 0
    v_permlane32_swap_b32 v242, v245
    v_permlane32_swap_b32 v243, v246
    v_permlane32_swap_b32 v244, v247
    v_max_f32 v242, v242, v245
    v_max_f32 v243, v243, v246
    v_max_f32 v244, v244, v247
    v_mov_b32 v245, v242
    v_mov_b32 v246, v243
    v_mov_b32 v247, v244
    s_nop 0
    v_permlane16_swap_b32 v242, v245
    v_permlane16_swap_b32 v243, v246
    v_permlane16_swap_b32 v244, v247
    v_max_f32 v242, v242, v245
    v_max_f32 v243, v243, v246
    v_max_f32 v244, v244, v247
    v_xor_b32 v168, 0x80000000, v242
    v_mov_b32 v232, 0
    v_xor_b32 v172, 0x80000000, v243
    v_mov_b32 v233, 0
    v_xor_b32 v176, 0x80000000, v244
    v_mov_b32 v234, 0
    v_mov_b32 v169, v168
    v_mov_b32 v170, v168
    v_mov_b32 v171, v168
    v_mov_b32 v173, v172
    v_mov_b32 v174, v172
    v_mov_b32 v175, v172
    v_mov_b32 v177, v176
    v_mov_b32 v178, v176
    v_mov_b32 v179, v176
    s_nop 7
    v_mov_b32 v0, 0
    v_mov_b32 v1, 0
    v_mov_b32 v2, 0
    v_mov_b32 v3, 0
    v_mov_b32 v4, 0
    v_mov_b32 v5, 0
    v_mov_b32 v6, 0
    v_mov_b32 v7, 0
    v_mov_b32 v8, 0
    v_mov_b32 v9, 0
    v_mov_b32 v10, 0
    v_mov_b32 v11, 0
    v_mov_b32 v12, 0
    v_mov_b32 v13, 0
    v_mov_b32 v14, 0
    v_mov_b32 v15, 0
    v_mov_b32 v16, 0
    v_mov_b32 v17, 0
    v_mov_b32 v18, 0
    v_mov_b32 v19, 0
    v_mov_b32 v20, 0
    v_mov_b32 v21, 0
    v_mov_b32 v22, 0
    v_mov_b32 v23, 0
    v_mov_b32 v24, 0
    v_mov_b32 v25, 0
    v_mov_b32 v26, 0
    v_mov_b32 v27, 0
    v_mov_b32 v28, 0
    v_mov_b32 v29, 0
    v_mov_b32 v30, 0
    v_mov_b32 v31, 0
    v_mov_b32 v32, 0
    v_mov_b32 v33, 0
    v_mov_b32 v34, 0
    v_mov_b32 v35, 0
    v_mov_b32 v36, 0
    v_mov_b32 v37, 0
    v_mov_b32 v38, 0
    v_mov_b32 v39, 0
    v_mov_b32 v40, 0
    v_mov_b32 v41, 0
    v_mov_b32 v42, 0
    v_mov_b32 v43, 0
    v_mov_b32 v44, 0
    v_mov_b32 v45, 0
    v_mov_b32 v46, 0
    v_mov_b32 v47, 0
    v_mov_b32 v48, 0
    v_mov_b32 v49, 0
    v_mov_b32 v50, 0
    v_mov_b32 v51, 0
    v_mov_b32 v52, 0
    v_mov_b32 v53, 0
    v_mov_b32 v54, 0
    v_mov_b32 v55, 0
    v_mov_b32 v56, 0
    v_mov_b32 v57, 0
    v_mov_b32 v58, 0
    v_mov_b32 v59, 0
    v_mov_b32 v60, 0
    v_mov_b32 v61, 0
    v_mov_b32 v62, 0
    v_mov_b32 v63, 0
    v_mov_b32 v64, 0
    v_mov_b32 v65, 0
    v_mov_b32 v66, 0
    v_mov_b32 v67, 0
    v_mov_b32 v68, 0
    v_mov_b32 v69, 0
    v_mov_b32 v70, 0
    v_mov_b32 v71, 0
    v_mov_b32 v72, 0
    v_mov_b32 v73, 0
    v_mov_b32 v74, 0
    v_mov_b32 v75, 0
    v_mov_b32 v76, 0
    v_mov_b32 v77, 0
    v_mov_b32 v78, 0
    v_mov_b32 v79, 0
    v_mov_b32 v80, 0
    v_mov_b32 v81, 0
    v_mov_b32 v82, 0
    v_mov_b32 v83, 0
    v_mov_b32 v84, 0
    v_mov_b32 v85, 0
    v_mov_b32 v86, 0
    v_mov_b32 v87, 0
    v_mov_b32 v88, 0
    v_mov_b32 v89, 0
    v_mov_b32 v90, 0
    v_mov_b32 v91, 0
    v_mov_b32 v92, 0
    v_mov_b32 v93, 0
    v_mov_b32 v94, 0
    v_mov_b32 v95, 0
    s_nop 1
    s_mov_b32 s33, 16
LS_AA:
    s_barrier
    ds_read_b128 v[204:207], v237 offset:0
    ds_read_b128 v[208:211], v237 offset:64
    ds_read_b128 v[212:215], v237 offset:4224
    ds_read_b128 v[216:219], v237 offset:4288
    s_waitcnt lgkmcnt(0)
    v_mfma_f32_16x16x32_bf16 v[144:147], v[204:207], v[96:99], v[168:171]
    v_mfma_f32_16x16x32_bf16 v[148:151], v[204:207], v[100:103], v[172:175]
    v_mfma_f32_16x16x32_bf16 v[152:155], v[204:207], v[104:107], v[176:179]
    v_mfma_f32_16x16x32_bf16 v[144:147], v[208:211], v[108:111], v[144:147]
    v_mfma_f32_16x16x32_bf16 v[148:151], v[208:211], v[112:115], v[148:151]
    v_mfma_f32_16x16x32_bf16 v[152:155], v[208:211], v[116:119], v[152:155]
    v_mfma_f32_16x16x32_bf16 v[144:147], v[212:215], v[120:123], v[144:147]
    v_mfma_f32_16x16x32_bf16 v[148:151], v[212:215], v[124:127], v[148:151]
    v_mfma_f32_16x16x32_bf16 v[152:155], v[212:215], v[128:131], v[152:155]
    v_mfma_f32_16x16x32_bf16 v[144:147], v[216:219], v[132:135], v[144:147]
    v_mfma_f32_16x16x32_bf16 v[148:151], v[216:219], v[136:139], v[148:151]
    v_mfma_f32_16x16x32_bf16 v[152:155], v[216:219], v[140:143], v[152:155]
    ds_read_b128 v[204:207], v237 offset:512
    ds_read_b128 v[208:211], v237 offset:576
    ds_read_b128 v[212:215], v237 offset:4736
    ds_read_b128 v[216:219], v237 offset:4800
    s_waitcnt lgkmcnt(0)
    v_mfma_f32_16x16x32_bf16 v[156:159], v[204:207], v[96:99], v[168:171]
    v_mfma_f32_16x16x32_bf16 v[160:163], v[204:207], v[100:103], v[172:175]
    v_mfma_f32_16x16x32_bf16 v[164:167], v[204:207], v[104:107], v[176:179]
    v_mfma_f32_16x16x32_bf16 v[156:159], v[208:211], v[108:111], v[156:159]
    v_mfma_f32_16x16x32_bf16 v[160:163], v[208:211], v[112:115], v[160:163]
    v_mfma_f32_16x16x32_bf16 v[164:167], v[208:211], v[116:119], v[164:167]
    v_mfma_f32_16x16x32_bf16 v[156:159], v[212:215], v[120:123], v[156:159]
    v_mfma_f32_16x16x32_bf16 v[160:163], v[212:215], v[124:127], v[160:163]
    v_mfma_f32_16x16x32_bf16 v[164:167], v[212:215], v[128:131], v[164:167]
    v_mfma_f32_16x16x32_bf16 v[156:159], v[216:219], v[132:135], v[156:159]
    v_mfma_f32_16x16x32_bf16 v[160:163], v[216:219], v[136:139], v[160:163]
    v_mfma_f32_16x16x32_bf16 v[164:167], v[216:219], v[140:143], v[164:167]
    s_nop 7
    v_exp_f32 v220, v144
    v_exp_f32 v221, v145
    v_exp_f32 v222, v146
    v_exp_f32 v223, v147
    v_exp_f32 v224, v148
    v_exp_f32 v225, v149
    v_exp_f32 v226, v150
    v_exp_f32 v227, v151
    v_exp_f32 v228, v152
    v_add_f32 v232, v232, v220
    v_exp_f32 v229, v153
    v_add_f32 v232, v232, v221
    v_cvt_pk_bf16_f32 v180, v220, v221
    v_exp_f32 v230, v154
    v_add_f32 v232, v232, v222
    v_exp_f32 v231, v155
    v_add_f32 v232, v232, v223
    v_cvt_pk_bf16_f32 v181, v222, v223
    v_add_f32 v233, v233, v224
    v_add_f32 v233, v233, v225
    v_cvt_pk_bf16_f32 v184, v224, v225
    v_add_f32 v233, v233, v226
    v_add_f32 v233, v233, v227
    v_cvt_pk_bf16_f32 v185, v226, v227
    v_add_f32 v234, v234, v228
    v_add_f32 v234, v234, v229
    v_cvt_pk_bf16_f32 v188, v228, v229
    v_add_f32 v234, v234, v230
    v_add_f32 v234, v234, v231
    v_cvt_pk_bf16_f32 v189, v230, v231
    v_exp_f32 v220, v156
    v_exp_f32 v221, v157
    v_exp_f32 v222, v158
    v_exp_f32 v223, v159
    v_exp_f32 v224, v160
    v_exp_f32 v225, v161
    v_exp_f32 v226, v162
    v_exp_f32 v227, v163
    v_exp_f32 v228, v164
    v_add_f32 v232, v232, v220
    v_exp_f32 v229, v165
    v_add_f32 v232, v232, v221
    v_cvt_pk_bf16_f32 v182, v220, v221
    v_exp_f32 v230, v166
    v_add_f32 v232, v232, v222
    v_exp_f32 v231, v167
    v_add_f32 v232, v232, v223
    v_cvt_pk_bf16_f32 v183, v222, v223
    v_add_f32 v233, v233, v224
    v_add_f32 v233, v233, v225
    v_cvt_pk_bf16_f32 v186, v224, v225
    v_add_f32 v233, v233, v226
    v_add_f32 v233, v233, v227
    v_cvt_pk_bf16_f32 v187, v226, v227
    v_add_f32 v234, v234, v228
    v_add_f32 v234, v234, v229
    v_cvt_pk_bf16_f32 v190, v228, v229
    v_add_f32 v234, v234, v230
    v_add_f32 v234, v234, v231
    v_cvt_pk_bf16_f32 v191, v230, v231
    s_nop 1
    ds_read_b64_tr_b16 v[204:205], v251 offset:16896
    ds_read_b64_tr_b16 v[206:207], v251 offset:17408
    ds_read_b64_tr_b16 v[208:209], v251 offset:16928
    ds_read_b64_tr_b16 v[210:211], v251 offset:17440
    ds_read_b64_tr_b16 v[212:213], v251 offset:16960
    ds_read_b64_tr_b16 v[214:215], v251 offset:17472
    ds_read_b64_tr_b16 v[216:217], v251 offset:16992
    ds_read_b64_tr_b16 v[218:219], v251 offset:17504
    s_waitcnt lgkmcnt(0)
    v_mfma_f32_16x16x32_bf16 v[0:3], v[204:207], v[180:183], v[0:3]
    v_mfma_f32_16x16x32_bf16 v[4:7], v[204:207], v[184:187], v[4:7]
    v_mfma_f32_16x16x32_bf16 v[8:11], v[204:207], v[188:191], v[8:11]
    v_mfma_f32_16x16x32_bf16 v[12:15], v[208:211], v[180:183], v[12:15]
    v_mfma_f32_16x16x32_bf16 v[16:19], v[208:211], v[184:187], v[16:19]
    v_mfma_f32_16x16x32_bf16 v[20:23], v[208:211], v[188:191], v[20:23]
    v_mfma_f32_16x16x32_bf16 v[24:27], v[212:215], v[180:183], v[24:27]
    v_mfma_f32_16x16x32_bf16 v[28:31], v[212:215], v[184:187], v[28:31]
    v_mfma_f32_16x16x32_bf16 v[32:35], v[212:215], v[188:191], v[32:35]
    v_mfma_f32_16x16x32_bf16 v[36:39], v[216:219], v[180:183], v[36:39]
    v_mfma_f32_16x16x32_bf16 v[40:43], v[216:219], v[184:187], v[40:43]
    v_mfma_f32_16x16x32_bf16 v[44:47], v[216:219], v[188:191], v[44:47]
    ds_read_b64_tr_b16 v[204:205], v251 offset:21120
    ds_read_b64_tr_b16 v[206:207], v251 offset:21632
    ds_read_b64_tr_b16 v[208:209], v251 offset:21152
    ds_read_b64_tr_b16 v[210:211], v251 offset:21664
    ds_read_b64_tr_b16 v[212:213], v251 offset:21184
    ds_read_b64_tr_b16 v[214:215], v251 offset:21696
    ds_read_b64_tr_b16 v[216:217], v251 offset:21216
    ds_read_b64_tr_b16 v[218:219], v251 offset:21728
    s_waitcnt lgkmcnt(0)
    v_mfma_f32_16x16x32_bf16 v[48:51], v[204:207], v[180:183], v[48:51]
    v_mfma_f32_16x16x32_bf16 v[52:55], v[204:207], v[184:187], v[52:55]
    v_mfma_f32_16x16x32_bf16 v[56:59], v[204:207], v[188:191], v[56:59]
    v_mfma_f32_16x16x32_bf16 v[60:63], v[208:211], v[180:183], v[60:63]
    v_mfma_f32_16x16x32_bf16 v[64:67], v[208:211], v[184:187], v[64:67]
    v_mfma_f32_16x16x32_bf16 v[68:71], v[208:211], v[188:191], v[68:71]
    v_mfma_f32_16x16x32_bf16 v[72:75], v[212:215], v[180:183], v[72:75]
    v_mfma_f32_16x16x32_bf16 v[76:79], v[212:215], v[184:187], v[76:79]
    v_mfma_f32_16x16x32_bf16 v[80:83], v[212:215], v[188:191], v[80:83]
    v_mfma_f32_16x16x32_bf16 v[84:87], v[216:219], v[180:183], v[84:87]
    v_mfma_f32_16x16x32_bf16 v[88:91], v[216:219], v[184:187], v[88:91]
    v_mfma_f32_16x16x32_bf16 v[92:95], v[216:219], v[188:191], v[92:95]
    s_barrier
    s_sub_u32 s33, s33, 1
    s_cmp_lg_u32 s33, 0
    s_cbranch_scc1 LS_AA
    v_mov_b32 v245, v232
    v_mov_b32 v246, v233
    v_mov_b32 v247, v234
    s_nop 0
    v_permlane32_swap_b32 v232, v245
    v_permlane32_swap_b32 v233, v246
    v_permlane32_swap_b32 v234, v247
    v_add_f32 v232, v232, v245
    v_add_f32 v233, v233, v246
    v_add_f32 v234, v234, v247
    v_mov_b32 v245, v232
    v_mov_b32 v246, v233
    v_mov_b32 v247, v234
    s_nop 0
    v_permlane16_swap_b32 v232, v245
    v_permlane16_swap_b32 v233, v246
    v_permlane16_swap_b32 v234, v247
    v_add_f32 v232, v232, v245
    v_add_f32 v233, v233, v246
    v_add_f32 v234, v234, v247
    v_rcp_f32 v242, v232
    s_nop 0
    v_rcp_f32 v244, v233
    s_nop 0
    v_rcp_f32 v246, v234
    s_nop 0
    s_nop 7
    v_pk_mul_f32 v[0:1], v[0:1], v[242:243] op_sel_hi:[1,0]
    v_pk_mul_f32 v[2:3], v[2:3], v[242:243] op_sel_hi:[1,0]
    v_cvt_pk_bf16_f32 v0, v0, v1
    v_cvt_pk_bf16_f32 v1, v2, v3
    v_pk_mul_f32 v[12:13], v[12:13], v[242:243] op_sel_hi:[1,0]
    v_pk_mul_f32 v[14:15], v[14:15], v[242:243] op_sel_hi:[1,0]
    v_cvt_pk_bf16_f32 v2, v12, v13
    v_cvt_pk_bf16_f32 v3, v14, v15
    ds_write_b128 v240, v[0:3] offset:0
    v_pk_mul_f32 v[4:5], v[4:5], v[244:245] op_sel_hi:[1,0]
    v_pk_mul_f32 v[6:7], v[6:7], v[244:245] op_sel_hi:[1,0]
    v_cvt_pk_bf16_f32 v4, v4, v5
    v_cvt_pk_bf16_f32 v5, v6, v7
    v_pk_mul_f32 v[16:17], v[16:17], v[244:245] op_sel_hi:[1,0]
    v_pk_mul_f32 v[18:19], v[18:19], v[244:245] op_sel_hi:[1,0]
    v_cvt_pk_bf16_f32 v6, v16, v17
    v_cvt_pk_bf16_f32 v7, v18, v19
    ds_write_b128 v240, v[4:7] offset:2048
    v_pk_mul_f32 v[8:9], v[8:9], v[246:247] op_sel_hi:[1,0]
    v_pk_mul_f32 v[10:11], v[10:11], v[246:247] op_sel_hi:[1,0]
    v_cvt_pk_bf16_f32 v8, v8, v9
    v_cvt_pk_bf16_f32 v9, v10, v11
    v_pk_mul_f32 v[20:21], v[20:21], v[246:247] op_sel_hi:[1,0]
    v_pk_mul_f32 v[22:23], v[22:23], v[246:247] op_sel_hi:[1,0]
    v_cvt_pk_bf16_f32 v10, v20, v21
    v_cvt_pk_bf16_f32 v11, v22, v23
    ds_write_b128 v240, v[8:11] offset:4096
    v_pk_mul_f32 v[24:25], v[24:25], v[242:243] op_sel_hi:[1,0]
    v_pk_mul_f32 v[26:27], v[26:27], v[242:243] op_sel_hi:[1,0]
    v_cvt_pk_bf16_f32 v24, v24, v25
    v_cvt_pk_bf16_f32 v25, v26, v27
    v_pk_mul_f32 v[36:37], v[36:37], v[242:243] op_sel_hi:[1,0]
    v_pk_mul_f32 v[38:39], v[38:39], v[242:243] op_sel_hi:[1,0]
    v_cvt_pk_bf16_f32 v26, v36, v37
    v_cvt_pk_bf16_f32 v27, v38, v39
    ds_write_b128 v240, v[24:27] offset:6144
    v_pk_mul_f32 v[28:29], v[28:29], v[244:245] op_sel_hi:[1,0]
    v_pk_mul_f32 v[30:31], v[30:31], v[244:245] op_sel_hi:[1,0]
    v_cvt_pk_bf16_f32 v28, v28, v29
    v_cvt_pk_bf16_f32 v29, v30, v31
    v_pk_mul_f32 v[40:41], v[40:41], v[244:245] op_sel_hi:[1,0]
    v_pk_mul_f32 v[42:43], v[42:43], v[244:245] op_sel_hi:[1,0]
    v_cvt_pk_bf16_f32 v30, v40, v41
    v_cvt_pk_bf16_f32 v31, v42, v43
    ds_write_b128 v240, v[28:31] offset:8192
    v_pk_mul_f32 v[32:33], v[32:33], v[246:247] op_sel_hi:[1,0]
    v_pk_mul_f32 v[34:35], v[34:35], v[246:247] op_sel_hi:[1,0]
    v_cvt_pk_bf16_f32 v32, v32, v33
    v_cvt_pk_bf16_f32 v33, v34, v35
    v_pk_mul_f32 v[44:45], v[44:45], v[246:247] op_sel_hi:[1,0]
    v_pk_mul_f32 v[46:47], v[46:47], v[246:247] op_sel_hi:[1,0]
    v_cvt_pk_bf16_f32 v34, v44, v45
    v_cvt_pk_bf16_f32 v35, v46, v47
    ds_write_b128 v240, v[32:35] offset:10240
    v_pk_mul_f32 v[48:49], v[48:49], v[242:243] op_sel_hi:[1,0]
    v_pk_mul_f32 v[50:51], v[50:51], v[242:243] op_sel_hi:[1,0]
    v_cvt_pk_bf16_f32 v48, v48, v49
    v_cvt_pk_bf16_f32 v49, v50, v51
    v_pk_mul_f32 v[60:61], v[60:61], v[242:243] op_sel_hi:[1,0]
    v_pk_mul_f32 v[62:63], v[62:63], v[242:243] op_sel_hi:[1,0]
    v_cvt_pk_bf16_f32 v50, v60, v61
    v_cvt_pk_bf16_f32 v51, v62, v63
    ds_write_b128 v240, v[48:51] offset:12288
    v_pk_mul_f32 v[52:53], v[52:53], v[244:245] op_sel_hi:[1,0]
    v_pk_mul_f32 v[54:55], v[54:55], v[244:245] op_sel_hi:[1,0]
    v_cvt_pk_bf16_f32 v52, v52, v53
    v_cvt_pk_bf16_f32 v53, v54, v55
    v_pk_mul_f32 v[64:65], v[64:65], v[244:245] op_sel_hi:[1,0]
    v_pk_mul_f32 v[66:67], v[66:67], v[244:245] op_sel_hi:[1,0]
    v_cvt_pk_bf16_f32 v54, v64, v65
    v_cvt_pk_bf16_f32 v55, v66, v67
    ds_write_b128 v240, v[52:55] offset:14336
    v_pk_mul_f32 v[56:57], v[56:57], v[246:247] op_sel_hi:[1,0]
    v_pk_mul_f32 v[58:59], v[58:59], v[246:247] op_sel_hi:[1,0]
    v_cvt_pk_bf16_f32 v56, v56, v57
    v_cvt_pk_bf16_f32 v57, v58, v59
    v_pk_mul_f32 v[68:69], v[68:69], v[246:247] op_sel_hi:[1,0]
    v_pk_mul_f32 v[70:71], v[70:71], v[246:247] op_sel_hi:[1,0]
    v_cvt_pk_bf16_f32 v58, v68, v69
    v_cvt_pk_bf16_f32 v59, v70, v71
    ds_write_b128 v240, v[56:59] offset:16384
    v_pk_mul_f32 v[72:73], v[72:73], v[242:243] op_sel_hi:[1,0]
    v_pk_mul_f32 v[74:75], v[74:75], v[242:243] op_sel_hi:[1,0]
    v_cvt_pk_bf16_f32 v72, v72, v73
    v_cvt_pk_bf16_f32 v73, v74, v75
    v_pk_mul_f32 v[84:85], v[84:85], v[242:243] op_sel_hi:[1,0]
    v_pk_mul_f32 v[86:87], v[86:87], v[242:243] op_sel_hi:[1,0]
    v_cvt_pk_bf16_f32 v74, v84, v85
    v_cvt_pk_bf16_f32 v75, v86, v87
    ds_write_b128 v240, v[72:75] offset:18432
    v_pk_mul_f32 v[76:77], v[76:77], v[244:245] op_sel_hi:[1,0]
    v_pk_mul_f32 v[78:79], v[78:79], v[244:245] op_sel_hi:[1,0]
    v_cvt_pk_bf16_f32 v76, v76, v77
    v_cvt_pk_bf16_f32 v77, v78, v79
    v_pk_mul_f32 v[88:89], v[88:89], v[244:245] op_sel_hi:[1,0]
    v_pk_mul_f32 v[90:91], v[90:91], v[244:245] op_sel_hi:[1,0]
    v_cvt_pk_bf16_f32 v78, v88, v89
    v_cvt_pk_bf16_f32 v79, v90, v91
    ds_write_b128 v240, v[76:79] offset:20480
    v_pk_mul_f32 v[80:81], v[80:81], v[246:247] op_sel_hi:[1,0]
    v_pk_mul_f32 v[82:83], v[82:83], v[246:247] op_sel_hi:[1,0]
    v_cvt_pk_bf16_f32 v80, v80, v81
    v_cvt_pk_bf16_f32 v81, v82, v83
    v_pk_mul_f32 v[92:93], v[92:93], v[246:247] op_sel_hi:[1,0]
    v_pk_mul_f32 v[94:95], v[94:95], v[246:247] op_sel_hi:[1,0]
    v_cvt_pk_bf16_f32 v82, v92, v93
    v_cvt_pk_bf16_f32 v83, v94, v95
    ds_write_b128 v240, v[80:83] offset:22528
    s_waitcnt lgkmcnt(0)
    s_barrier
    s_mov_b32 s33, 8
LS_AO:
    s_barrier
    s_barrier
    s_sub_u32 s33, s33, 1
    s_cmp_lg_u32 s33, 0
    s_cbranch_scc1 LS_AO
    s_add_u32 s32, s32, 1
    s_cmp_lt_u32 s32, 4
    s_cbranch_scc1 LS_AR
    s_barrier
    s_endpgm
LP_A:
    s_setprio 0
    s_mov_b32 s45, s76
    s_mov_b32 s50, s77
    s_add_u32 s46, s75, 524288
    s_mov_b32 s43, 128
    s_mov_b32 s47, 0
    s_mov_b32 s41, 0
    s_mov_b32 s42, 0
    s_lshr_b32 s35, s36, 1
    s_lshl_b32 s34, s37, 7
    s_mov_b32 s44, 0
    s_mul_i32 s52, s35, 2112
    s_mul_i32 s48, s37, 4224
    s_add_u32 s52, s52, s48
    s_add_u32 s52, s52, 38656
    s_lshl_b32 s35, s35, 9
    s_add_u32 s34, s34, s35
    v_lshlrev_b32 v248, 10, v240
    v_add3_u32 v248, v248, v241, s34
    v_and_b32 v240, 3, v252
    v_mul_u32_u24 v240, 1056, v240
    v_bfe_u32 v241, v252, 2, 2
    v_lshrrev_b32 v242, 4, v252
    v_mul_u32_u24 v251, 1056, v241
    v_lshl_add_u32 v251, v242, 7, v251
    v_and_b32 v240, 3, v252
    v_lshl_add_u32 v251, v240, 3, v251
    s_lshl_b32 s34, s36, 5
    s_add_u32 s34, s34, 640
    v_add_u32 v251, s34, v251
    v_lshlrev_b32 v253, 4, v252
    v_add_u32 v253, 106240, v253
    s_waitcnt vmcnt(4)
    s_mov_b32 s32, 0
LP_ROUNDA:
    s_barrier
    s_add_u32 s35, s46, 0
    s_add_u32 m0, s45, 33792
    s_nop 0
    buffer_load_dwordx4 v250, s[20:23], s35 offen lds
    s_add_u32 s35, s46, 8192
    s_add_u32 m0, s45, 34824
    s_nop 0
    buffer_load_dwordx4 v250, s[20:23], s35 offen lds
    s_add_u32 s35, s46, 16384
    s_add_u32 m0, s45, 35904
    s_nop 0
    buffer_load_dwordx4 v250, s[20:23], s35 offen lds
    s_add_u32 s35, s46, 24576
    s_add_u32 m0, s45, 36936
    s_nop 0
    buffer_load_dwordx4 v250, s[20:23], s35 offen lds
    s_add_u32 s46, s46, 262144
    s_add_u32 s35, s43, 0
    s_add_u32 m0, s50, 12672
    s_nop 0
    buffer_load_dwordx4 v249, s[16:19], s35 offen lds
    s_add_u32 s35, s43, 36864
    s_add_u32 m0, s50, 16896
    s_nop 0
    buffer_load_dwordx4 v249, s[16:19], s35 offen lds
    s_add_u32 s35, s43, 73728
    s_add_u32 m0, s50, 21120
    s_nop 0
    buffer_load_dwordx4 v249, s[16:19], s35 offen lds
    s_add_u32 s43, s43, 128
    s_add_u32 s35, s43, 0
    s_add_u32 m0, s50, 25344
    s_nop 0
    buffer_load_dwordx4 v249, s[16:19], s35 offen lds
    s_add_u32 s35, s43, 36864
    s_add_u32 m0, s50, 29568
    s_nop 0
    buffer_load_dwordx4 v249, s[16:19], s35 offen lds
    s_add_u32 s35, s43, 73728
    s_add_u32 m0, s50, 33792
    s_nop 0
    buffer_load_dwordx4 v249, s[16:19], s35 offen lds
    s_add_u32 s43, s43, 128
    s_waitcnt vmcnt(10) lgkmcnt(0)
    s_barrier
    s_add_u32 s35, s46, 0
    s_add_u32 m0, s45, 0
    s_nop 0
    buffer_load_dwordx4 v250, s[20:23], s35 offen lds
    s_add_u32 s35, s46, 8192
    s_add_u32 m0, s45, 1032
    s_nop 0
    buffer_load_dwordx4 v250, s[20:23], s35 offen lds
    s_add_u32 s35, s46, 16384
    s_add_u32 m0, s45, 2112
    s_nop 0
    buffer_load_dwordx4 v250, s[20:23], s35 offen lds
    s_add_u32 s35, s46, 24576
    s_add_u32 m0, s45, 3144
    s_nop 0
    buffer_load_dwordx4 v250, s[20:23], s35 offen lds
    s_add_u32 s46, s46, 262144
    s_waitcnt vmcnt(7) lgkmcnt(0)
    s_barrier
    v_mov_b32 v252, v253
    s_cmp_eq_u32 s32, 0
    s_cselect_b32 s26, 0, 1179648
    s_sub_u32 s47, s32, 1
    s_max_i32 s47, s47, 0
    s_mul_i32 s47, s47, 294912
    s_cmp_lg_u32 s32, 1
    s_cbranch_scc1 LP_n0A_3
    s_mov_b32 s28, s72
    s_and_b32 s29, s73, 0xffff
    s_mov_b32 s30, 256
    s_mov_b32 s31, 0x20000
    v_mov_b32 v234, 0
    buffer_load_dwordx2 v[232:233], v234, s[28:31], 0 offen
LP_n0A_3:
    s_add_u32 s35, s46, 0
    s_add_u32 m0, s45, 16896
    s_nop 0
    buffer_load_dwordx4 v250, s[20:23], s35 offen lds
    s_add_u32 s35, s46, 8192
    s_add_u32 m0, s45, 17928
    s_nop 0
    buffer_load_dwordx4 v250, s[20:23], s35 offen lds
    s_add_u32 s35, s46, 16384
    s_add_u32 m0, s45, 19008
    s_nop 0
    buffer_load_dwordx4 v250, s[20:23], s35 offen lds
    s_add_u32 s35, s46, 24576
    s_add_u32 m0, s45, 20040
    s_nop 0
    buffer_load_dwordx4 v250, s[20:23], s35 offen lds
    s_add_u32 s46, s46, 262144
    s_add_u32 s35, s43, 0
    s_add_u32 m0, s50, 0
    s_nop 0
    buffer_load_dwordx4 v249, s[16:19], s35 offen lds
    s_add_u32 s35, s43, 36864
    s_add_u32 m0, s50, 4224
    s_nop 0
    buffer_load_dwordx4 v249, s[16:19], s35 offen lds
    s_add_u32 s35, s43, 73728
    s_add_u32 m0, s50, 8448
    s_nop 0
    buffer_load_dwordx4 v249, s[16:19], s35 offen lds
    s_add_u32 s43, s43, 128
    s_waitcnt vmcnt(7) lgkmcnt(0)
    s_barrier
    s_add_u32 s35, s46, 0
    s_add_u32 m0, s45, 33792
    s_nop 0
    buffer_load_dwordx4 v250, s[20:23], s35 offen lds
    s_add_u32 s35, s46, 8192
    s_add_u32 m0, s45, 34824
    s_nop 0
    buffer_load_dwordx4 v250, s[20:23], s35 offen lds
    s_add_u32 s35, s46, 16384
    s_add_u32 m0, s45, 35904
    s_nop 0
    buffer_load_dwordx4 v250, s[20:23], s35 offen lds
    s_add_u32 s35, s46, 24576
    s_add_u32 m0, s45, 36936
    s_nop 0
    buffer_load_dwordx4 v250, s[20:23], s35 offen lds
    s_add_u32 s46, s46, 262144
    s_cmp_eq_u32 s32, 0
    s_cbranch_scc1 LP_zA_4
LP_zA_4_r:
    s_waitcnt vmcnt(7) lgkmcnt(0)
    s_barrier
    s_add_u32 s35, s46, 0
    s_add_u32 m0, s45, 0
    s_nop 0
    buffer_load_dwordx4 v250, s[20:23], s35 offen lds
    s_add_u32 s35, s46, 8192
    s_add_u32 m0, s45, 1032
    s_nop 0
    buffer_load_dwordx4 v250, s[20:23], s35 offen lds
    s_add_u32 s35, s46, 16384
    s_add_u32 m0, s45, 2112
    s_nop 0
    buffer_load_dwordx4 v250, s[20:23], s35 offen lds
    s_add_u32 s35, s46, 24576
    s_add_u32 m0, s45, 3144
    s_nop 0
    buffer_load_dwordx4 v250, s[20:23], s35 offen lds
    s_add_u32 s46, s46, 262144
    s_add_u32 s35, s43, 0
    s_add_u32 m0, s50, 12672
    s_nop 0
    buffer_load_dwordx4 v249, s[16:19], s35 offen lds
    s_add_u32 s35, s43, 36864
    s_add_u32 m0, s50, 16896
    s_nop 0
    buffer_load_dwordx4 v249, s[16:19], s35 offen lds
    s_add_u32 s35, s43, 73728
    s_add_u32 m0, s50, 21120
    s_nop 0
    buffer_load_dwordx4 v249, s[16:19], s35 offen lds
    s_add_u32 s43, s43, 128
    s_waitcnt vmcnt(7) lgkmcnt(0)
    s_barrier
    s_add_u32 s35, s46, 0
    s_add_u32 m0, s45, 16896
    s_nop 0
    buffer_load_dwordx4 v250, s[20:23], s35 offen lds
    s_add_u32 s35, s46, 8192
    s_add_u32 m0, s45, 17928
    s_nop 0
    buffer_load_dwordx4 v250, s[20:23], s35 offen lds
    s_add_u32 s35, s46, 16384
    s_add_u32 m0, s45, 19008
    s_nop 0
    buffer_load_dwordx4 v250, s[20:23], s35 offen lds
    s_add_u32 s35, s46, 24576
    s_add_u32 m0, s45, 20040
    s_nop 0
    buffer_load_dwordx4 v250, s[20:23], s35 offen lds
    s_add_u32 s46, s46, 262144
    s_cmp_eq_u32 s32, 0
    s_cbranch_scc1 LP_zA_5
LP_zA_5_r:
    s_waitcnt vmcnt(7) lgkmcnt(0)
    s_barrier
    s_cmp_lg_u32 s32, 1
    s_cbranch_scc1 LP_ngA_6
    v_readfirstlane_b32 s84, v232
    v_readfirstlane_b32 s85, v233
    s_nop 1
    s_cmp_lg_u32 s84, 0
    s_cbranch_scc1 LP_ngA_6
    s_mov_b32 s28, s72
    s_and_b32 s29, s73, 0xffff
    s_mov_b32 s30, 256
    s_mov_b32 s31, 0x20000
    v_mov_b32 v234, 0
    s_mov_b32 s40, 200000
    buffer_load_dwordx2 v[232:233], v234, s[28:31], 0 offen
    s_waitcnt vmcnt(0)
    v_readfirstlane_b32 s84, v232
    v_readfirstlane_b32 s85, v233
    s_nop 1
    s_cmp_lg_u32 s84, 0
    s_cbranch_scc1 LP_ngA_6_g_ok
LP_ngA_6_g:
    buffer_load_dwordx2 v[232:233], v234, s[28:31], 0 offen sc1
    s_waitcnt vmcnt(0)
    v_readfirstlane_b32 s84, v232
    v_readfirstlane_b32 s85, v233
    s_nop 1
    s_cmp_lg_u32 s84, 0
    s_cbranch_scc1 LP_ngA_6_g_ok
    s_sleep 8
    s_sub_u32 s40, s40, 1
    s_cmp_lg_u32 s40, 0
    s_cbranch_scc1 LP_ngA_6_g
LP_ngA_6_g_ok:
LP_ngA_6:
    s_add_u32 s35, s46, 0
    s_add_u32 m0, s45, 33792
    s_nop 0
    buffer_load_dwordx4 v250, s[20:23], s35 offen lds
    s_add_u32 s35, s46, 8192
    s_add_u32 m0, s45, 34824
    s_nop 0
    buffer_load_dwordx4 v250, s[20:23], s35 offen lds
    s_add_u32 s35, s46, 16384
    s_add_u32 m0, s45, 35904
    s_nop 0
    buffer_load_dwordx4 v250, s[20:23], s35 offen lds
    s_add_u32 s35, s46, 24576
    s_add_u32 m0, s45, 36936
    s_nop 0
    buffer_load_dwordx4 v250, s[20:23], s35 offen lds
    s_add_u32 s46, s46, 262144
    s_add_u32 s35, s43, 0
    s_add_u32 m0, s50, 25344
    s_nop 0
    buffer_load_dwordx4 v249, s[16:19], s35 offen lds
    s_add_u32 s35, s43, 36864
    s_add_u32 m0, s50, 29568
    s_nop 0
    buffer_load_dwordx4 v249, s[16:19], s35 offen lds
    s_add_u32 s35, s43, 73728
    s_add_u32 m0, s50, 33792
    s_nop 0
    buffer_load_dwordx4 v249, s[16:19], s35 offen lds
    s_add_u32 s43, s43, 128
    s_waitcnt vmcnt(7) lgkmcnt(0)
    s_barrier
    s_add_u32 s35, s46, 0
    s_add_u32 m0, s45, 0
    s_nop 0
    buffer_load_dwordx4 v250, s[20:23], s35 offen lds
    s_add_u32 s35, s46, 8192
    s_add_u32 m0, s45, 1032
    s_nop 0
    buffer_load_dwordx4 v250, s[20:23], s35 offen lds
    s_add_u32 s35, s46, 16384
    s_add_u32 m0, s45, 2112
    s_nop 0
    buffer_load_dwordx4 v250, s[20:23], s35 offen lds
    s_add_u32 s35, s46, 24576
    s_add_u32 m0, s45, 3144
    s_nop 0
    buffer_load_dwordx4 v250, s[20:23], s35 offen lds
    s_add_u32 s46, s46, 262144
    s_cmp_eq_u32 s32, 0
    s_cbranch_scc1 LP_zA_7
LP_zA_7_r:
    s_waitcnt vmcnt(7) lgkmcnt(0)
    s_barrier
    s_add_u32 s35, s46, 0
    s_add_u32 m0, s45, 16896
    s_nop 0
    buffer_load_dwordx4 v250, s[20:23], s35 offen lds
    s_add_u32 s35, s46, 8192
    s_add_u32 m0, s45, 17928
    s_nop 0
    buffer_load_dwordx4 v250, s[20:23], s35 offen lds
    s_add_u32 s35, s46, 16384
    s_add_u32 m0, s45, 19008
    s_nop 0
    buffer_load_dwordx4 v250, s[20:23], s35 offen lds
    s_add_u32 s35, s46, 24576
    s_add_u32 m0, s45, 20040
    s_nop 0
    buffer_load_dwordx4 v250, s[20:23], s35 offen lds
    s_add_u32 s46, s46, 262144
    s_add_u32 s35, s43, 0
    s_add_u32 m0, s50, 0
    s_nop 0
    buffer_load_dwordx4 v249, s[16:19], s35 offen lds
    s_add_u32 s35, s43, 36864
    s_add_u32 m0, s50, 4224
    s_nop 0
    buffer_load_dwordx4 v249, s[16:19], s35 offen lds
    s_add_u32 s35, s43, 73728
    s_add_u32 m0, s50, 8448
    s_nop 0
    buffer_load_dwordx4 v249, s[16:19], s35 offen lds
    s_add_u32 s43, s43, 128
    s_waitcnt vmcnt(7) lgkmcnt(0)
    s_barrier
    s_add_u32 s35, s46, 0
    s_add_u32 m0, s45, 33792
    s_nop 0
    buffer_load_dwordx4 v250, s[20:23], s35 offen lds
    s_add_u32 s35, s46, 8192
    s_add_u32 m0, s45, 34824
    s_nop 0
    buffer_load_dwordx4 v250, s[20:23], s35 offen lds
    s_add_u32 s35, s46, 16384
    s_add_u32 m0, s45, 35904
    s_nop 0
    buffer_load_dwordx4 v250, s[20:23], s35 offen lds
    s_add_u32 s35, s46, 24576
    s_add_u32 m0, s45, 36936
    s_nop 0
    buffer_load_dwordx4 v250, s[20:23], s35 offen lds
    s_add_u32 s46, s46, 262144
    s_cmp_eq_u32 s32, 0
    s_cbranch_scc1 LP_zA_8
LP_zA_8_r:
    s_waitcnt vmcnt(7) lgkmcnt(0)
    s_barrier
    s_add_u32 s35, s46, 0
    s_add_u32 m0, s45, 0
    s_nop 0
    buffer_load_dwordx4 v250, s[20:23], s35 offen lds
    s_add_u32 s35, s46, 8192
    s_add_u32 m0, s45, 1032
    s_nop 0
    buffer_load_dwordx4 v250, s[20:23], s35 offen lds
    s_add_u32 s35, s46, 16384
    s_add_u32 m0, s45, 2112
    s_nop 0
    buffer_load_dwordx4 v250, s[20:23], s35 offen lds
    s_add_u32 s35, s46, 24576
    s_add_u32 m0, s45, 3144
    s_nop 0
    buffer_load_dwordx4 v250, s[20:23], s35 offen lds
    s_add_u32 s46, s46, 262144
    s_add_u32 s35, s43, 0
    s_add_u32 m0, s50, 12672
    s_nop 0
    buffer_load_dwordx4 v249, s[16:19], s35 offen lds
    s_add_u32 s35, s43, 36864
    s_add_u32 m0, s50, 16896
    s_nop 0
    buffer_load_dwordx4 v249, s[16:19], s35 offen lds
    s_add_u32 s35, s43, 73728
    s_add_u32 m0, s50, 21120
    s_nop 0
    buffer_load_dwordx4 v249, s[16:19], s35 offen lds
    s_add_u32 s43, s43, 128
    s_waitcnt vmcnt(7) lgkmcnt(0)
    s_barrier
    s_add_u32 s35, s46, 0
    s_add_u32 m0, s45, 16896
    s_nop 0
    buffer_load_dwordx4 v250, s[20:23], s35 offen lds
    s_add_u32 s35, s46, 8192
    s_add_u32 m0, s45, 17928
    s_nop 0
    buffer_load_dwordx4 v250, s[20:23], s35 offen lds
    s_add_u32 s35, s46, 16384
    s_add_u32 m0, s45, 19008
    s_nop 0
    buffer_load_dwordx4 v250, s[20:23], s35 offen lds
    s_add_u32 s35, s46, 24576
    s_add_u32 m0, s45, 20040
    s_nop 0
    buffer_load_dwordx4 v250, s[20:23], s35 offen lds
    s_add_u32 s46, s46, 262144
    s_waitcnt vmcnt(7) lgkmcnt(0)
    s_barrier
    s_add_u32 s35, s46, 0
    s_add_u32 m0, s45, 33792
    s_nop 0
    buffer_load_dwordx4 v250, s[20:23], s35 offen lds
    s_add_u32 s35, s46, 8192
    s_add_u32 m0, s45, 34824
    s_nop 0
    buffer_load_dwordx4 v250, s[20:23], s35 offen lds
    s_add_u32 s35, s46, 16384
    s_add_u32 m0, s45, 35904
    s_nop 0
    buffer_load_dwordx4 v250, s[20:23], s35 offen lds
    s_add_u32 s35, s46, 24576
    s_add_u32 m0, s45, 36936
    s_nop 0
    buffer_load_dwordx4 v250, s[20:23], s35 offen lds
    s_add_u32 s46, s46, 262144
    s_add_u32 s35, s43, 0
    s_add_u32 m0, s50, 25344
    s_nop 0
    buffer_load_dwordx4 v249, s[16:19], s35 offen lds
    s_add_u32 s35, s43, 36864
    s_add_u32 m0, s50, 29568
    s_nop 0
    buffer_load_dwordx4 v249, s[16:19], s35 offen lds
    s_add_u32 s35, s43, 73728
    s_add_u32 m0, s50, 33792
    s_nop 0
    buffer_load_dwordx4 v249, s[16:19], s35 offen lds
    s_mov_b32 s43, 0
    s_waitcnt vmcnt(7) lgkmcnt(0)
    s_barrier
    s_add_u32 s35, s46, 0
    s_add_u32 m0, s45, 0
    s_nop 0
    buffer_load_dwordx4 v250, s[20:23], s35 offen lds
    s_add_u32 s35, s46, 8192
    s_add_u32 m0, s45, 1032
    s_nop 0
    buffer_load_dwordx4 v250, s[20:23], s35 offen lds
    s_add_u32 s35, s46, 16384
    s_add_u32 m0, s45, 2112
    s_nop 0
    buffer_load_dwordx4 v250, s[20:23], s35 offen lds
    s_add_u32 s35, s46, 24576
    s_add_u32 m0, s45, 3144
    s_nop 0
    buffer_load_dwordx4 v250, s[20:23], s35 offen lds
    s_add_u32 s46, s46, 262144
    s_add_u32 m0, s52, 50688
    s_nop 0
    buffer_load_dwordx4 v248, s[8:11], s41 offen offset:0 nt lds
    s_add_u32 m0, s52, 51488
    s_nop 0
    buffer_load_dwordx4 v248, s[8:11], s41 offen offset:256 nt lds
    s_add_u32 s41, s41, 8192
    s_waitcnt vmcnt(9) lgkmcnt(0)
    s_barrier
    s_add_u32 s35, s46, 0
    s_add_u32 m0, s45, 16896
    s_nop 0
    buffer_load_dwordx4 v250, s[20:23], s35 offen lds
    s_add_u32 s35, s46, 8192
    s_add_u32 m0, s45, 17928
    s_nop 0
    buffer_load_dwordx4 v250, s[20:23], s35 offen lds
    s_add_u32 s35, s46, 16384
    s_add_u32 m0, s45, 19008
    s_nop 0
    buffer_load_dwordx4 v250, s[20:23], s35 offen lds
    s_add_u32 s35, s46, 24576
    s_add_u32 m0, s45, 20040
    s_nop 0
    buffer_load_dwordx4 v250, s[20:23], s35 offen lds
    s_add_u32 s46, s46, 262144
    s_waitcnt vmcnt(6) lgkmcnt(0)
    s_barrier
    s_add_u32 s35, s46, 0
    s_add_u32 m0, s45, 33792
    s_nop 0
    buffer_load_dwordx4 v250, s[20:23], s35 offen lds
    s_add_u32 s35, s46, 8192
    s_add_u32 m0, s45, 34824
    s_nop 0
    buffer_load_dwordx4 v250, s[20:23], s35 offen lds
    s_add_u32 s35, s46, 16384
    s_add_u32 m0, s45, 35904
    s_nop 0
    buffer_load_dwordx4 v250, s[20:23], s35 offen lds
    s_add_u32 s35, s46, 24576
    s_add_u32 m0, s45, 36936
    s_nop 0
    buffer_load_dwordx4 v250, s[20:23], s35 offen lds
    s_sub_u32 s46, s46, 4455936
    s_add_u32 s35, s47, s90
    s_add_u32 m0, s50, 0
    s_nop 0
    buffer_load_dwordx4 v249, s[24:27], s35 offen lds
    s_add_u32 s35, s47, s91
    s_add_u32 m0, s50, 4224
    s_nop 0
    buffer_load_dwordx4 v249, s[24:27], s35 offen lds
    s_add_u32 s35, s47, s92
    s_add_u32 m0, s50, 8448
    s_nop 0
    buffer_load_dwordx4 v249, s[24:27], s35 offen lds
    s_waitcnt vmcnt(7) lgkmcnt(0)
    s_barrier
    s_add_u32 s35, s47, s93
    s_add_u32 m0, s50, 12672
    s_nop 0
    buffer_load_dwordx4 v249, s[24:27], s35 offen lds
    s_add_u32 s35, s47, s94
    s_add_u32 m0, s50, 16896
    s_nop 0
    buffer_load_dwordx4 v249, s[24:27], s35 offen lds
    s_add_u32 m0, s52, 0
    s_nop 0
    buffer_load_dwordx4 v248, s[8:11], s41 offen offset:0 nt lds
    s_add_u32 m0, s52, 800
    s_nop 0
    buffer_load_dwordx4 v248, s[8:11], s41 offen offset:256 nt lds
    s_add_u32 s41, s41, 8192
    s_waitcnt vmcnt(7) lgkmcnt(0)
    s_barrier
    s_add_u32 m0, s52, 16896
    s_nop 0
    buffer_load_dwordx4 v248, s[12:15], s42 offen offset:0 nt lds
    s_add_u32 m0, s52, 17696
    s_nop 0
    buffer_load_dwordx4 v248, s[12:15], s42 offen offset:256 nt lds
    s_add_u32 s42, s42, 8192
    s_waitcnt vmcnt(6) lgkmcnt(0)
    s_barrier
    s_cmp_eq_u32 s32, 0
    s_cbranch_scc1 LP_r0A_9
    ds_read_b128 v[216:219], v252 offset:0
    ds_read_b128 v[220:223], v252 offset:1024
    ds_read_b128 v[224:227], v252 offset:2048
    ds_read_b128 v[228:231], v252 offset:3072
    ds_read_b128 v[232:235], v252 offset:4096
    ds_read_b128 v[236:239], v252 offset:5120
    ds_read_b64_tr_b16 v[240:241], v251 offset:0
    ds_read_b64_tr_b16 v[242:243], v251 offset:512
    ds_read_b64_tr_b16 v[244:245], v251 offset:4224
    ds_read_b64_tr_b16 v[246:247], v251 offset:4736
    s_add_u32 s35, s47, s95
    s_add_u32 m0, s50, 21120
    s_nop 0
    buffer_load_dwordx4 v249, s[24:27], s35 offen lds
    s_waitcnt lgkmcnt(2)
    v_mfma_f32_16x16x32_bf16 v[0:3], v[240:243], v[216:219], v[0:3]
    v_mfma_f32_16x16x32_bf16 v[4:7], v[240:243], v[220:223], v[4:7]
    v_mfma_f32_16x16x32_bf16 v[8:11], v[240:243], v[224:227], v[8:11]
    s_add_u32 s35, s47, s96
    s_add_u32 m0, s50, 25344
    v_mfma_f32_16x16x32_bf16 v[12:15], v[240:243], v[228:231], v[12:15]
    buffer_load_dwordx4 v249, s[24:27], s35 offen lds
    v_mfma_f32_16x16x32_bf16 v[16:19], v[240:243], v[232:235], v[16:19]
    v_mfma_f32_16x16x32_bf16 v[20:23], v[240:243], v[236:239], v[20:23]
    ds_read_b64_tr_b16 v[240:241], v251 offset:8448
    ds_read_b64_tr_b16 v[242:243], v251 offset:8960
    s_waitcnt lgkmcnt(2)
    s_add_u32 s35, s47, s97
    s_add_u32 m0, s50, 29568
    v_mfma_f32_16x16x32_bf16 v[24:27], v[244:247], v[216:219], v[24:27]
    buffer_load_dwordx4 v249, s[24:27], s35 offen lds
    v_mfma_f32_16x16x32_bf16 v[28:31], v[244:247], v[220:223], v[28:31]
    v_mfma_f32_16x16x32_bf16 v[32:35], v[244:247], v[224:227], v[32:35]
    v_mfma_f32_16x16x32_bf16 v[36:39], v[244:247], v[228:231], v[36:39]
    s_add_u32 s35, s47, s98
    s_add_u32 m0, s50, 33792
    v_mfma_f32_16x16x32_bf16 v[40:43], v[244:247], v[232:235], v[40:43]
    buffer_load_dwordx4 v249, s[24:27], s35 offen lds
    s_add_u32 s47, s47, 36864
    v_mfma_f32_16x16x32_bf16 v[44:47], v[244:247], v[236:239], v[44:47]
    s_waitcnt lgkmcnt(0)
    v_mfma_f32_16x16x32_bf16 v[48:51], v[240:243], v[216:219], v[48:51]
    s_add_u32 m0, s52, 33792
    v_mfma_f32_16x16x32_bf16 v[52:55], v[240:243], v[220:223], v[52:55]
    buffer_load_dwordx4 v248, s[8:11], s41 offen offset:0 nt lds
    v_mfma_f32_16x16x32_bf16 v[56:59], v[240:243], v[224:227], v[56:59]
    v_mfma_f32_16x16x32_bf16 v[60:63], v[240:243], v[228:231], v[60:63]
    v_mfma_f32_16x16x32_bf16 v[64:67], v[240:243], v[232:235], v[64:67]
    s_add_u32 m0, s52, 34592
    v_mfma_f32_16x16x32_bf16 v[68:71], v[240:243], v[236:239], v[68:71]
    buffer_load_dwordx4 v248, s[8:11], s41 offen offset:256 nt lds
    s_add_u32 s41, s41, 8192
LP_jA_10:
    s_waitcnt vmcnt(8) lgkmcnt(0)
LP_H19A:
    s_barrier
    s_cmp_eq_u32 s32, 0
    s_cbranch_scc1 LP_r0A_11
    ds_read_b64_tr_b16 v[244:245], v251 offset:12672
    ds_read_b64_tr_b16 v[246:247], v251 offset:13184
    ds_read_b64_tr_b16 v[240:241], v251 offset:16896
    ds_read_b64_tr_b16 v[242:243], v251 offset:17408
    s_add_u32 s35, s47, s90
    s_add_u32 m0, s50, 0
    s_nop 0
    buffer_load_dwordx4 v249, s[24:27], s35 offen lds
    s_waitcnt lgkmcnt(2)
    v_mfma_f32_16x16x32_bf16 v[72:75], v[244:247], v[216:219], v[72:75]
    s_add_u32 s35, s47, s91
    s_add_u32 m0, s50, 4224
    v_mfma_f32_16x16x32_bf16 v[76:79], v[244:247], v[220:223], v[76:79]
    buffer_load_dwordx4 v249, s[24:27], s35 offen lds
    s_add_u32 s35, s47, s92
    s_add_u32 m0, s50, 8448
    v_mfma_f32_16x16x32_bf16 v[80:83], v[244:247], v[224:227], v[80:83]
    buffer_load_dwordx4 v249, s[24:27], s35 offen lds
    v_mfma_f32_16x16x32_bf16 v[84:87], v[244:247], v[228:231], v[84:87]
    s_add_u32 m0, s52, 50688
    v_mfma_f32_16x16x32_bf16 v[88:91], v[244:247], v[232:235], v[88:91]
    buffer_load_dwordx4 v248, s[12:15], s42 offen offset:0 nt lds
    s_add_u32 m0, s52, 51488
    v_mfma_f32_16x16x32_bf16 v[92:95], v[244:247], v[236:239], v[92:95]
    buffer_load_dwordx4 v248, s[12:15], s42 offen offset:256 nt lds
    s_add_u32 s42, s42, 8192
LP_jA_12:
    s_waitcnt vmcnt(11) lgkmcnt(0)
    s_barrier
    s_lshr_b32 s99, 14, s32
    s_and_b32 s99, s99, 1
    s_add_u32 m0, s52, 0
    s_nop 0
    buffer_load_dwordx4 v248, s[8:11], s41 offen offset:0 nt lds
    s_add_u32 m0, s52, 800
    s_nop 0
    buffer_load_dwordx4 v248, s[8:11], s41 offen offset:256 nt lds
    s_add_u32 s41, s41, 8192
    s_cmp_eq_u32 s99, 0
    s_cbranch_scc1 LP_th_13
    s_waitcnt vmcnt(2)
LP_th_13:
    s_waitcnt vmcnt(7) lgkmcnt(0)
    s_mov_b32 s33, 3
LP_TA:
    s_barrier
    s_cmp_eq_u32 s32, 0
    s_cbranch_scc1 LP_r0A_14
    ds_read_b64_tr_b16 v[244:245], v251 offset:21120
    ds_read_b64_tr_b16 v[246:247], v251 offset:21632
    s_add_u32 s35, s47, s93
    s_add_u32 m0, s50, 12672
    s_nop 0
    buffer_load_dwordx4 v249, s[24:27], s35 offen lds
    v_mfma_f32_16x16x32_bf16 v[96:99], v[240:243], v[216:219], v[96:99]
    v_mfma_f32_16x16x32_bf16 v[100:103], v[240:243], v[220:223], v[100:103]
    v_mfma_f32_16x16x32_bf16 v[104:107], v[240:243], v[224:227], v[104:107]
    s_add_u32 s35, s47, s94
    s_add_u32 m0, s50, 16896
    v_mfma_f32_16x16x32_bf16 v[108:111], v[240:243], v[228:231], v[108:111]
    buffer_load_dwordx4 v249, s[24:27], s35 offen lds
    v_mfma_f32_16x16x32_bf16 v[112:115], v[240:243], v[232:235], v[112:115]
    v_mfma_f32_16x16x32_bf16 v[116:119], v[240:243], v[236:239], v[116:119]
    ds_read_b64_tr_b16 v[240:241], v251 offset:25344
    ds_read_b64_tr_b16 v[242:243], v251 offset:25856
    s_waitcnt lgkmcnt(2)
    v_mfma_f32_16x16x32_bf16 v[120:123], v[244:247], v[216:219], v[120:123]
    s_add_u32 m0, s52, 16896
    v_mfma_f32_16x16x32_bf16 v[124:127], v[244:247], v[220:223], v[124:127]
    buffer_load_dwordx4 v248, s[12:15], s42 offen offset:0 nt lds
    v_mfma_f32_16x16x32_bf16 v[128:131], v[244:247], v[224:227], v[128:131]
    v_mfma_f32_16x16x32_bf16 v[132:135], v[244:247], v[228:231], v[132:135]
    v_mfma_f32_16x16x32_bf16 v[136:139], v[244:247], v[232:235], v[136:139]
    s_add_u32 m0, s52, 17696
    v_mfma_f32_16x16x32_bf16 v[140:143], v[244:247], v[236:239], v[140:143]
    buffer_load_dwordx4 v248, s[12:15], s42 offen offset:256 nt lds
    s_add_u32 s42, s42, 8192
LP_jA_15:
    s_cmp_eq_u32 s99, 0
    s_cbranch_scc1 LP_th_16
    s_waitcnt vmcnt(4)
LP_th_16:
    s_waitcnt vmcnt(6) lgkmcnt(0)
    s_barrier
    s_cmp_eq_u32 s32, 0
    s_cbranch_scc1 LP_r0A_17
    ds_read_b64_tr_b16 v[244:245], v251 offset:29568
    ds_read_b64_tr_b16 v[246:247], v251 offset:30080
    s_add_u32 s35, s47, s95
    s_add_u32 m0, s50, 21120
    s_nop 0
    buffer_load_dwordx4 v249, s[24:27], s35 offen lds
    v_mfma_f32_16x16x32_bf16 v[144:147], v[240:243], v[216:219], v[144:147]
    v_mfma_f32_16x16x32_bf16 v[148:151], v[240:243], v[220:223], v[148:151]
    v_mfma_f32_16x16x32_bf16 v[152:155], v[240:243], v[224:227], v[152:155]
    s_add_u32 s35, s47, s96
    s_add_u32 m0, s50, 25344
    v_mfma_f32_16x16x32_bf16 v[156:159], v[240:243], v[228:231], v[156:159]
    buffer_load_dwordx4 v249, s[24:27], s35 offen lds
    v_mfma_f32_16x16x32_bf16 v[160:163], v[240:243], v[232:235], v[160:163]
    v_mfma_f32_16x16x32_bf16 v[164:167], v[240:243], v[236:239], v[164:167]
    ds_read_b64_tr_b16 v[240:241], v251 offset:33792
    ds_read_b64_tr_b16 v[242:243], v251 offset:34304
    s_waitcnt lgkmcnt(2)
    v_mfma_f32_16x16x32_bf16 v[168:171], v[244:247], v[216:219], v[168:171]
    s_add_u32 m0, s52, 33792
    v_mfma_f32_16x16x32_bf16 v[172:175], v[244:247], v[220:223], v[172:175]
    buffer_load_dwordx4 v248, s[8:11], s41 offen offset:0 nt lds
    v_mfma_f32_16x16x32_bf16 v[176:179], v[244:247], v[224:227], v[176:179]
    v_mfma_f32_16x16x32_bf16 v[180:183], v[244:247], v[228:231], v[180:183]
    v_mfma_f32_16x16x32_bf16 v[184:187], v[244:247], v[232:235], v[184:187]
    s_add_u32 m0, s52, 34592
    v_mfma_f32_16x16x32_bf16 v[188:191], v[244:247], v[236:239], v[188:191]
    buffer_load_dwordx4 v248, s[8:11], s41 offen offset:256 nt lds
    s_add_u32 s41, s41, 8192
LP_jA_18:
    s_cmp_eq_u32 s99, 0
    s_cbranch_scc1 LP_th_19
    s_waitcnt vmcnt(4)
LP_th_19:
    s_waitcnt vmcnt(8) lgkmcnt(0)
    s_barrier
    s_cmp_eq_u32 s32, 0
    s_cbranch_scc1 LP_r0A_20
    ds_read_b64_tr_b16 v[244:245], v251 offset:0
    ds_read_b64_tr_b16 v[246:247], v251 offset:512
    s_add_u32 s35, s47, s97
    s_add_u32 m0, s50, 29568
    s_nop 0
    buffer_load_dwordx4 v249, s[24:27], s35 offen lds
    v_mfma_f32_16x16x32_bf16 v[192:195], v[240:243], v[216:219], v[192:195]
    ds_read_b128 v[216:219], v252 offset:6144
    v_mfma_f32_16x16x32_bf16 v[196:199], v[240:243], v[220:223], v[196:199]
    ds_read_b128 v[220:223], v252 offset:7168
    v_mfma_f32_16x16x32_bf16 v[200:203], v[240:243], v[224:227], v[200:203]
    ds_read_b128 v[224:227], v252 offset:8192
    v_mfma_f32_16x16x32_bf16 v[204:207], v[240:243], v[228:231], v[204:207]
    ds_read_b128 v[228:231], v252 offset:9216
    v_mfma_f32_16x16x32_bf16 v[208:211], v[240:243], v[232:235], v[208:211]
    ds_read_b128 v[232:235], v252 offset:10240
    s_add_u32 s35, s47, s98
    s_add_u32 m0, s50, 33792
    v_mfma_f32_16x16x32_bf16 v[212:215], v[240:243], v[236:239], v[212:215]
    ds_read_b128 v[236:239], v252 offset:11264
    ds_read_b64_tr_b16 v[240:241], v251 offset:4224
    ds_read_b64_tr_b16 v[242:243], v251 offset:4736
    buffer_load_dwordx4 v249, s[24:27], s35 offen lds
    s_add_u32 s47, s47, 36864
    v_add_u32 v252, 6144, v252
    s_waitcnt lgkmcnt(8)
    s_waitcnt lgkmcnt(6)
    v_mfma_f32_16x16x32_bf16 v[0:3], v[244:247], v[216:219], v[0:3]
    v_mfma_f32_16x16x32_bf16 v[4:7], v[244:247], v[220:223], v[4:7]
    s_waitcnt lgkmcnt(4)
    v_mfma_f32_16x16x32_bf16 v[8:11], v[244:247], v[224:227], v[8:11]
    v_mfma_f32_16x16x32_bf16 v[12:15], v[244:247], v[228:231], v[12:15]
    s_waitcnt lgkmcnt(2)
    v_mfma_f32_16x16x32_bf16 v[16:19], v[244:247], v[232:235], v[16:19]
    s_add_u32 m0, s52, 50688
    v_mfma_f32_16x16x32_bf16 v[20:23], v[244:247], v[236:239], v[20:23]
    ds_read_b64_tr_b16 v[244:245], v251 offset:8448
    ds_read_b64_tr_b16 v[246:247], v251 offset:8960
    buffer_load_dwordx4 v248, s[12:15], s42 offen offset:0 nt lds
    s_waitcnt lgkmcnt(2)
    v_mfma_f32_16x16x32_bf16 v[24:27], v[240:243], v[216:219], v[24:27]
    v_mfma_f32_16x16x32_bf16 v[28:31], v[240:243], v[220:223], v[28:31]
    v_mfma_f32_16x16x32_bf16 v[32:35], v[240:243], v[224:227], v[32:35]
    v_mfma_f32_16x16x32_bf16 v[36:39], v[240:243], v[228:231], v[36:39]
    v_mfma_f32_16x16x32_bf16 v[40:43], v[240:243], v[232:235], v[40:43]
    s_add_u32 m0, s52, 51488
    v_mfma_f32_16x16x32_bf16 v[44:47], v[240:243], v[236:239], v[44:47]
    buffer_load_dwordx4 v248, s[12:15], s42 offen offset:256 nt lds
    s_add_u32 s42, s42, 8192
LP_jA_21:
    s_cmp_eq_u32 s99, 0
    s_cbranch_scc1 LP_th_22
    s_waitcnt vmcnt(4)
LP_th_22:
    s_waitcnt vmcnt(8) lgkmcnt(0)
    s_barrier
    s_cmp_eq_u32 s32, 0
    s_cbranch_scc1 LP_r0A_23
    ds_read_b64_tr_b16 v[240:241], v251 offset:12672
    ds_read_b64_tr_b16 v[242:243], v251 offset:13184
    s_add_u32 s35, s47, s90
    s_add_u32 m0, s50, 0
    s_nop 0
    buffer_load_dwordx4 v249, s[24:27], s35 offen lds
    v_mfma_f32_16x16x32_bf16 v[48:51], v[244:247], v[216:219], v[48:51]
    v_mfma_f32_16x16x32_bf16 v[52:55], v[244:247], v[220:223], v[52:55]
    s_add_u32 s35, s47, s91
    s_add_u32 m0, s50, 4224
    v_mfma_f32_16x16x32_bf16 v[56:59], v[244:247], v[224:227], v[56:59]
    buffer_load_dwordx4 v249, s[24:27], s35 offen lds
    v_mfma_f32_16x16x32_bf16 v[60:63], v[244:247], v[228:231], v[60:63]
    v_mfma_f32_16x16x32_bf16 v[64:67], v[244:247], v[232:235], v[64:67]
    s_add_u32 s35, s47, s92
    s_add_u32 m0, s50, 8448
    v_mfma_f32_16x16x32_bf16 v[68:71], v[244:247], v[236:239], v[68:71]
    ds_read_b64_tr_b16 v[244:245], v251 offset:16896
    ds_read_b64_tr_b16 v[246:247], v251 offset:17408
    buffer_load_dwordx4 v249, s[24:27], s35 offen lds
    s_waitcnt lgkmcnt(2)
    v_mfma_f32_16x16x32_bf16 v[72:75], v[240:243], v[216:219], v[72:75]
    v_mfma_f32_16x16x32_bf16 v[76:79], v[240:243], v[220:223], v[76:79]
    s_add_u32 m0, s52, 0
    v_mfma_f32_16x16x32_bf16 v[80:83], v[240:243], v[224:227], v[80:83]
    buffer_load_dwordx4 v248, s[8:11], s41 offen offset:0 nt lds
    v_mfma_f32_16x16x32_bf16 v[84:87], v[240:243], v[228:231], v[84:87]
    v_mfma_f32_16x16x32_bf16 v[88:91], v[240:243], v[232:235], v[88:91]
    s_add_u32 m0, s52, 800
    v_mfma_f32_16x16x32_bf16 v[92:95], v[240:243], v[236:239], v[92:95]
    buffer_load_dwordx4 v248, s[8:11], s41 offen offset:256 nt lds
    s_add_u32 s41, s41, 8192
LP_jA_24:
    s_cmp_eq_u32 s99, 0
    s_cbranch_scc1 LP_th_25
    s_waitcnt vmcnt(5)
LP_th_25:
    s_waitcnt vmcnt(9) lgkmcnt(0)
    s_barrier
    s_cmp_eq_u32 s32, 0
    s_cbranch_scc1 LP_r0A_26
    ds_read_b64_tr_b16 v[240:241], v251 offset:21120
    ds_read_b64_tr_b16 v[242:243], v251 offset:21632
    s_add_u32 s35, s47, s93
    s_add_u32 m0, s50, 12672
    s_nop 0
    buffer_load_dwordx4 v249, s[24:27], s35 offen lds
    v_mfma_f32_16x16x32_bf16 v[96:99], v[244:247], v[216:219], v[96:99]
    v_mfma_f32_16x16x32_bf16 v[100:103], v[244:247], v[220:223], v[100:103]
    v_mfma_f32_16x16x32_bf16 v[104:107], v[244:247], v[224:227], v[104:107]
    s_add_u32 s35, s47, s94
    s_add_u32 m0, s50, 16896
    v_mfma_f32_16x16x32_bf16 v[108:111], v[244:247], v[228:231], v[108:111]
    buffer_load_dwordx4 v249, s[24:27], s35 offen lds
    v_mfma_f32_16x16x32_bf16 v[112:115], v[244:247], v[232:235], v[112:115]
    v_mfma_f32_16x16x32_bf16 v[116:119], v[244:247], v[236:239], v[116:119]
    ds_read_b64_tr_b16 v[244:245], v251 offset:25344
    ds_read_b64_tr_b16 v[246:247], v251 offset:25856
    s_waitcnt lgkmcnt(2)
    v_mfma_f32_16x16x32_bf16 v[120:123], v[240:243], v[216:219], v[120:123]
    s_add_u32 m0, s52, 16896
    v_mfma_f32_16x16x32_bf16 v[124:127], v[240:243], v[220:223], v[124:127]
    buffer_load_dwordx4 v248, s[12:15], s42 offen offset:0 nt lds
    v_mfma_f32_16x16x32_bf16 v[128:131], v[240:243], v[224:227], v[128:131]
    v_mfma_f32_16x16x32_bf16 v[132:135], v[240:243], v[228:231], v[132:135]
    v_mfma_f32_16x16x32_bf16 v[136:139], v[240:243], v[232:235], v[136:139]
    s_add_u32 m0, s52, 17696
    v_mfma_f32_16x16x32_bf16 v[140:143], v[240:243], v[236:239], v[140:143]
    buffer_load_dwordx4 v248, s[12:15], s42 offen offset:256 nt lds
    s_add_u32 s42, s42, 8192
LP_jA_27:
    s_cmp_eq_u32 s99, 0
    s_cbranch_scc1 LP_th_28
    s_waitcnt vmcnt(4)
LP_th_28:
    s_waitcnt vmcnt(9) lgkmcnt(0)
    s_barrier
    s_cmp_eq_u32 s32, 0
    s_cbranch_scc1 LP_r0A_29
    ds_read_b64_tr_b16 v[240:241], v251 offset:29568
    ds_read_b64_tr_b16 v[242:243], v251 offset:30080
    s_add_u32 s35, s47, s95
    s_add_u32 m0, s50, 21120
    s_nop 0
    buffer_load_dwordx4 v249, s[24:27], s35 offen lds
    v_mfma_f32_16x16x32_bf16 v[144:147], v[244:247], v[216:219], v[144:147]
    v_mfma_f32_16x16x32_bf16 v[148:151], v[244:247], v[220:223], v[148:151]
    v_mfma_f32_16x16x32_bf16 v[152:155], v[244:247], v[224:227], v[152:155]
    s_add_u32 s35, s47, s96
    s_add_u32 m0, s50, 25344
    v_mfma_f32_16x16x32_bf16 v[156:159], v[244:247], v[228:231], v[156:159]
    buffer_load_dwordx4 v249, s[24:27], s35 offen lds
    v_mfma_f32_16x16x32_bf16 v[160:163], v[244:247], v[232:235], v[160:163]
    v_mfma_f32_16x16x32_bf16 v[164:167], v[244:247], v[236:239], v[164:167]
    ds_read_b64_tr_b16 v[244:245], v251 offset:33792
    ds_read_b64_tr_b16 v[246:247], v251 offset:34304
    s_waitcnt lgkmcnt(2)
    v_mfma_f32_16x16x32_bf16 v[168:171], v[240:243], v[216:219], v[168:171]
    s_add_u32 m0, s52, 33792
    v_mfma_f32_16x16x32_bf16 v[172:175], v[240:243], v[220:223], v[172:175]
    buffer_load_dwordx4 v248, s[8:11], s41 offen offset:0 nt lds
    v_mfma_f32_16x16x32_bf16 v[176:179], v[240:243], v[224:227], v[176:179]
    v_mfma_f32_16x16x32_bf16 v[180:183], v[240:243], v[228:231], v[180:183]
    v_mfma_f32_16x16x32_bf16 v[184:187], v[240:243], v[232:235], v[184:187]
    s_add_u32 m0, s52, 34592
    v_mfma_f32_16x16x32_bf16 v[188:191], v[240:243], v[236:239], v[188:191]
    buffer_load_dwordx4 v248, s[8:11], s41 offen offset:256 nt lds
    s_add_u32 s41, s41, 8192
LP_jA_30:
    s_cmp_eq_u32 s99, 0
    s_cbranch_scc1 LP_th_31
    s_waitcnt vmcnt(4)
LP_th_31:
    s_waitcnt vmcnt(8) lgkmcnt(0)
    s_barrier
    s_cmp_eq_u32 s32, 0
    s_cbranch_scc1 LP_r0A_32
    ds_read_b64_tr_b16 v[240:241], v251 offset:0
    ds_read_b64_tr_b16 v[242:243], v251 offset:512
    s_add_u32 s35, s47, s97
    s_add_u32 m0, s50, 29568
    s_nop 0
    buffer_load_dwordx4 v249, s[24:27], s35 offen lds
    v_mfma_f32_16x16x32_bf16 v[192:195], v[244:247], v[216:219], v[192:195]
    ds_read_b128 v[216:219], v252 offset:6144
    v_mfma_f32_16x16x32_bf16 v[196:199], v[244:247], v[220:223], v[196:199]
    ds_read_b128 v[220:223], v252 offset:7168
    v_mfma_f32_16x16x32_bf16 v[200:203], v[244:247], v[224:227], v[200:203]
    ds_read_b128 v[224:227], v252 offset:8192
    v_mfma_f32_16x16x32_bf16 v[204:207], v[244:247], v[228:231], v[204:207]
    ds_read_b128 v[228:231], v252 offset:9216
    v_mfma_f32_16x16x32_bf16 v[208:211], v[244:247], v[232:235], v[208:211]
    ds_read_b128 v[232:235], v252 offset:10240
    s_add_u32 s35, s47, s98
    s_add_u32 m0, s50, 33792
    v_mfma_f32_16x16x32_bf16 v[212:215], v[244:247], v[236:239], v[212:215]
    ds_read_b128 v[236:239], v252 offset:11264
    ds_read_b64_tr_b16 v[244:245], v251 offset:4224
    ds_read_b64_tr_b16 v[246:247], v251 offset:4736
    buffer_load_dwordx4 v249, s[24:27], s35 offen lds
    s_add_u32 s47, s47, 36864
    v_add_u32 v252, 6144, v252
    s_waitcnt lgkmcnt(8)
    s_waitcnt lgkmcnt(6)
    v_mfma_f32_16x16x32_bf16 v[0:3], v[240:243], v[216:219], v[0:3]
    v_mfma_f32_16x16x32_bf16 v[4:7], v[240:243], v[220:223], v[4:7]
    s_waitcnt lgkmcnt(4)
    v_mfma_f32_16x16x32_bf16 v[8:11], v[240:243], v[224:227], v[8:11]
    v_mfma_f32_16x16x32_bf16 v[12:15], v[240:243], v[228:231], v[12:15]
    s_waitcnt lgkmcnt(2)
    v_mfma_f32_16x16x32_bf16 v[16:19], v[240:243], v[232:235], v[16:19]
    s_add_u32 m0, s52, 50688
    v_mfma_f32_16x16x32_bf16 v[20:23], v[240:243], v[236:239], v[20:23]
    ds_read_b64_tr_b16 v[240:241], v251 offset:8448
    ds_read_b64_tr_b16 v[242:243], v251 offset:8960
    buffer_load_dwordx4 v248, s[12:15], s42 offen offset:0 nt lds
    s_waitcnt lgkmcnt(2)
    v_mfma_f32_16x16x32_bf16 v[24:27], v[244:247], v[216:219], v[24:27]
    v_mfma_f32_16x16x32_bf16 v[28:31], v[244:247], v[220:223], v[28:31]
    v_mfma_f32_16x16x32_bf16 v[32:35], v[244:247], v[224:227], v[32:35]
    v_mfma_f32_16x16x32_bf16 v[36:39], v[244:247], v[228:231], v[36:39]
    v_mfma_f32_16x16x32_bf16 v[40:43], v[244:247], v[232:235], v[40:43]
    s_add_u32 m0, s52, 51488
    v_mfma_f32_16x16x32_bf16 v[44:47], v[244:247], v[236:239], v[44:47]
    buffer_load_dwordx4 v248, s[12:15], s42 offen offset:256 nt lds
    s_add_u32 s42, s42, 8192
LP_jA_33:
    s_cmp_eq_u32 s99, 0
    s_cbranch_scc1 LP_th_34
    s_waitcnt vmcnt(4)
LP_th_34:
    s_waitcnt vmcnt(8) lgkmcnt(0)
    s_barrier
    s_cmp_eq_u32 s32, 0
    s_cbranch_scc1 LP_r0A_35
    ds_read_b64_tr_b16 v[244:245], v251 offset:12672
    ds_read_b64_tr_b16 v[246:247], v251 offset:13184
    s_add_u32 s35, s47, s90
    s_add_u32 m0, s50, 0
    s_nop 0
    buffer_load_dwordx4 v249, s[24:27], s35 offen lds
    v_mfma_f32_16x16x32_bf16 v[48:51], v[240:243], v[216:219], v[48:51]
    v_mfma_f32_16x16x32_bf16 v[52:55], v[240:243], v[220:223], v[52:55]
    s_add_u32 s35, s47, s91
    s_add_u32 m0, s50, 4224
    v_mfma_f32_16x16x32_bf16 v[56:59], v[240:243], v[224:227], v[56:59]
    buffer_load_dwordx4 v249, s[24:27], s35 offen lds
    v_mfma_f32_16x16x32_bf16 v[60:63], v[240:243], v[228:231], v[60:63]
    v_mfma_f32_16x16x32_bf16 v[64:67], v[240:243], v[232:235], v[64:67]
    s_add_u32 s35, s47, s92
    s_add_u32 m0, s50, 8448
    v_mfma_f32_16x16x32_bf16 v[68:71], v[240:243], v[236:239], v[68:71]
    ds_read_b64_tr_b16 v[240:241], v251 offset:16896
    ds_read_b64_tr_b16 v[242:243], v251 offset:17408
    buffer_load_dwordx4 v249, s[24:27], s35 offen lds
    s_waitcnt lgkmcnt(2)
    v_mfma_f32_16x16x32_bf16 v[72:75], v[244:247], v[216:219], v[72:75]
    v_mfma_f32_16x16x32_bf16 v[76:79], v[244:247], v[220:223], v[76:79]
    s_add_u32 m0, s52, 0
    v_mfma_f32_16x16x32_bf16 v[80:83], v[244:247], v[224:227], v[80:83]
    buffer_load_dwordx4 v248, s[8:11], s41 offen offset:0 nt lds
    v_mfma_f32_16x16x32_bf16 v[84:87], v[244:247], v[228:231], v[84:87]
    v_mfma_f32_16x16x32_bf16 v[88:91], v[244:247], v[232:235], v[88:91]
    s_add_u32 m0, s52, 800
    v_mfma_f32_16x16x32_bf16 v[92:95], v[244:247], v[236:239], v[92:95]
    buffer_load_dwordx4 v248, s[8:11], s41 offen offset:256 nt lds
    s_add_u32 s41, s41, 8192
LP_jA_36:
    s_cmp_eq_u32 s99, 0
    s_cbranch_scc1 LP_th_37
    s_waitcnt vmcnt(5)
LP_th_37:
    s_waitcnt vmcnt(9) lgkmcnt(0)
    s_sub_u32 s33, s33, 1
    s_cmp_lg_u32 s33, 0
    s_cbranch_scc1 LP_TA
    s_barrier
    s_cmp_eq_u32 s32, 0
    s_cbranch_scc1 LP_r0A_38
    ds_read_b64_tr_b16 v[244:245], v251 offset:21120
    ds_read_b64_tr_b16 v[246:247], v251 offset:21632
    s_add_u32 s35, s47, s93
    s_add_u32 m0, s50, 12672
    s_nop 0
    buffer_load_dwordx4 v249, s[24:27], s35 offen lds
    v_mfma_f32_16x16x32_bf16 v[96:99], v[240:243], v[216:219], v[96:99]
    v_mfma_f32_16x16x32_bf16 v[100:103], v[240:243], v[220:223], v[100:103]
    v_mfma_f32_16x16x32_bf16 v[104:107], v[240:243], v[224:227], v[104:107]
    s_add_u32 s35, s47, s94
    s_add_u32 m0, s50, 16896
    v_mfma_f32_16x16x32_bf16 v[108:111], v[240:243], v[228:231], v[108:111]
    buffer_load_dwordx4 v249, s[24:27], s35 offen lds
    v_mfma_f32_16x16x32_bf16 v[112:115], v[240:243], v[232:235], v[112:115]
    v_mfma_f32_16x16x32_bf16 v[116:119], v[240:243], v[236:239], v[116:119]
    ds_read_b64_tr_b16 v[240:241], v251 offset:25344
    ds_read_b64_tr_b16 v[242:243], v251 offset:25856
    s_waitcnt lgkmcnt(2)
    v_mfma_f32_16x16x32_bf16 v[120:123], v[244:247], v[216:219], v[120:123]
    s_add_u32 m0, s52, 16896
    v_mfma_f32_16x16x32_bf16 v[124:127], v[244:247], v[220:223], v[124:127]
    buffer_load_dwordx4 v248, s[12:15], s42 offen offset:0 nt lds
    v_mfma_f32_16x16x32_bf16 v[128:131], v[244:247], v[224:227], v[128:131]
    v_mfma_f32_16x16x32_bf16 v[132:135], v[244:247], v[228:231], v[132:135]
    v_mfma_f32_16x16x32_bf16 v[136:139], v[244:247], v[232:235], v[136:139]
    s_add_u32 m0, s52, 17696
    v_mfma_f32_16x16x32_bf16 v[140:143], v[244:247], v[236:239], v[140:143]
    buffer_load_dwordx4 v248, s[12:15], s42 offen offset:256 nt lds
    s_add_u32 s42, s42, 8192
LP_jA_39:
    s_cmp_eq_u32 s99, 0
    s_cbranch_scc1 LP_th_40
    s_waitcnt vmcnt(4)
LP_th_40:
    s_waitcnt vmcnt(9) lgkmcnt(0)
    s_barrier
    s_cmp_eq_u32 s32, 0
    s_cbranch_scc1 LP_r0A_41
    ds_read_b64_tr_b16 v[244:245], v251 offset:29568
    ds_read_b64_tr_b16 v[246:247], v251 offset:30080
    s_add_u32 s35, s47, s95
    s_add_u32 m0, s50, 21120
    s_nop 0
    buffer_load_dwordx4 v249, s[24:27], s35 offen lds
    v_mfma_f32_16x16x32_bf16 v[144:147], v[240:243], v[216:219], v[144:147]
    v_mfma_f32_16x16x32_bf16 v[148:151], v[240:243], v[220:223], v[148:151]
    v_mfma_f32_16x16x32_bf16 v[152:155], v[240:243], v[224:227], v[152:155]
    s_add_u32 s35, s47, s96
    s_add_u32 m0, s50, 25344
    v_mfma_f32_16x16x32_bf16 v[156:159], v[240:243], v[228:231], v[156:159]
    buffer_load_dwordx4 v249, s[24:27], s35 offen lds
    v_mfma_f32_16x16x32_bf16 v[160:163], v[240:243], v[232:235], v[160:163]
    v_mfma_f32_16x16x32_bf16 v[164:167], v[240:243], v[236:239], v[164:167]
    ds_read_b64_tr_b16 v[240:241], v251 offset:33792
    ds_read_b64_tr_b16 v[242:243], v251 offset:34304
    s_waitcnt lgkmcnt(2)
    v_mfma_f32_16x16x32_bf16 v[168:171], v[244:247], v[216:219], v[168:171]
    s_add_u32 m0, s52, 33792
    v_mfma_f32_16x16x32_bf16 v[172:175], v[244:247], v[220:223], v[172:175]
    buffer_load_dwordx4 v248, s[12:15], s42 offen offset:0 nt lds
    v_mfma_f32_16x16x32_bf16 v[176:179], v[244:247], v[224:227], v[176:179]
    v_mfma_f32_16x16x32_bf16 v[180:183], v[244:247], v[228:231], v[180:183]
    v_mfma_f32_16x16x32_bf16 v[184:187], v[244:247], v[232:235], v[184:187]
    s_add_u32 m0, s52, 34592
    v_mfma_f32_16x16x32_bf16 v[188:191], v[244:247], v[236:239], v[188:191]
    buffer_load_dwordx4 v248, s[12:15], s42 offen offset:256 nt lds
    s_add_u32 s42, s42, 8192
    s_add_u32 s41, s41, s44
    s_add_u32 s42, s42, s44
LP_jA_42:
    s_cmp_eq_u32 s99, 0
    s_cbranch_scc1 LP_th_43
    s_waitcnt vmcnt(4)
LP_th_43:
    s_waitcnt vmcnt(8) lgkmcnt(0)
    s_add_u32 s34, s32, 1
    s_cmp_eq_u32 s34, 4
    s_cbranch_scc1 LP_ETA
    s_barrier
    s_cmp_eq_u32 s32, 0
    s_cbranch_scc1 LP_r0A_44
    ds_read_b64_tr_b16 v[244:245], v251 offset:0
    ds_read_b64_tr_b16 v[246:247], v251 offset:512
    s_add_u32 s35, s47, s97
    s_add_u32 m0, s50, 29568
    s_nop 0
    buffer_load_dwordx4 v249, s[24:27], s35 offen lds
    v_mfma_f32_16x16x32_bf16 v[192:195], v[240:243], v[216:219], v[192:195]
    ds_read_b128 v[216:219], v252 offset:6144
    v_mfma_f32_16x16x32_bf16 v[196:199], v[240:243], v[220:223], v[196:199]
    ds_read_b128 v[220:223], v252 offset:7168
    v_mfma_f32_16x16x32_bf16 v[200:203], v[240:243], v[224:227], v[200:203]
    ds_read_b128 v[224:227], v252 offset:8192
    v_mfma_f32_16x16x32_bf16 v[204:207], v[240:243], v[228:231], v[204:207]
    ds_read_b128 v[228:231], v252 offset:9216
    v_mfma_f32_16x16x32_bf16 v[208:211], v[240:243], v[232:235], v[208:211]
    ds_read_b128 v[232:235], v252 offset:10240
    v_mfma_f32_16x16x32_bf16 v[212:215], v[240:243], v[236:239], v[212:215]
    ds_read_b128 v[236:239], v252 offset:11264
    ds_read_b64_tr_b16 v[240:241], v251 offset:4224
    ds_read_b64_tr_b16 v[242:243], v251 offset:4736
    v_add_u32 v252, 6144, v252
    s_waitcnt lgkmcnt(8)
    s_waitcnt lgkmcnt(6)
    v_mfma_f32_16x16x32_bf16 v[0:3], v[244:247], v[216:219], v[0:3]
    v_mfma_f32_16x16x32_bf16 v[4:7], v[244:247], v[220:223], v[4:7]
    s_waitcnt lgkmcnt(4)
    v_mfma_f32_16x16x32_bf16 v[8:11], v[244:247], v[224:227], v[8:11]
    v_mfma_f32_16x16x32_bf16 v[12:15], v[244:247], v[228:231], v[12:15]
    s_waitcnt lgkmcnt(2)
    v_mfma_f32_16x16x32_bf16 v[16:19], v[244:247], v[232:235], v[16:19]
    v_mfma_f32_16x16x32_bf16 v[20:23], v[244:247], v[236:239], v[20:23]
    ds_read_b64_tr_b16 v[244:245], v251 offset:8448
    ds_read_b64_tr_b16 v[246:247], v251 offset:8960
    s_waitcnt lgkmcnt(2)
    v_mfma_f32_16x16x32_bf16 v[24:27], v[240:243], v[216:219], v[24:27]
    v_mfma_f32_16x16x32_bf16 v[28:31], v[240:243], v[220:223], v[28:31]
    v_mfma_f32_16x16x32_bf16 v[32:35], v[240:243], v[224:227], v[32:35]
    v_mfma_f32_16x16x32_bf16 v[36:39], v[240:243], v[228:231], v[36:39]
    v_mfma_f32_16x16x32_bf16 v[40:43], v[240:243], v[232:235], v[40:43]
    s_add_u32 s35, s47, s98
    s_add_u32 m0, s50, 33792
    v_mfma_f32_16x16x32_bf16 v[44:47], v[240:243], v[236:239], v[44:47]
    buffer_load_dwordx4 v249, s[24:27], s35 offen lds
    s_add_u32 s47, s47, 36864
LP_jA_45:
    s_cmp_eq_u32 s99, 0
    s_cbranch_scc1 LP_th_46
    s_waitcnt vmcnt(2)
LP_th_46:
    s_waitcnt vmcnt(6) lgkmcnt(0)
    s_barrier
    s_cmp_eq_u32 s32, 0
    s_cbranch_scc1 LP_r0A_47
    ds_read_b64_tr_b16 v[240:241], v251 offset:12672
    ds_read_b64_tr_b16 v[242:243], v251 offset:13184
    s_add_u32 s35, s46, 0
    s_add_u32 m0, s45, 0
    s_nop 0
    buffer_load_dwordx4 v250, s[20:23], s35 offen lds
    v_mfma_f32_16x16x32_bf16 v[48:51], v[244:247], v[216:219], v[48:51]
    s_add_u32 s35, s46, 8192
    s_add_u32 m0, s45, 1032
    v_mfma_f32_16x16x32_bf16 v[52:55], v[244:247], v[220:223], v[52:55]
    buffer_load_dwordx4 v250, s[20:23], s35 offen lds
    v_mfma_f32_16x16x32_bf16 v[56:59], v[244:247], v[224:227], v[56:59]
    s_add_u32 s35, s46, 16384
    s_add_u32 m0, s45, 2112
    v_mfma_f32_16x16x32_bf16 v[60:63], v[244:247], v[228:231], v[60:63]
    buffer_load_dwordx4 v250, s[20:23], s35 offen lds
    v_mfma_f32_16x16x32_bf16 v[64:67], v[244:247], v[232:235], v[64:67]
    s_add_u32 s35, s46, 24576
    s_add_u32 m0, s45, 3144
    v_mfma_f32_16x16x32_bf16 v[68:71], v[244:247], v[236:239], v[68:71]
    ds_read_b64_tr_b16 v[244:245], v251 offset:16896
    ds_read_b64_tr_b16 v[246:247], v251 offset:17408
    buffer_load_dwordx4 v250, s[20:23], s35 offen lds
    s_add_u32 s46, s46, 262144
    s_waitcnt lgkmcnt(2)
    v_mfma_f32_16x16x32_bf16 v[72:75], v[240:243], v[216:219], v[72:75]
    s_add_u32 s35, s43, 0
    s_add_u32 m0, s50, 0
    v_mfma_f32_16x16x32_bf16 v[76:79], v[240:243], v[220:223], v[76:79]
    buffer_load_dwordx4 v249, s[16:19], s35 offen lds
    v_mfma_f32_16x16x32_bf16 v[80:83], v[240:243], v[224:227], v[80:83]
    s_add_u32 s35, s43, 36864
    s_add_u32 m0, s50, 4224
    v_mfma_f32_16x16x32_bf16 v[84:87], v[240:243], v[228:231], v[84:87]
    buffer_load_dwordx4 v249, s[16:19], s35 offen lds
    v_mfma_f32_16x16x32_bf16 v[88:91], v[240:243], v[232:235], v[88:91]
    s_add_u32 s35, s43, 73728
    s_add_u32 m0, s50, 8448
    v_mfma_f32_16x16x32_bf16 v[92:95], v[240:243], v[236:239], v[92:95]
    buffer_load_dwordx4 v249, s[16:19], s35 offen lds
    s_add_u32 s43, s43, 128
LP_jA_48:
    s_waitcnt vmcnt(7) lgkmcnt(0)
    s_barrier
    s_cmp_eq_u32 s32, 0
    s_cbranch_scc1 LP_r0A_49
    ds_read_b64_tr_b16 v[240:241], v251 offset:21120
    ds_read_b64_tr_b16 v[242:243], v251 offset:21632
    s_add_u32 s35, s46, 0
    s_add_u32 m0, s45, 16896
    s_nop 0
    buffer_load_dwordx4 v250, s[20:23], s35 offen lds
    v_mfma_f32_16x16x32_bf16 v[96:99], v[244:247], v[216:219], v[96:99]
    v_mfma_f32_16x16x32_bf16 v[100:103], v[244:247], v[220:223], v[100:103]
    v_mfma_f32_16x16x32_bf16 v[104:107], v[244:247], v[224:227], v[104:107]
    v_mfma_f32_16x16x32_bf16 v[108:111], v[244:247], v[228:231], v[108:111]
    v_mfma_f32_16x16x32_bf16 v[112:115], v[244:247], v[232:235], v[112:115]
    v_mfma_f32_16x16x32_bf16 v[116:119], v[244:247], v[236:239], v[116:119]
    ds_read_b64_tr_b16 v[244:245], v251 offset:25344
    ds_read_b64_tr_b16 v[246:247], v251 offset:25856
    s_waitcnt lgkmcnt(2)
    v_mfma_f32_16x16x32_bf16 v[120:123], v[240:243], v[216:219], v[120:123]
    v_mfma_f32_16x16x32_bf16 v[124:127], v[240:243], v[220:223], v[124:127]
    v_mfma_f32_16x16x32_bf16 v[128:131], v[240:243], v[224:227], v[128:131]
    s_add_u32 s35, s46, 8192
    s_add_u32 m0, s45, 17928
    v_mfma_f32_16x16x32_bf16 v[132:135], v[240:243], v[228:231], v[132:135]
    buffer_load_dwordx4 v250, s[20:23], s35 offen lds
    v_mfma_f32_16x16x32_bf16 v[136:139], v[240:243], v[232:235], v[136:139]
    v_mfma_f32_16x16x32_bf16 v[140:143], v[240:243], v[236:239], v[140:143]
    ds_read_b64_tr_b16 v[240:241], v251 offset:29568
    ds_read_b64_tr_b16 v[242:243], v251 offset:30080
    s_waitcnt lgkmcnt(2)
    v_mfma_f32_16x16x32_bf16 v[144:147], v[244:247], v[216:219], v[144:147]
    v_mfma_f32_16x16x32_bf16 v[148:151], v[244:247], v[220:223], v[148:151]
    v_mfma_f32_16x16x32_bf16 v[152:155], v[244:247], v[224:227], v[152:155]
    v_mfma_f32_16x16x32_bf16 v[156:159], v[244:247], v[228:231], v[156:159]
    v_mfma_f32_16x16x32_bf16 v[160:163], v[244:247], v[232:235], v[160:163]
    v_mfma_f32_16x16x32_bf16 v[164:167], v[244:247], v[236:239], v[164:167]
    ds_read_b64_tr_b16 v[244:245], v251 offset:33792
    ds_read_b64_tr_b16 v[246:247], v251 offset:34304
    s_waitcnt lgkmcnt(2)
    v_mfma_f32_16x16x32_bf16 v[168:171], v[240:243], v[216:219], v[168:171]
    s_add_u32 s35, s46, 16384
    s_add_u32 m0, s45, 19008
    v_mfma_f32_16x16x32_bf16 v[172:175], v[240:243], v[220:223], v[172:175]
    buffer_load_dwordx4 v250, s[20:23], s35 offen lds
    v_mfma_f32_16x16x32_bf16 v[176:179], v[240:243], v[224:227], v[176:179]
    v_mfma_f32_16x16x32_bf16 v[180:183], v[240:243], v[228:231], v[180:183]
    v_mfma_f32_16x16x32_bf16 v[184:187], v[240:243], v[232:235], v[184:187]
    v_mfma_f32_16x16x32_bf16 v[188:191], v[240:243], v[236:239], v[188:191]
    s_waitcnt lgkmcnt(0)
    v_mfma_f32_16x16x32_bf16 v[192:195], v[244:247], v[216:219], v[192:195]
    v_mfma_f32_16x16x32_bf16 v[196:199], v[244:247], v[220:223], v[196:199]
    v_mfma_f32_16x16x32_bf16 v[200:203], v[244:247], v[224:227], v[200:203]
    v_mfma_f32_16x16x32_bf16 v[204:207], v[244:247], v[228:231], v[204:207]
    v_mfma_f32_16x16x32_bf16 v[208:211], v[244:247], v[232:235], v[208:211]
    s_add_u32 s35, s46, 24576
    s_add_u32 m0, s45, 20040
    v_mfma_f32_16x16x32_bf16 v[212:215], v[244:247], v[236:239], v[212:215]
    buffer_load_dwordx4 v250, s[20:23], s35 offen lds
    s_add_u32 s46, s46, 262144
LP_jA_50:
    s_waitcnt vmcnt(4) lgkmcnt(0)
    s_add_u32 s32, s32, 1
    s_branch LP_ROUNDA
LP_ETA:
    s_barrier
    s_cmp_eq_u32 s32, 0
    s_cbranch_scc1 LP_r0A_51
    ds_read_b64_tr_b16 v[244:245], v251 offset:0
    ds_read_b64_tr_b16 v[246:247], v251 offset:512
    s_add_u32 s35, s47, s97
    s_add_u32 m0, s50, 29568
    s_nop 0
    buffer_load_dwordx4 v249, s[24:27], s35 offen lds
    v_mfma_f32_16x16x32_bf16 v[192:195], v[240:243], v[216:219], v[192:195]
    ds_read_b128 v[216:219], v252 offset:6144
    v_mfma_f32_16x16x32_bf16 v[196:199], v[240:243], v[220:223], v[196:199]
    ds_read_b128 v[220:223], v252 offset:7168
    v_mfma_f32_16x16x32_bf16 v[200:203], v[240:243], v[224:227], v[200:203]
    ds_read_b128 v[224:227], v252 offset:8192
    s_add_u32 s35, s47, s98
    s_add_u32 m0, s50, 33792
    v_mfma_f32_16x16x32_bf16 v[204:207], v[240:243], v[228:231], v[204:207]
    ds_read_b128 v[228:231], v252 offset:9216
    buffer_load_dwordx4 v249, s[24:27], s35 offen lds
    s_add_u32 s47, s47, 36864
    v_mfma_f32_16x16x32_bf16 v[208:211], v[240:243], v[232:235], v[208:211]
    ds_read_b128 v[232:235], v252 offset:10240
    v_mfma_f32_16x16x32_bf16 v[212:215], v[240:243], v[236:239], v[212:215]
    ds_read_b128 v[236:239], v252 offset:11264
    ds_read_b64_tr_b16 v[240:241], v251 offset:4224
    ds_read_b64_tr_b16 v[242:243], v251 offset:4736
    v_add_u32 v252, 6144, v252
    s_waitcnt lgkmcnt(8)
    s_add_u32 s35, s47, s95
    s_add_u32 m0, s50, 88704
    s_waitcnt lgkmcnt(6)
    v_mfma_f32_16x16x32_bf16 v[0:3], v[244:247], v[216:219], v[0:3]
    buffer_load_dwordx4 v249, s[24:27], s35 offen lds
    v_mfma_f32_16x16x32_bf16 v[4:7], v[244:247], v[220:223], v[4:7]
    s_waitcnt lgkmcnt(4)
    v_mfma_f32_16x16x32_bf16 v[8:11], v[244:247], v[224:227], v[8:11]
    v_mfma_f32_16x16x32_bf16 v[12:15], v[244:247], v[228:231], v[12:15]
    s_add_u32 s35, s47, s96
    s_add_u32 m0, s50, 92928
    s_waitcnt lgkmcnt(2)
    v_mfma_f32_16x16x32_bf16 v[16:19], v[244:247], v[232:235], v[16:19]
    buffer_load_dwordx4 v249, s[24:27], s35 offen lds
    v_mfma_f32_16x16x32_bf16 v[20:23], v[244:247], v[236:239], v[20:23]
    ds_read_b64_tr_b16 v[244:245], v251 offset:8448
    ds_read_b64_tr_b16 v[246:247], v251 offset:8960
    s_waitcnt lgkmcnt(2)
    v_mfma_f32_16x16x32_bf16 v[24:27], v[240:243], v[216:219], v[24:27]
    s_add_u32 s35, s47, s97
    s_add_u32 m0, s50, 97152
    v_mfma_f32_16x16x32_bf16 v[28:31], v[240:243], v[220:223], v[28:31]
    buffer_load_dwordx4 v249, s[24:27], s35 offen lds
    v_mfma_f32_16x16x32_bf16 v[32:35], v[240:243], v[224:227], v[32:35]
    v_mfma_f32_16x16x32_bf16 v[36:39], v[240:243], v[228:231], v[36:39]
    v_mfma_f32_16x16x32_bf16 v[40:43], v[240:243], v[232:235], v[40:43]
    s_add_u32 s35, s47, s98
    s_add_u32 m0, s50, 101376
    v_mfma_f32_16x16x32_bf16 v[44:47], v[240:243], v[236:239], v[44:47]
    buffer_load_dwordx4 v249, s[24:27], s35 offen lds
LP_jA_52:
    s_cmp_eq_u32 s99, 0
    s_cbranch_scc1 LP_th_53
    s_waitcnt vmcnt(6)
LP_th_53:
    s_waitcnt vmcnt(10) lgkmcnt(0)
    s_barrier
    s_cmp_eq_u32 s32, 0
    s_cbranch_scc1 LP_r0A_54
    ds_read_b64_tr_b16 v[240:241], v251 offset:12672
    ds_read_b64_tr_b16 v[242:243], v251 offset:13184
    s_add_u32 s35, s47, s90
    s_add_u32 m0, s50, 0
    s_nop 0
    buffer_load_dwordx4 v249, s[24:27], s35 offen lds
    v_mfma_f32_16x16x32_bf16 v[48:51], v[244:247], v[216:219], v[48:51]
    v_mfma_f32_16x16x32_bf16 v[52:55], v[244:247], v[220:223], v[52:55]
    v_mfma_f32_16x16x32_bf16 v[56:59], v[244:247], v[224:227], v[56:59]
    v_mfma_f32_16x16x32_bf16 v[60:63], v[244:247], v[228:231], v[60:63]
    v_mfma_f32_16x16x32_bf16 v[64:67], v[244:247], v[232:235], v[64:67]
    s_add_u32 s35, s47, s91
    s_add_u32 m0, s50, 4224
    v_mfma_f32_16x16x32_bf16 v[68:71], v[244:247], v[236:239], v[68:71]
    ds_read_b64_tr_b16 v[244:245], v251 offset:16896
    ds_read_b64_tr_b16 v[246:247], v251 offset:17408
    buffer_load_dwordx4 v249, s[24:27], s35 offen lds
    s_waitcnt lgkmcnt(2)
    v_mfma_f32_16x16x32_bf16 v[72:75], v[240:243], v[216:219], v[72:75]
    v_mfma_f32_16x16x32_bf16 v[76:79], v[240:243], v[220:223], v[76:79]
    v_mfma_f32_16x16x32_bf16 v[80:83], v[240:243], v[224:227], v[80:83]
    v_mfma_f32_16x16x32_bf16 v[84:87], v[240:243], v[228:231], v[84:87]
    v_mfma_f32_16x16x32_bf16 v[88:91], v[240:243], v[232:235], v[88:91]
    s_add_u32 s35, s47, s92
    s_add_u32 m0, s50, 8448
    v_mfma_f32_16x16x32_bf16 v[92:95], v[240:243], v[236:239], v[92:95]
    buffer_load_dwordx4 v249, s[24:27], s35 offen lds
LP_jA_55:
    s_waitcnt vmcnt(7) lgkmcnt(0)
    s_barrier
    s_cmp_eq_u32 s32, 0
    s_cbranch_scc1 LP_r0A_56
    ds_read_b64_tr_b16 v[240:241], v251 offset:21120
    ds_read_b64_tr_b16 v[242:243], v251 offset:21632
    s_add_u32 s35, s47, s93
    s_add_u32 m0, s50, 12672
    s_nop 0
    buffer_load_dwordx4 v249, s[24:27], s35 offen lds
    v_mfma_f32_16x16x32_bf16 v[96:99], v[244:247], v[216:219], v[96:99]
    v_mfma_f32_16x16x32_bf16 v[100:103], v[244:247], v[220:223], v[100:103]
    v_mfma_f32_16x16x32_bf16 v[104:107], v[244:247], v[224:227], v[104:107]
    v_mfma_f32_16x16x32_bf16 v[108:111], v[244:247], v[228:231], v[108:111]
    v_mfma_f32_16x16x32_bf16 v[112:115], v[244:247], v[232:235], v[112:115]
    v_mfma_f32_16x16x32_bf16 v[116:119], v[244:247], v[236:239], v[116:119]
    ds_read_b64_tr_b16 v[244:245], v251 offset:25344
    ds_read_b64_tr_b16 v[246:247], v251 offset:25856
    s_waitcnt lgkmcnt(2)
    v_mfma_f32_16x16x32_bf16 v[120:123], v[240:243], v[216:219], v[120:123]
    v_mfma_f32_16x16x32_bf16 v[124:127], v[240:243], v[220:223], v[124:127]
    v_mfma_f32_16x16x32_bf16 v[128:131], v[240:243], v[224:227], v[128:131]
    v_mfma_f32_16x16x32_bf16 v[132:135], v[240:243], v[228:231], v[132:135]
    v_mfma_f32_16x16x32_bf16 v[136:139], v[240:243], v[232:235], v[136:139]
    v_mfma_f32_16x16x32_bf16 v[140:143], v[240:243], v[236:239], v[140:143]
    ds_read_b64_tr_b16 v[240:241], v251 offset:29568
    ds_read_b64_tr_b16 v[242:243], v251 offset:30080
    s_waitcnt lgkmcnt(2)
    v_mfma_f32_16x16x32_bf16 v[144:147], v[244:247], v[216:219], v[144:147]
    v_mfma_f32_16x16x32_bf16 v[148:151], v[244:247], v[220:223], v[148:151]
    v_mfma_f32_16x16x32_bf16 v[152:155], v[244:247], v[224:227], v[152:155]
    v_mfma_f32_16x16x32_bf16 v[156:159], v[244:247], v[228:231], v[156:159]
    v_mfma_f32_16x16x32_bf16 v[160:163], v[244:247], v[232:235], v[160:163]
    v_mfma_f32_16x16x32_bf16 v[164:167], v[244:247], v[236:239], v[164:167]
    ds_read_b64_tr_b16 v[244:245], v251 offset:33792
    ds_read_b64_tr_b16 v[246:247], v251 offset:34304
    s_waitcnt lgkmcnt(2)
    v_mfma_f32_16x16x32_bf16 v[168:171], v[240:243], v[216:219], v[168:171]
    v_mfma_f32_16x16x32_bf16 v[172:175], v[240:243], v[220:223], v[172:175]
    v_mfma_f32_16x16x32_bf16 v[176:179], v[240:243], v[224:227], v[176:179]
    v_mfma_f32_16x16x32_bf16 v[180:183], v[240:243], v[228:231], v[180:183]
    v_mfma_f32_16x16x32_bf16 v[184:187], v[240:243], v[232:235], v[184:187]
    v_mfma_f32_16x16x32_bf16 v[188:191], v[240:243], v[236:239], v[188:191]
    s_waitcnt lgkmcnt(0)
    v_mfma_f32_16x16x32_bf16 v[192:195], v[244:247], v[216:219], v[192:195]
    v_mfma_f32_16x16x32_bf16 v[196:199], v[244:247], v[220:223], v[196:199]
    v_mfma_f32_16x16x32_bf16 v[200:203], v[244:247], v[224:227], v[200:203]
    v_mfma_f32_16x16x32_bf16 v[204:207], v[244:247], v[228:231], v[204:207]
    v_mfma_f32_16x16x32_bf16 v[208:211], v[244:247], v[232:235], v[208:211]
    s_add_u32 s35, s47, s94
    s_add_u32 m0, s50, 16896
    v_mfma_f32_16x16x32_bf16 v[212:215], v[244:247], v[236:239], v[212:215]
    buffer_load_dwordx4 v249, s[24:27], s35 offen lds
LP_jA_57:
    s_waitcnt vmcnt(0) lgkmcnt(0)
    s_barrier
    s_branch LP_TAIL0
LP_B:
    s_setprio 0
    s_mov_b32 s45, s76
    s_mov_b32 s50, s77
    s_add_u32 s46, s75, 524288
    s_mov_b32 s43, 128
    s_mov_b32 s47, 0
    s_mov_b32 s41, 0
    s_mov_b32 s42, 0
    s_lshr_b32 s35, s36, 1
    s_lshl_b32 s34, s37, 7
    s_mov_b32 s44, 131072
    s_mov_b32 s52, s45
    s_lshl_b32 s35, s35, 17
    s_add_u32 s34, s34, s35
    v_lshlrev_b32 v248, 10, v240
    v_add3_u32 v248, v248, v241, s34
    v_and_b32 v240, 3, v252
    v_mul_u32_u24 v240, 1056, v240
    v_bfe_u32 v241, v252, 2, 2
    v_lshrrev_b32 v242, 4, v252
    v_mul_u32_u24 v251, 1056, v241
    v_lshl_add_u32 v251, v242, 7, v251
    v_and_b32 v240, 3, v252
    v_lshl_add_u32 v251, v240, 3, v251
    s_lshl_b32 s34, s36, 5
    s_add_u32 s34, s34, 640
    v_add_u32 v251, s34, v251
    v_lshlrev_b32 v253, 4, v252
    v_add_u32 v253, 106240, v253
    s_waitcnt vmcnt(4)
    s_mov_b32 s32, 0
LP_ROUNDB:
    s_barrier
    s_add_u32 s35, s46, 0
    s_add_u32 m0, s45, 33792
    s_nop 0
    buffer_load_dwordx4 v250, s[20:23], s35 offen lds
    s_add_u32 s35, s46, 8192
    s_add_u32 m0, s45, 34824
    s_nop 0
    buffer_load_dwordx4 v250, s[20:23], s35 offen lds
    s_add_u32 s35, s46, 16384
    s_add_u32 m0, s45, 35904
    s_nop 0
    buffer_load_dwordx4 v250, s[20:23], s35 offen lds
    s_add_u32 s35, s46, 24576
    s_add_u32 m0, s45, 36936
    s_nop 0
    buffer_load_dwordx4 v250, s[20:23], s35 offen lds
    s_add_u32 s46, s46, 262144
    s_add_u32 s35, s43, 0
    s_add_u32 m0, s50, 12672
    s_nop 0
    buffer_load_dwordx4 v249, s[16:19], s35 offen lds
    s_add_u32 s35, s43, 36864
    s_add_u32 m0, s50, 16896
    s_nop 0
    buffer_load_dwordx4 v249, s[16:19], s35 offen lds
    s_add_u32 s35, s43, 73728
    s_add_u32 m0, s50, 21120
    s_nop 0
    buffer_load_dwordx4 v249, s[16:19], s35 offen lds
    s_add_u32 s43, s43, 128
    s_add_u32 s35, s43, 0
    s_add_u32 m0, s50, 25344
    s_nop 0
    buffer_load_dwordx4 v249, s[16:19], s35 offen lds
    s_add_u32 s35, s43, 36864
    s_add_u32 m0, s50, 29568
    s_nop 0
    buffer_load_dwordx4 v249, s[16:19], s35 offen lds
    s_add_u32 s35, s43, 73728
    s_add_u32 m0, s50, 33792
    s_nop 0
    buffer_load_dwordx4 v249, s[16:19], s35 offen lds
    s_add_u32 s43, s43, 128
    s_waitcnt vmcnt(10) lgkmcnt(0)
    s_barrier
    s_add_u32 s35, s46, 0
    s_add_u32 m0, s45, 0
    s_nop 0
    buffer_load_dwordx4 v250, s[20:23], s35 offen lds
    s_add_u32 s35, s46, 8192
    s_add_u32 m0, s45, 1032
    s_nop 0
    buffer_load_dwordx4 v250, s[20:23], s35 offen lds
    s_add_u32 s35, s46, 16384
    s_add_u32 m0, s45, 2112
    s_nop 0
    buffer_load_dwordx4 v250, s[20:23], s35 offen lds
    s_add_u32 s35, s46, 24576
    s_add_u32 m0, s45, 3144
    s_nop 0
    buffer_load_dwordx4 v250, s[20:23], s35 offen lds
    s_add_u32 s46, s46, 262144
    s_waitcnt vmcnt(7) lgkmcnt(0)
    s_barrier
    v_mov_b32 v252, v253
    s_cmp_eq_u32 s32, 0
    s_cselect_b32 s26, 0, 1179648
    s_sub_u32 s47, s32, 1
    s_max_i32 s47, s47, 0
    s_mul_i32 s47, s47, 294912
    s_cmp_lg_u32 s32, 1
    s_cbranch_scc1 LP_n0B_58
    s_mov_b32 s28, s72
    s_and_b32 s29, s73, 0xffff
    s_mov_b32 s30, 256
    s_mov_b32 s31, 0x20000
    v_mov_b32 v234, 0
    buffer_load_dwordx2 v[232:233], v234, s[28:31], 0 offen
LP_n0B_58:
    s_add_u32 s35, s46, 0
    s_add_u32 m0, s45, 16896
    s_nop 0
    buffer_load_dwordx4 v250, s[20:23], s35 offen lds
    s_add_u32 s35, s46, 8192
    s_add_u32 m0, s45, 17928
    s_nop 0
    buffer_load_dwordx4 v250, s[20:23], s35 offen lds
    s_add_u32 s35, s46, 16384
    s_add_u32 m0, s45, 19008
    s_nop 0
    buffer_load_dwordx4 v250, s[20:23], s35 offen lds
    s_add_u32 s35, s46, 24576
    s_add_u32 m0, s45, 20040
    s_nop 0
    buffer_load_dwordx4 v250, s[20:23], s35 offen lds
    s_add_u32 s46, s46, 262144
    s_add_u32 s35, s43, 0
    s_add_u32 m0, s50, 0
    s_nop 0
    buffer_load_dwordx4 v249, s[16:19], s35 offen lds
    s_add_u32 s35, s43, 36864
    s_add_u32 m0, s50, 4224
    s_nop 0
    buffer_load_dwordx4 v249, s[16:19], s35 offen lds
    s_add_u32 s35, s43, 73728
    s_add_u32 m0, s50, 8448
    s_nop 0
    buffer_load_dwordx4 v249, s[16:19], s35 offen lds
    s_add_u32 s43, s43, 128
    s_waitcnt vmcnt(7) lgkmcnt(0)
    s_barrier
    s_add_u32 s35, s46, 0
    s_add_u32 m0, s45, 33792
    s_nop 0
    buffer_load_dwordx4 v250, s[20:23], s35 offen lds
    s_add_u32 s35, s46, 8192
    s_add_u32 m0, s45, 34824
    s_nop 0
    buffer_load_dwordx4 v250, s[20:23], s35 offen lds
    s_add_u32 s35, s46, 16384
    s_add_u32 m0, s45, 35904
    s_nop 0
    buffer_load_dwordx4 v250, s[20:23], s35 offen lds
    s_add_u32 s35, s46, 24576
    s_add_u32 m0, s45, 36936
    s_nop 0
    buffer_load_dwordx4 v250, s[20:23], s35 offen lds
    s_add_u32 s46, s46, 262144
    s_cmp_eq_u32 s32, 0
    s_cbranch_scc1 LP_zB_59
LP_zB_59_r:
    s_waitcnt vmcnt(7) lgkmcnt(0)
    s_barrier
    s_add_u32 s35, s46, 0
    s_add_u32 m0, s45, 0
    s_nop 0
    buffer_load_dwordx4 v250, s[20:23], s35 offen lds
    s_add_u32 s35, s46, 8192
    s_add_u32 m0, s45, 1032
    s_nop 0
    buffer_load_dwordx4 v250, s[20:23], s35 offen lds
    s_add_u32 s35, s46, 16384
    s_add_u32 m0, s45, 2112
    s_nop 0
    buffer_load_dwordx4 v250, s[20:23], s35 offen lds
    s_add_u32 s35, s46, 24576
    s_add_u32 m0, s45, 3144
    s_nop 0
    buffer_load_dwordx4 v250, s[20:23], s35 offen lds
    s_add_u32 s46, s46, 262144
    s_add_u32 s35, s43, 0
    s_add_u32 m0, s50, 12672
    s_nop 0
    buffer_load_dwordx4 v249, s[16:19], s35 offen lds
    s_add_u32 s35, s43, 36864
    s_add_u32 m0, s50, 16896
    s_nop 0
    buffer_load_dwordx4 v249, s[16:19], s35 offen lds
    s_add_u32 s35, s43, 73728
    s_add_u32 m0, s50, 21120
    s_nop 0
    buffer_load_dwordx4 v249, s[16:19], s35 offen lds
    s_add_u32 s43, s43, 128
    s_waitcnt vmcnt(7) lgkmcnt(0)
    s_barrier
    s_add_u32 s35, s46, 0
    s_add_u32 m0, s45, 16896
    s_nop 0
    buffer_load_dwordx4 v250, s[20:23], s35 offen lds
    s_add_u32 s35, s46, 8192
    s_add_u32 m0, s45, 17928
    s_nop 0
    buffer_load_dwordx4 v250, s[20:23], s35 offen lds
    s_add_u32 s35, s46, 16384
    s_add_u32 m0, s45, 19008
    s_nop 0
    buffer_load_dwordx4 v250, s[20:23], s35 offen lds
    s_add_u32 s35, s46, 24576
    s_add_u32 m0, s45, 20040
    s_nop 0
    buffer_load_dwordx4 v250, s[20:23], s35 offen lds
    s_add_u32 s46, s46, 262144
    s_cmp_eq_u32 s32, 0
    s_cbranch_scc1 LP_zB_60
LP_zB_60_r:
    s_waitcnt vmcnt(7) lgkmcnt(0)
    s_barrier
    s_cmp_lg_u32 s32, 1
    s_cbranch_scc1 LP_ngB_61
    v_readfirstlane_b32 s84, v232
    v_readfirstlane_b32 s85, v233
    s_nop 1
    s_cmp_lg_u32 s84, 0
    s_cbranch_scc1 LP_ngB_61
    s_mov_b32 s28, s72
    s_and_b32 s29, s73, 0xffff
    s_mov_b32 s30, 256
    s_mov_b32 s31, 0x20000
    v_mov_b32 v234, 0
    s_mov_b32 s40, 200000
    buffer_load_dwordx2 v[232:233], v234, s[28:31], 0 offen
    s_waitcnt vmcnt(0)
    v_readfirstlane_b32 s84, v232
    v_readfirstlane_b32 s85, v233
    s_nop 1
    s_cmp_lg_u32 s84, 0
    s_cbranch_scc1 LP_ngB_61_g_ok
LP_ngB_61_g:
    buffer_load_dwordx2 v[232:233], v234, s[28:31], 0 offen sc1
    s_waitcnt vmcnt(0)
    v_readfirstlane_b32 s84, v232
    v_readfirstlane_b32 s85, v233
    s_nop 1
    s_cmp_lg_u32 s84, 0
    s_cbranch_scc1 LP_ngB_61_g_ok
    s_sleep 8
    s_sub_u32 s40, s40, 1
    s_cmp_lg_u32 s40, 0
    s_cbranch_scc1 LP_ngB_61_g
LP_ngB_61_g_ok:
LP_ngB_61:
    s_add_u32 s35, s46, 0
    s_add_u32 m0, s45, 33792
    s_nop 0
    buffer_load_dwordx4 v250, s[20:23], s35 offen lds
    s_add_u32 s35, s46, 8192
    s_add_u32 m0, s45, 34824
    s_nop 0
    buffer_load_dwordx4 v250, s[20:23], s35 offen lds
    s_add_u32 s35, s46, 16384
    s_add_u32 m0, s45, 35904
    s_nop 0
    buffer_load_dwordx4 v250, s[20:23], s35 offen lds
    s_add_u32 s35, s46, 24576
    s_add_u32 m0, s45, 36936
    s_nop 0
    buffer_load_dwordx4 v250, s[20:23], s35 offen lds
    s_add_u32 s46, s46, 262144
    s_add_u32 s35, s43, 0
    s_add_u32 m0, s50, 25344
    s_nop 0
    buffer_load_dwordx4 v249, s[16:19], s35 offen lds
    s_add_u32 s35, s43, 36864
    s_add_u32 m0, s50, 29568
    s_nop 0
    buffer_load_dwordx4 v249, s[16:19], s35 offen lds
    s_add_u32 s35, s43, 73728
    s_add_u32 m0, s50, 33792
    s_nop 0
    buffer_load_dwordx4 v249, s[16:19], s35 offen lds
    s_add_u32 s43, s43, 128
    s_waitcnt vmcnt(7) lgkmcnt(0)
    s_barrier
    s_add_u32 s35, s46, 0
    s_add_u32 m0, s45, 0
    s_nop 0
    buffer_load_dwordx4 v250, s[20:23], s35 offen lds
    s_add_u32 s35, s46, 8192
    s_add_u32 m0, s45, 1032
    s_nop 0
    buffer_load_dwordx4 v250, s[20:23], s35 offen lds
    s_add_u32 s35, s46, 16384
    s_add_u32 m0, s45, 2112
    s_nop 0
    buffer_load_dwordx4 v250, s[20:23], s35 offen lds
    s_add_u32 s35, s46, 24576
    s_add_u32 m0, s45, 3144
    s_nop 0
    buffer_load_dwordx4 v250, s[20:23], s35 offen lds
    s_add_u32 s46, s46, 262144
    s_cmp_eq_u32 s32, 0
    s_cbranch_scc1 LP_zB_62
LP_zB_62_r:
    s_waitcnt vmcnt(7) lgkmcnt(0)
    s_barrier
    s_add_u32 s35, s46, 0
    s_add_u32 m0, s45, 16896
    s_nop 0
    buffer_load_dwordx4 v250, s[20:23], s35 offen lds
    s_add_u32 s35, s46, 8192
    s_add_u32 m0, s45, 17928
    s_nop 0
    buffer_load_dwordx4 v250, s[20:23], s35 offen lds
    s_add_u32 s35, s46, 16384
    s_add_u32 m0, s45, 19008
    s_nop 0
    buffer_load_dwordx4 v250, s[20:23], s35 offen lds
    s_add_u32 s35, s46, 24576
    s_add_u32 m0, s45, 20040
    s_nop 0
    buffer_load_dwordx4 v250, s[20:23], s35 offen lds
    s_add_u32 s46, s46, 262144
    s_add_u32 s35, s43, 0
    s_add_u32 m0, s50, 0
    s_nop 0
    buffer_load_dwordx4 v249, s[16:19], s35 offen lds
    s_add_u32 s35, s43, 36864
    s_add_u32 m0, s50, 4224
    s_nop 0
    buffer_load_dwordx4 v249, s[16:19], s35 offen lds
    s_add_u32 s35, s43, 73728
    s_add_u32 m0, s50, 8448
    s_nop 0
    buffer_load_dwordx4 v249, s[16:19], s35 offen lds
    s_add_u32 s43, s43, 128
    s_waitcnt vmcnt(7) lgkmcnt(0)
    s_barrier
    s_add_u32 s35, s46, 0
    s_add_u32 m0, s45, 33792
    s_nop 0
    buffer_load_dwordx4 v250, s[20:23], s35 offen lds
    s_add_u32 s35, s46, 8192
    s_add_u32 m0, s45, 34824
    s_nop 0
    buffer_load_dwordx4 v250, s[20:23], s35 offen lds
    s_add_u32 s35, s46, 16384
    s_add_u32 m0, s45, 35904
    s_nop 0
    buffer_load_dwordx4 v250, s[20:23], s35 offen lds
    s_add_u32 s35, s46, 24576
    s_add_u32 m0, s45, 36936
    s_nop 0
    buffer_load_dwordx4 v250, s[20:23], s35 offen lds
    s_add_u32 s46, s46, 262144
    s_cmp_eq_u32 s32, 0
    s_cbranch_scc1 LP_zB_63
LP_zB_63_r:
    s_waitcnt vmcnt(7) lgkmcnt(0)
    s_barrier
    s_add_u32 s35, s46, 0
    s_add_u32 m0, s45, 0
    s_nop 0
    buffer_load_dwordx4 v250, s[20:23], s35 offen lds
    s_add_u32 s35, s46, 8192
    s_add_u32 m0, s45, 1032
    s_nop 0
    buffer_load_dwordx4 v250, s[20:23], s35 offen lds
    s_add_u32 s35, s46, 16384
    s_add_u32 m0, s45, 2112
    s_nop 0
    buffer_load_dwordx4 v250, s[20:23], s35 offen lds
    s_add_u32 s35, s46, 24576
    s_add_u32 m0, s45, 3144
    s_nop 0
    buffer_load_dwordx4 v250, s[20:23], s35 offen lds
    s_add_u32 s46, s46, 262144
    s_add_u32 s35, s43, 0
    s_add_u32 m0, s50, 12672
    s_nop 0
    buffer_load_dwordx4 v249, s[16:19], s35 offen lds
    s_add_u32 s35, s43, 36864
    s_add_u32 m0, s50, 16896
    s_nop 0
    buffer_load_dwordx4 v249, s[16:19], s35 offen lds
    s_add_u32 s35, s43, 73728
    s_add_u32 m0, s50, 21120
    s_nop 0
    buffer_load_dwordx4 v249, s[16:19], s35 offen lds
    s_add_u32 s43, s43, 128
    s_waitcnt vmcnt(7) lgkmcnt(0)
    s_barrier
    s_add_u32 s35, s46, 0
    s_add_u32 m0, s45, 16896
    s_nop 0
    buffer_load_dwordx4 v250, s[20:23], s35 offen lds
    s_add_u32 s35, s46, 8192
    s_add_u32 m0, s45, 17928
    s_nop 0
    buffer_load_dwordx4 v250, s[20:23], s35 offen lds
    s_add_u32 s35, s46, 16384
    s_add_u32 m0, s45, 19008
    s_nop 0
    buffer_load_dwordx4 v250, s[20:23], s35 offen lds
    s_add_u32 s35, s46, 24576
    s_add_u32 m0, s45, 20040
    s_nop 0
    buffer_load_dwordx4 v250, s[20:23], s35 offen lds
    s_add_u32 s46, s46, 262144
    s_waitcnt vmcnt(7) lgkmcnt(0)
    s_barrier
    s_add_u32 s35, s46, 0
    s_add_u32 m0, s45, 33792
    s_nop 0
    buffer_load_dwordx4 v250, s[20:23], s35 offen lds
    s_add_u32 s35, s46, 8192
    s_add_u32 m0, s45, 34824
    s_nop 0
    buffer_load_dwordx4 v250, s[20:23], s35 offen lds
    s_add_u32 s35, s46, 16384
    s_add_u32 m0, s45, 35904
    s_nop 0
    buffer_load_dwordx4 v250, s[20:23], s35 offen lds
    s_add_u32 s35, s46, 24576
    s_add_u32 m0, s45, 36936
    s_nop 0
    buffer_load_dwordx4 v250, s[20:23], s35 offen lds
    s_add_u32 s46, s46, 262144
    s_add_u32 s35, s43, 0
    s_add_u32 m0, s50, 25344
    s_nop 0
    buffer_load_dwordx4 v249, s[16:19], s35 offen lds
    s_add_u32 s35, s43, 36864
    s_add_u32 m0, s50, 29568
    s_nop 0
    buffer_load_dwordx4 v249, s[16:19], s35 offen lds
    s_add_u32 s35, s43, 73728
    s_add_u32 m0, s50, 33792
    s_nop 0
    buffer_load_dwordx4 v249, s[16:19], s35 offen lds
    s_mov_b32 s43, 0
    s_waitcnt vmcnt(7) lgkmcnt(0)
    s_barrier
    s_add_u32 s35, s46, 0
    s_add_u32 m0, s45, 0
    s_nop 0
    buffer_load_dwordx4 v250, s[20:23], s35 offen lds
    s_add_u32 s35, s46, 8192
    s_add_u32 m0, s45, 1032
    s_nop 0
    buffer_load_dwordx4 v250, s[20:23], s35 offen lds
    s_add_u32 s35, s46, 16384
    s_add_u32 m0, s45, 2112
    s_nop 0
    buffer_load_dwordx4 v250, s[20:23], s35 offen lds
    s_add_u32 s35, s46, 24576
    s_add_u32 m0, s45, 3144
    s_nop 0
    buffer_load_dwordx4 v250, s[20:23], s35 offen lds
    s_add_u32 s46, s46, 262144
    s_add_u32 m0, s52, 50688
    s_nop 0
    buffer_load_dwordx4 v248, s[8:11], s41 offen offset:0 nt lds
    s_add_u32 m0, s52, 51488
    s_nop 0
    buffer_load_dwordx4 v248, s[8:11], s41 offen offset:256 nt lds
    s_add_u32 m0, s52, 52288
    s_nop 0
    buffer_load_dwordx4 v248, s[8:11], s41 offen offset:512 nt lds
    s_add_u32 m0, s52, 53088
    s_nop 0
    buffer_load_dwordx4 v248, s[8:11], s41 offen offset:768 nt lds
    s_add_u32 s41, s41, 8192
    s_waitcnt vmcnt(11) lgkmcnt(0)
    s_barrier
    s_add_u32 s35, s46, 0
    s_add_u32 m0, s45, 16896
    s_nop 0
    buffer_load_dwordx4 v250, s[20:23], s35 offen lds
    s_add_u32 s35, s46, 8192
    s_add_u32 m0, s45, 17928
    s_nop 0
    buffer_load_dwordx4 v250, s[20:23], s35 offen lds
    s_add_u32 s35, s46, 16384
    s_add_u32 m0, s45, 19008
    s_nop 0
    buffer_load_dwordx4 v250, s[20:23], s35 offen lds
    s_add_u32 s35, s46, 24576
    s_add_u32 m0, s45, 20040
    s_nop 0
    buffer_load_dwordx4 v250, s[20:23], s35 offen lds
    s_add_u32 s46, s46, 262144
    s_waitcnt vmcnt(8) lgkmcnt(0)
    s_barrier
    s_add_u32 s35, s46, 0
    s_add_u32 m0, s45, 33792
    s_nop 0
    buffer_load_dwordx4 v250, s[20:23], s35 offen lds
    s_add_u32 s35, s46, 8192
    s_add_u32 m0, s45, 34824
    s_nop 0
    buffer_load_dwordx4 v250, s[20:23], s35 offen lds
    s_add_u32 s35, s46, 16384
    s_add_u32 m0, s45, 35904
    s_nop 0
    buffer_load_dwordx4 v250, s[20:23], s35 offen lds
    s_add_u32 s35, s46, 24576
    s_add_u32 m0, s45, 36936
    s_nop 0
    buffer_load_dwordx4 v250, s[20:23], s35 offen lds
    s_sub_u32 s46, s46, 4455936
    s_add_u32 s35, s47, s90
    s_add_u32 m0, s50, 0
    s_nop 0
    buffer_load_dwordx4 v249, s[24:27], s35 offen lds
    s_add_u32 s35, s47, s91
    s_add_u32 m0, s50, 4224
    s_nop 0
    buffer_load_dwordx4 v249, s[24:27], s35 offen lds
    s_add_u32 s35, s47, s92
    s_add_u32 m0, s50, 8448
    s_nop 0
    buffer_load_dwordx4 v249, s[24:27], s35 offen lds
    s_waitcnt vmcnt(7) lgkmcnt(0)
    s_barrier
    s_add_u32 s35, s47, s93
    s_add_u32 m0, s50, 12672
    s_nop 0
    buffer_load_dwordx4 v249, s[24:27], s35 offen lds
    s_add_u32 s35, s47, s94
    s_add_u32 m0, s50, 16896
    s_nop 0
    buffer_load_dwordx4 v249, s[24:27], s35 offen lds
    s_add_u32 m0, s52, 0
    s_nop 0
    buffer_load_dwordx4 v248, s[8:11], s41 offen offset:0 nt lds
    s_add_u32 m0, s52, 800
    s_nop 0
    buffer_load_dwordx4 v248, s[8:11], s41 offen offset:256 nt lds
    s_add_u32 m0, s52, 1600
    s_nop 0
    buffer_load_dwordx4 v248, s[8:11], s41 offen offset:512 nt lds
    s_add_u32 m0, s52, 2400
    s_nop 0
    buffer_load_dwordx4 v248, s[8:11], s41 offen offset:768 nt lds
    s_add_u32 s41, s41, 8192
    s_waitcnt vmcnt(9) lgkmcnt(0)
    s_barrier
    s_add_u32 m0, s52, 16896
    s_nop 0
    buffer_load_dwordx4 v248, s[12:15], s42 offen offset:0 nt lds
    s_add_u32 m0, s52, 17696
    s_nop 0
    buffer_load_dwordx4 v248, s[12:15], s42 offen offset:256 nt lds
    s_add_u32 m0, s52, 18496
    s_nop 0
    buffer_load_dwordx4 v248, s[12:15], s42 offen offset:512 nt lds
    s_add_u32 m0, s52, 19296
    s_nop 0
    buffer_load_dwordx4 v248, s[12:15], s42 offen offset:768 nt lds
    s_add_u32 s42, s42, 8192
    s_waitcnt vmcnt(10) lgkmcnt(0)
    s_barrier
    s_cmp_eq_u32 s32, 0
    s_cbranch_scc1 LP_r0B_64
    ds_read_b128 v[216:219], v252 offset:0
    ds_read_b128 v[220:223], v252 offset:1024
    ds_read_b128 v[224:227], v252 offset:2048
    ds_read_b128 v[228:231], v252 offset:3072
    ds_read_b128 v[232:235], v252 offset:4096
    ds_read_b128 v[236:239], v252 offset:5120
    ds_read_b64_tr_b16 v[240:241], v251 offset:0
    ds_read_b64_tr_b16 v[242:243], v251 offset:512
    ds_read_b64_tr_b16 v[244:245], v251 offset:4224
    ds_read_b64_tr_b16 v[246:247], v251 offset:4736
    s_add_u32 s35, s47, s95
    s_add_u32 m0, s50, 21120
    s_nop 0
    buffer_load_dwordx4 v249, s[24:27], s35 offen lds
    s_waitcnt lgkmcnt(2)
    v_mfma_f32_16x16x32_bf16 v[0:3], v[240:243], v[216:219], v[0:3]
    v_mfma_f32_16x16x32_bf16 v[4:7], v[240:243], v[220:223], v[4:7]
    s_add_u32 s35, s47, s96
    s_add_u32 m0, s50, 25344
    v_mfma_f32_16x16x32_bf16 v[8:11], v[240:243], v[224:227], v[8:11]
    buffer_load_dwordx4 v249, s[24:27], s35 offen lds
    v_mfma_f32_16x16x32_bf16 v[12:15], v[240:243], v[228:231], v[12:15]
    s_add_u32 s35, s47, s97
    s_add_u32 m0, s50, 29568
    v_mfma_f32_16x16x32_bf16 v[16:19], v[240:243], v[232:235], v[16:19]
    buffer_load_dwordx4 v249, s[24:27], s35 offen lds
    v_mfma_f32_16x16x32_bf16 v[20:23], v[240:243], v[236:239], v[20:23]
    ds_read_b64_tr_b16 v[240:241], v251 offset:8448
    ds_read_b64_tr_b16 v[242:243], v251 offset:8960
    s_waitcnt lgkmcnt(2)
    v_mfma_f32_16x16x32_bf16 v[24:27], v[244:247], v[216:219], v[24:27]
    s_add_u32 s35, s47, s98
    s_add_u32 m0, s50, 33792
    v_mfma_f32_16x16x32_bf16 v[28:31], v[244:247], v[220:223], v[28:31]
    buffer_load_dwordx4 v249, s[24:27], s35 offen lds
    s_add_u32 s47, s47, 36864
    v_mfma_f32_16x16x32_bf16 v[32:35], v[244:247], v[224:227], v[32:35]
    s_add_u32 m0, s52, 33792
    v_mfma_f32_16x16x32_bf16 v[36:39], v[244:247], v[228:231], v[36:39]
    buffer_load_dwordx4 v248, s[8:11], s41 offen offset:0 nt lds
    v_mfma_f32_16x16x32_bf16 v[40:43], v[244:247], v[232:235], v[40:43]
    v_mfma_f32_16x16x32_bf16 v[44:47], v[244:247], v[236:239], v[44:47]
    s_waitcnt lgkmcnt(0)
    s_add_u32 m0, s52, 34592
    v_mfma_f32_16x16x32_bf16 v[48:51], v[240:243], v[216:219], v[48:51]
    buffer_load_dwordx4 v248, s[8:11], s41 offen offset:256 nt lds
    v_mfma_f32_16x16x32_bf16 v[52:55], v[240:243], v[220:223], v[52:55]
    s_add_u32 m0, s52, 35392
    v_mfma_f32_16x16x32_bf16 v[56:59], v[240:243], v[224:227], v[56:59]
    buffer_load_dwordx4 v248, s[8:11], s41 offen offset:512 nt lds
    v_mfma_f32_16x16x32_bf16 v[60:63], v[240:243], v[228:231], v[60:63]
    v_mfma_f32_16x16x32_bf16 v[64:67], v[240:243], v[232:235], v[64:67]
    s_add_u32 m0, s52, 36192
    v_mfma_f32_16x16x32_bf16 v[68:71], v[240:243], v[236:239], v[68:71]
    buffer_load_dwordx4 v248, s[8:11], s41 offen offset:768 nt lds
    s_add_u32 s41, s41, 8192
LP_jB_65:
    s_waitcnt vmcnt(12) lgkmcnt(0)
LP_H19B:
    s_barrier
    s_cmp_eq_u32 s32, 0
    s_cbranch_scc1 LP_r0B_66
    ds_read_b64_tr_b16 v[244:245], v251 offset:12672
    ds_read_b64_tr_b16 v[246:247], v251 offset:13184
    ds_read_b64_tr_b16 v[240:241], v251 offset:16896
    ds_read_b64_tr_b16 v[242:243], v251 offset:17408
    s_add_u32 s35, s47, s90
    s_add_u32 m0, s50, 0
    s_nop 0
    buffer_load_dwordx4 v249, s[24:27], s35 offen lds
    s_waitcnt lgkmcnt(2)
    s_add_u32 s35, s47, s91
    s_add_u32 m0, s50, 4224
    v_mfma_f32_16x16x32_bf16 v[72:75], v[244:247], v[216:219], v[72:75]
    buffer_load_dwordx4 v249, s[24:27], s35 offen lds
    s_add_u32 s35, s47, s92
    s_add_u32 m0, s50, 8448
    v_mfma_f32_16x16x32_bf16 v[76:79], v[244:247], v[220:223], v[76:79]
    buffer_load_dwordx4 v249, s[24:27], s35 offen lds
    s_add_u32 m0, s52, 50688
    v_mfma_f32_16x16x32_bf16 v[80:83], v[244:247], v[224:227], v[80:83]
    buffer_load_dwordx4 v248, s[12:15], s42 offen offset:0 nt lds
    s_add_u32 m0, s52, 51488
    v_mfma_f32_16x16x32_bf16 v[84:87], v[244:247], v[228:231], v[84:87]
    buffer_load_dwordx4 v248, s[12:15], s42 offen offset:256 nt lds
    s_add_u32 m0, s52, 52288
    v_mfma_f32_16x16x32_bf16 v[88:91], v[244:247], v[232:235], v[88:91]
    buffer_load_dwordx4 v248, s[12:15], s42 offen offset:512 nt lds
    s_add_u32 m0, s52, 53088
    v_mfma_f32_16x16x32_bf16 v[92:95], v[244:247], v[236:239], v[92:95]
    buffer_load_dwordx4 v248, s[12:15], s42 offen offset:768 nt lds
    s_add_u32 s42, s42, 8192
LP_jB_67:
    s_waitcnt vmcnt(15) lgkmcnt(0)
    s_barrier
    s_add_u32 m0, s52, 0
    s_nop 0
    buffer_load_dwordx4 v248, s[8:11], s41 offen offset:0 nt lds
    s_add_u32 m0, s52, 800
    s_nop 0
    buffer_load_dwordx4 v248, s[8:11], s41 offen offset:256 nt lds
    s_add_u32 m0, s52, 1600
    s_nop 0
    buffer_load_dwordx4 v248, s[8:11], s41 offen offset:512 nt lds
    s_add_u32 m0, s52, 2400
    s_nop 0
    buffer_load_dwordx4 v248, s[8:11], s41 offen offset:768 nt lds
    s_add_u32 s41, s41, 8192
    s_waitcnt vmcnt(11) lgkmcnt(0)
    s_mov_b32 s33, 3
LP_TB:
    s_barrier
    s_cmp_eq_u32 s32, 0
    s_cbranch_scc1 LP_r0B_68
    ds_read_b64_tr_b16 v[244:245], v251 offset:21120
    ds_read_b64_tr_b16 v[246:247], v251 offset:21632
    s_add_u32 s35, s47, s93
    s_add_u32 m0, s50, 12672
    s_nop 0
    buffer_load_dwordx4 v249, s[24:27], s35 offen lds
    v_mfma_f32_16x16x32_bf16 v[96:99], v[240:243], v[216:219], v[96:99]
    s_add_u32 s35, s47, s94
    s_add_u32 m0, s50, 16896
    v_mfma_f32_16x16x32_bf16 v[100:103], v[240:243], v[220:223], v[100:103]
    buffer_load_dwordx4 v249, s[24:27], s35 offen lds
    v_mfma_f32_16x16x32_bf16 v[104:107], v[240:243], v[224:227], v[104:107]
    v_mfma_f32_16x16x32_bf16 v[108:111], v[240:243], v[228:231], v[108:111]
    s_add_u32 m0, s52, 16896
    v_mfma_f32_16x16x32_bf16 v[112:115], v[240:243], v[232:235], v[112:115]
    buffer_load_dwordx4 v248, s[12:15], s42 offen offset:0 nt lds
    v_mfma_f32_16x16x32_bf16 v[116:119], v[240:243], v[236:239], v[116:119]
    ds_read_b64_tr_b16 v[240:241], v251 offset:25344
    ds_read_b64_tr_b16 v[242:243], v251 offset:25856
    s_waitcnt lgkmcnt(2)
    s_add_u32 m0, s52, 17696
    v_mfma_f32_16x16x32_bf16 v[120:123], v[244:247], v[216:219], v[120:123]
    buffer_load_dwordx4 v248, s[12:15], s42 offen offset:256 nt lds
    v_mfma_f32_16x16x32_bf16 v[124:127], v[244:247], v[220:223], v[124:127]
    v_mfma_f32_16x16x32_bf16 v[128:131], v[244:247], v[224:227], v[128:131]
    s_add_u32 m0, s52, 18496
    v_mfma_f32_16x16x32_bf16 v[132:135], v[244:247], v[228:231], v[132:135]
    buffer_load_dwordx4 v248, s[12:15], s42 offen offset:512 nt lds
    v_mfma_f32_16x16x32_bf16 v[136:139], v[244:247], v[232:235], v[136:139]
    s_add_u32 m0, s52, 19296
    v_mfma_f32_16x16x32_bf16 v[140:143], v[244:247], v[236:239], v[140:143]
    buffer_load_dwordx4 v248, s[12:15], s42 offen offset:768 nt lds
    s_add_u32 s42, s42, 8192
LP_jB_69:
    s_waitcnt vmcnt(10) lgkmcnt(0)
    s_barrier
    s_cmp_eq_u32 s32, 0
    s_cbranch_scc1 LP_r0B_70
    ds_read_b64_tr_b16 v[244:245], v251 offset:29568
    ds_read_b64_tr_b16 v[246:247], v251 offset:30080
    s_add_u32 s35, s47, s95
    s_add_u32 m0, s50, 21120
    s_nop 0
    buffer_load_dwordx4 v249, s[24:27], s35 offen lds
    v_mfma_f32_16x16x32_bf16 v[144:147], v[240:243], v[216:219], v[144:147]
    s_add_u32 s35, s47, s96
    s_add_u32 m0, s50, 25344
    v_mfma_f32_16x16x32_bf16 v[148:151], v[240:243], v[220:223], v[148:151]
    buffer_load_dwordx4 v249, s[24:27], s35 offen lds
    v_mfma_f32_16x16x32_bf16 v[152:155], v[240:243], v[224:227], v[152:155]
    v_mfma_f32_16x16x32_bf16 v[156:159], v[240:243], v[228:231], v[156:159]
    s_add_u32 m0, s52, 33792
    v_mfma_f32_16x16x32_bf16 v[160:163], v[240:243], v[232:235], v[160:163]
    buffer_load_dwordx4 v248, s[8:11], s41 offen offset:0 nt lds
    v_mfma_f32_16x16x32_bf16 v[164:167], v[240:243], v[236:239], v[164:167]
    ds_read_b64_tr_b16 v[240:241], v251 offset:33792
    ds_read_b64_tr_b16 v[242:243], v251 offset:34304
    s_waitcnt lgkmcnt(2)
    s_add_u32 m0, s52, 34592
    v_mfma_f32_16x16x32_bf16 v[168:171], v[244:247], v[216:219], v[168:171]
    buffer_load_dwordx4 v248, s[8:11], s41 offen offset:256 nt lds
    v_mfma_f32_16x16x32_bf16 v[172:175], v[244:247], v[220:223], v[172:175]
    v_mfma_f32_16x16x32_bf16 v[176:179], v[244:247], v[224:227], v[176:179]
    s_add_u32 m0, s52, 35392
    v_mfma_f32_16x16x32_bf16 v[180:183], v[244:247], v[228:231], v[180:183]
    buffer_load_dwordx4 v248, s[8:11], s41 offen offset:512 nt lds
    v_mfma_f32_16x16x32_bf16 v[184:187], v[244:247], v[232:235], v[184:187]
    s_add_u32 m0, s52, 36192
    v_mfma_f32_16x16x32_bf16 v[188:191], v[244:247], v[236:239], v[188:191]
    buffer_load_dwordx4 v248, s[8:11], s41 offen offset:768 nt lds
    s_add_u32 s41, s41, 8192
LP_jB_71:
    s_waitcnt vmcnt(12) lgkmcnt(0)
    s_barrier
    s_cmp_eq_u32 s32, 0
    s_cbranch_scc1 LP_r0B_72
    ds_read_b64_tr_b16 v[244:245], v251 offset:0
    ds_read_b64_tr_b16 v[246:247], v251 offset:512
    s_add_u32 s35, s47, s97
    s_add_u32 m0, s50, 29568
    s_nop 0
    buffer_load_dwordx4 v249, s[24:27], s35 offen lds
    v_mfma_f32_16x16x32_bf16 v[192:195], v[240:243], v[216:219], v[192:195]
    ds_read_b128 v[216:219], v252 offset:6144
    v_mfma_f32_16x16x32_bf16 v[196:199], v[240:243], v[220:223], v[196:199]
    ds_read_b128 v[220:223], v252 offset:7168
    v_mfma_f32_16x16x32_bf16 v[200:203], v[240:243], v[224:227], v[200:203]
    ds_read_b128 v[224:227], v252 offset:8192
    s_add_u32 s35, s47, s98
    s_add_u32 m0, s50, 33792
    v_mfma_f32_16x16x32_bf16 v[204:207], v[240:243], v[228:231], v[204:207]
    ds_read_b128 v[228:231], v252 offset:9216
    buffer_load_dwordx4 v249, s[24:27], s35 offen lds
    s_add_u32 s47, s47, 36864
    v_mfma_f32_16x16x32_bf16 v[208:211], v[240:243], v[232:235], v[208:211]
    ds_read_b128 v[232:235], v252 offset:10240
    v_mfma_f32_16x16x32_bf16 v[212:215], v[240:243], v[236:239], v[212:215]
    ds_read_b128 v[236:239], v252 offset:11264
    ds_read_b64_tr_b16 v[240:241], v251 offset:4224
    ds_read_b64_tr_b16 v[242:243], v251 offset:4736
    v_add_u32 v252, 6144, v252
    s_waitcnt lgkmcnt(8)
    s_add_u32 m0, s52, 50688
    s_waitcnt lgkmcnt(6)
    v_mfma_f32_16x16x32_bf16 v[0:3], v[244:247], v[216:219], v[0:3]
    buffer_load_dwordx4 v248, s[12:15], s42 offen offset:0 nt lds
    v_mfma_f32_16x16x32_bf16 v[4:7], v[244:247], v[220:223], v[4:7]
    s_waitcnt lgkmcnt(4)
    v_mfma_f32_16x16x32_bf16 v[8:11], v[244:247], v[224:227], v[8:11]
    v_mfma_f32_16x16x32_bf16 v[12:15], v[244:247], v[228:231], v[12:15]
    s_add_u32 m0, s52, 51488
    s_waitcnt lgkmcnt(2)
    v_mfma_f32_16x16x32_bf16 v[16:19], v[244:247], v[232:235], v[16:19]
    buffer_load_dwordx4 v248, s[12:15], s42 offen offset:256 nt lds
    v_mfma_f32_16x16x32_bf16 v[20:23], v[244:247], v[236:239], v[20:23]
    ds_read_b64_tr_b16 v[244:245], v251 offset:8448
    ds_read_b64_tr_b16 v[246:247], v251 offset:8960
    s_waitcnt lgkmcnt(2)
    v_mfma_f32_16x16x32_bf16 v[24:27], v[240:243], v[216:219], v[24:27]
    s_add_u32 m0, s52, 52288
    v_mfma_f32_16x16x32_bf16 v[28:31], v[240:243], v[220:223], v[28:31]
    buffer_load_dwordx4 v248, s[12:15], s42 offen offset:512 nt lds
    v_mfma_f32_16x16x32_bf16 v[32:35], v[240:243], v[224:227], v[32:35]
    v_mfma_f32_16x16x32_bf16 v[36:39], v[240:243], v[228:231], v[36:39]
    v_mfma_f32_16x16x32_bf16 v[40:43], v[240:243], v[232:235], v[40:43]
    s_add_u32 m0, s52, 53088
    v_mfma_f32_16x16x32_bf16 v[44:47], v[240:243], v[236:239], v[44:47]
    buffer_load_dwordx4 v248, s[12:15], s42 offen offset:768 nt lds
    s_add_u32 s42, s42, 8192
LP_jB_73:
    s_waitcnt vmcnt(12) lgkmcnt(0)
    s_barrier
    s_cmp_eq_u32 s32, 0
    s_cbranch_scc1 LP_r0B_74
    ds_read_b64_tr_b16 v[240:241], v251 offset:12672
    ds_read_b64_tr_b16 v[242:243], v251 offset:13184
    s_add_u32 s35, s47, s90
    s_add_u32 m0, s50, 0
    s_nop 0
    buffer_load_dwordx4 v249, s[24:27], s35 offen lds
    v_mfma_f32_16x16x32_bf16 v[48:51], v[244:247], v[216:219], v[48:51]
    s_add_u32 s35, s47, s91
    s_add_u32 m0, s50, 4224
    v_mfma_f32_16x16x32_bf16 v[52:55], v[244:247], v[220:223], v[52:55]
    buffer_load_dwordx4 v249, s[24:27], s35 offen lds
    v_mfma_f32_16x16x32_bf16 v[56:59], v[244:247], v[224:227], v[56:59]
    s_add_u32 s35, s47, s92
    s_add_u32 m0, s50, 8448
    v_mfma_f32_16x16x32_bf16 v[60:63], v[244:247], v[228:231], v[60:63]
    buffer_load_dwordx4 v249, s[24:27], s35 offen lds
    v_mfma_f32_16x16x32_bf16 v[64:67], v[244:247], v[232:235], v[64:67]
    s_add_u32 m0, s52, 0
    v_mfma_f32_16x16x32_bf16 v[68:71], v[244:247], v[236:239], v[68:71]
    ds_read_b64_tr_b16 v[244:245], v251 offset:16896
    ds_read_b64_tr_b16 v[246:247], v251 offset:17408
    buffer_load_dwordx4 v248, s[8:11], s41 offen offset:0 nt lds
    s_waitcnt lgkmcnt(2)
    v_mfma_f32_16x16x32_bf16 v[72:75], v[240:243], v[216:219], v[72:75]
    s_add_u32 m0, s52, 800
    v_mfma_f32_16x16x32_bf16 v[76:79], v[240:243], v[220:223], v[76:79]
    buffer_load_dwordx4 v248, s[8:11], s41 offen offset:256 nt lds
    v_mfma_f32_16x16x32_bf16 v[80:83], v[240:243], v[224:227], v[80:83]
    s_add_u32 m0, s52, 1600
    v_mfma_f32_16x16x32_bf16 v[84:87], v[240:243], v[228:231], v[84:87]
    buffer_load_dwordx4 v248, s[8:11], s41 offen offset:512 nt lds
    v_mfma_f32_16x16x32_bf16 v[88:91], v[240:243], v[232:235], v[88:91]
    s_add_u32 m0, s52, 2400
    v_mfma_f32_16x16x32_bf16 v[92:95], v[240:243], v[236:239], v[92:95]
    buffer_load_dwordx4 v248, s[8:11], s41 offen offset:768 nt lds
    s_add_u32 s41, s41, 8192
LP_jB_75:
    s_waitcnt vmcnt(13) lgkmcnt(0)
    s_barrier
    s_cmp_eq_u32 s32, 0
    s_cbranch_scc1 LP_r0B_76
    ds_read_b64_tr_b16 v[240:241], v251 offset:21120
    ds_read_b64_tr_b16 v[242:243], v251 offset:21632
    s_add_u32 s35, s47, s93
    s_add_u32 m0, s50, 12672
    s_nop 0
    buffer_load_dwordx4 v249, s[24:27], s35 offen lds
    v_mfma_f32_16x16x32_bf16 v[96:99], v[244:247], v[216:219], v[96:99]
    s_add_u32 s35, s47, s94
    s_add_u32 m0, s50, 16896
    v_mfma_f32_16x16x32_bf16 v[100:103], v[244:247], v[220:223], v[100:103]
    buffer_load_dwordx4 v249, s[24:27], s35 offen lds
    v_mfma_f32_16x16x32_bf16 v[104:107], v[244:247], v[224:227], v[104:107]
    v_mfma_f32_16x16x32_bf16 v[108:111], v[244:247], v[228:231], v[108:111]
    s_add_u32 m0, s52, 16896
    v_mfma_f32_16x16x32_bf16 v[112:115], v[244:247], v[232:235], v[112:115]
    buffer_load_dwordx4 v248, s[12:15], s42 offen offset:0 nt lds
    v_mfma_f32_16x16x32_bf16 v[116:119], v[244:247], v[236:239], v[116:119]
    ds_read_b64_tr_b16 v[244:245], v251 offset:25344
    ds_read_b64_tr_b16 v[246:247], v251 offset:25856
    s_waitcnt lgkmcnt(2)
    s_add_u32 m0, s52, 17696
    v_mfma_f32_16x16x32_bf16 v[120:123], v[240:243], v[216:219], v[120:123]
    buffer_load_dwordx4 v248, s[12:15], s42 offen offset:256 nt lds
    v_mfma_f32_16x16x32_bf16 v[124:127], v[240:243], v[220:223], v[124:127]
    v_mfma_f32_16x16x32_bf16 v[128:131], v[240:243], v[224:227], v[128:131]
    s_add_u32 m0, s52, 18496
    v_mfma_f32_16x16x32_bf16 v[132:135], v[240:243], v[228:231], v[132:135]
    buffer_load_dwordx4 v248, s[12:15], s42 offen offset:512 nt lds
    v_mfma_f32_16x16x32_bf16 v[136:139], v[240:243], v[232:235], v[136:139]
    s_add_u32 m0, s52, 19296
    v_mfma_f32_16x16x32_bf16 v[140:143], v[240:243], v[236:239], v[140:143]
    buffer_load_dwordx4 v248, s[12:15], s42 offen offset:768 nt lds
    s_add_u32 s42, s42, 8192
LP_jB_77:
    s_waitcnt vmcnt(13) lgkmcnt(0)
    s_barrier
    s_cmp_eq_u32 s32, 0
    s_cbranch_scc1 LP_r0B_78
    ds_read_b64_tr_b16 v[240:241], v251 offset:29568
    ds_read_b64_tr_b16 v[242:243], v251 offset:30080
    s_add_u32 s35, s47, s95
    s_add_u32 m0, s50, 21120
    s_nop 0
    buffer_load_dwordx4 v249, s[24:27], s35 offen lds
    v_mfma_f32_16x16x32_bf16 v[144:147], v[244:247], v[216:219], v[144:147]
    s_add_u32 s35, s47, s96
    s_add_u32 m0, s50, 25344
    v_mfma_f32_16x16x32_bf16 v[148:151], v[244:247], v[220:223], v[148:151]
    buffer_load_dwordx4 v249, s[24:27], s35 offen lds
    v_mfma_f32_16x16x32_bf16 v[152:155], v[244:247], v[224:227], v[152:155]
    v_mfma_f32_16x16x32_bf16 v[156:159], v[244:247], v[228:231], v[156:159]
    s_add_u32 m0, s52, 33792
    v_mfma_f32_16x16x32_bf16 v[160:163], v[244:247], v[232:235], v[160:163]
    buffer_load_dwordx4 v248, s[8:11], s41 offen offset:0 nt lds
    v_mfma_f32_16x16x32_bf16 v[164:167], v[244:247], v[236:239], v[164:167]
    ds_read_b64_tr_b16 v[244:245], v251 offset:33792
    ds_read_b64_tr_b16 v[246:247], v251 offset:34304
    s_waitcnt lgkmcnt(2)
    s_add_u32 m0, s52, 34592
    v_mfma_f32_16x16x32_bf16 v[168:171], v[240:243], v[216:219], v[168:171]
    buffer_load_dwordx4 v248, s[8:11], s41 offen offset:256 nt lds
    v_mfma_f32_16x16x32_bf16 v[172:175], v[240:243], v[220:223], v[172:175]
    v_mfma_f32_16x16x32_bf16 v[176:179], v[240:243], v[224:227], v[176:179]
    s_add_u32 m0, s52, 35392
    v_mfma_f32_16x16x32_bf16 v[180:183], v[240:243], v[228:231], v[180:183]
    buffer_load_dwordx4 v248, s[8:11], s41 offen offset:512 nt lds
    v_mfma_f32_16x16x32_bf16 v[184:187], v[240:243], v[232:235], v[184:187]
    s_add_u32 m0, s52, 36192
    v_mfma_f32_16x16x32_bf16 v[188:191], v[240:243], v[236:239], v[188:191]
    buffer_load_dwordx4 v248, s[8:11], s41 offen offset:768 nt lds
    s_add_u32 s41, s41, 8192
LP_jB_79:
    s_waitcnt vmcnt(12) lgkmcnt(0)
    s_barrier
    s_cmp_eq_u32 s32, 0
    s_cbranch_scc1 LP_r0B_80
    ds_read_b64_tr_b16 v[240:241], v251 offset:0
    ds_read_b64_tr_b16 v[242:243], v251 offset:512
    s_add_u32 s35, s47, s97
    s_add_u32 m0, s50, 29568
    s_nop 0
    buffer_load_dwordx4 v249, s[24:27], s35 offen lds
    v_mfma_f32_16x16x32_bf16 v[192:195], v[244:247], v[216:219], v[192:195]
    ds_read_b128 v[216:219], v252 offset:6144
    v_mfma_f32_16x16x32_bf16 v[196:199], v[244:247], v[220:223], v[196:199]
    ds_read_b128 v[220:223], v252 offset:7168
    v_mfma_f32_16x16x32_bf16 v[200:203], v[244:247], v[224:227], v[200:203]
    ds_read_b128 v[224:227], v252 offset:8192
    s_add_u32 s35, s47, s98
    s_add_u32 m0, s50, 33792
    v_mfma_f32_16x16x32_bf16 v[204:207], v[244:247], v[228:231], v[204:207]
    ds_read_b128 v[228:231], v252 offset:9216
    buffer_load_dwordx4 v249, s[24:27], s35 offen lds
    s_add_u32 s47, s47, 36864
    v_mfma_f32_16x16x32_bf16 v[208:211], v[244:247], v[232:235], v[208:211]
    ds_read_b128 v[232:235], v252 offset:10240
    v_mfma_f32_16x16x32_bf16 v[212:215], v[244:247], v[236:239], v[212:215]
    ds_read_b128 v[236:239], v252 offset:11264
    ds_read_b64_tr_b16 v[244:245], v251 offset:4224
    ds_read_b64_tr_b16 v[246:247], v251 offset:4736
    v_add_u32 v252, 6144, v252
    s_waitcnt lgkmcnt(8)
    s_add_u32 m0, s52, 50688
    s_waitcnt lgkmcnt(6)
    v_mfma_f32_16x16x32_bf16 v[0:3], v[240:243], v[216:219], v[0:3]
    buffer_load_dwordx4 v248, s[12:15], s42 offen offset:0 nt lds
    v_mfma_f32_16x16x32_bf16 v[4:7], v[240:243], v[220:223], v[4:7]
    s_waitcnt lgkmcnt(4)
    v_mfma_f32_16x16x32_bf16 v[8:11], v[240:243], v[224:227], v[8:11]
    v_mfma_f32_16x16x32_bf16 v[12:15], v[240:243], v[228:231], v[12:15]
    s_add_u32 m0, s52, 51488
    s_waitcnt lgkmcnt(2)
    v_mfma_f32_16x16x32_bf16 v[16:19], v[240:243], v[232:235], v[16:19]
    buffer_load_dwordx4 v248, s[12:15], s42 offen offset:256 nt lds
    v_mfma_f32_16x16x32_bf16 v[20:23], v[240:243], v[236:239], v[20:23]
    ds_read_b64_tr_b16 v[240:241], v251 offset:8448
    ds_read_b64_tr_b16 v[242:243], v251 offset:8960
    s_waitcnt lgkmcnt(2)
    v_mfma_f32_16x16x32_bf16 v[24:27], v[244:247], v[216:219], v[24:27]
    s_add_u32 m0, s52, 52288
    v_mfma_f32_16x16x32_bf16 v[28:31], v[244:247], v[220:223], v[28:31]
    buffer_load_dwordx4 v248, s[12:15], s42 offen offset:512 nt lds
    v_mfma_f32_16x16x32_bf16 v[32:35], v[244:247], v[224:227], v[32:35]
    v_mfma_f32_16x16x32_bf16 v[36:39], v[244:247], v[228:231], v[36:39]
    v_mfma_f32_16x16x32_bf16 v[40:43], v[244:247], v[232:235], v[40:43]
    s_add_u32 m0, s52, 53088
    v_mfma_f32_16x16x32_bf16 v[44:47], v[244:247], v[236:239], v[44:47]
    buffer_load_dwordx4 v248, s[12:15], s42 offen offset:768 nt lds
    s_add_u32 s42, s42, 8192
LP_jB_81:
    s_waitcnt vmcnt(12) lgkmcnt(0)
    s_barrier
    s_cmp_eq_u32 s32, 0
    s_cbranch_scc1 LP_r0B_82
    ds_read_b64_tr_b16 v[244:245], v251 offset:12672
    ds_read_b64_tr_b16 v[246:247], v251 offset:13184
    s_add_u32 s35, s47, s90
    s_add_u32 m0, s50, 0
    s_nop 0
    buffer_load_dwordx4 v249, s[24:27], s35 offen lds
    v_mfma_f32_16x16x32_bf16 v[48:51], v[240:243], v[216:219], v[48:51]
    s_add_u32 s35, s47, s91
    s_add_u32 m0, s50, 4224
    v_mfma_f32_16x16x32_bf16 v[52:55], v[240:243], v[220:223], v[52:55]
    buffer_load_dwordx4 v249, s[24:27], s35 offen lds
    v_mfma_f32_16x16x32_bf16 v[56:59], v[240:243], v[224:227], v[56:59]
    s_add_u32 s35, s47, s92
    s_add_u32 m0, s50, 8448
    v_mfma_f32_16x16x32_bf16 v[60:63], v[240:243], v[228:231], v[60:63]
    buffer_load_dwordx4 v249, s[24:27], s35 offen lds
    v_mfma_f32_16x16x32_bf16 v[64:67], v[240:243], v[232:235], v[64:67]
    s_add_u32 m0, s52, 0
    v_mfma_f32_16x16x32_bf16 v[68:71], v[240:243], v[236:239], v[68:71]
    ds_read_b64_tr_b16 v[240:241], v251 offset:16896
    ds_read_b64_tr_b16 v[242:243], v251 offset:17408
    buffer_load_dwordx4 v248, s[8:11], s41 offen offset:0 nt lds
    s_waitcnt lgkmcnt(2)
    v_mfma_f32_16x16x32_bf16 v[72:75], v[244:247], v[216:219], v[72:75]
    s_add_u32 m0, s52, 800
    v_mfma_f32_16x16x32_bf16 v[76:79], v[244:247], v[220:223], v[76:79]
    buffer_load_dwordx4 v248, s[8:11], s41 offen offset:256 nt lds
    v_mfma_f32_16x16x32_bf16 v[80:83], v[244:247], v[224:227], v[80:83]
    s_add_u32 m0, s52, 1600
    v_mfma_f32_16x16x32_bf16 v[84:87], v[244:247], v[228:231], v[84:87]
    buffer_load_dwordx4 v248, s[8:11], s41 offen offset:512 nt lds
    v_mfma_f32_16x16x32_bf16 v[88:91], v[244:247], v[232:235], v[88:91]
    s_add_u32 m0, s52, 2400
    v_mfma_f32_16x16x32_bf16 v[92:95], v[244:247], v[236:239], v[92:95]
    buffer_load_dwordx4 v248, s[8:11], s41 offen offset:768 nt lds
    s_add_u32 s41, s41, 8192
LP_jB_83:
    s_waitcnt vmcnt(13) lgkmcnt(0)
    s_sub_u32 s33, s33, 1
    s_cmp_lg_u32 s33, 0
    s_cbranch_scc1 LP_TB
    s_barrier
    s_cmp_eq_u32 s32, 0
    s_cbranch_scc1 LP_r0B_84
    ds_read_b64_tr_b16 v[244:245], v251 offset:21120
    ds_read_b64_tr_b16 v[246:247], v251 offset:21632
    s_add_u32 s35, s47, s93
    s_add_u32 m0, s50, 12672
    s_nop 0
    buffer_load_dwordx4 v249, s[24:27], s35 offen lds
    v_mfma_f32_16x16x32_bf16 v[96:99], v[240:243], v[216:219], v[96:99]
    s_add_u32 s35, s47, s94
    s_add_u32 m0, s50, 16896
    v_mfma_f32_16x16x32_bf16 v[100:103], v[240:243], v[220:223], v[100:103]
    buffer_load_dwordx4 v249, s[24:27], s35 offen lds
    v_mfma_f32_16x16x32_bf16 v[104:107], v[240:243], v[224:227], v[104:107]
    v_mfma_f32_16x16x32_bf16 v[108:111], v[240:243], v[228:231], v[108:111]
    s_add_u32 m0, s52, 16896
    v_mfma_f32_16x16x32_bf16 v[112:115], v[240:243], v[232:235], v[112:115]
    buffer_load_dwordx4 v248, s[12:15], s42 offen offset:0 nt lds
    v_mfma_f32_16x16x32_bf16 v[116:119], v[240:243], v[236:239], v[116:119]
    ds_read_b64_tr_b16 v[240:241], v251 offset:25344
    ds_read_b64_tr_b16 v[242:243], v251 offset:25856
    s_waitcnt lgkmcnt(2)
    s_add_u32 m0, s52, 17696
    v_mfma_f32_16x16x32_bf16 v[120:123], v[244:247], v[216:219], v[120:123]
    buffer_load_dwordx4 v248, s[12:15], s42 offen offset:256 nt lds
    v_mfma_f32_16x16x32_bf16 v[124:127], v[244:247], v[220:223], v[124:127]
    v_mfma_f32_16x16x32_bf16 v[128:131], v[244:247], v[224:227], v[128:131]
    s_add_u32 m0, s52, 18496
    v_mfma_f32_16x16x32_bf16 v[132:135], v[244:247], v[228:231], v[132:135]
    buffer_load_dwordx4 v248, s[12:15], s42 offen offset:512 nt lds
    v_mfma_f32_16x16x32_bf16 v[136:139], v[244:247], v[232:235], v[136:139]
    s_add_u32 m0, s52, 19296
    v_mfma_f32_16x16x32_bf16 v[140:143], v[244:247], v[236:239], v[140:143]
    buffer_load_dwordx4 v248, s[12:15], s42 offen offset:768 nt lds
    s_add_u32 s42, s42, 8192
LP_jB_85:
    s_waitcnt vmcnt(13) lgkmcnt(0)
    s_barrier
    s_cmp_eq_u32 s32, 0
    s_cbranch_scc1 LP_r0B_86
    ds_read_b64_tr_b16 v[244:245], v251 offset:29568
    ds_read_b64_tr_b16 v[246:247], v251 offset:30080
    s_add_u32 s35, s47, s95
    s_add_u32 m0, s50, 21120
    s_nop 0
    buffer_load_dwordx4 v249, s[24:27], s35 offen lds
    v_mfma_f32_16x16x32_bf16 v[144:147], v[240:243], v[216:219], v[144:147]
    s_add_u32 s35, s47, s96
    s_add_u32 m0, s50, 25344
    v_mfma_f32_16x16x32_bf16 v[148:151], v[240:243], v[220:223], v[148:151]
    buffer_load_dwordx4 v249, s[24:27], s35 offen lds
    v_mfma_f32_16x16x32_bf16 v[152:155], v[240:243], v[224:227], v[152:155]
    v_mfma_f32_16x16x32_bf16 v[156:159], v[240:243], v[228:231], v[156:159]
    s_add_u32 m0, s52, 33792
    v_mfma_f32_16x16x32_bf16 v[160:163], v[240:243], v[232:235], v[160:163]
    buffer_load_dwordx4 v248, s[12:15], s42 offen offset:0 nt lds
    v_mfma_f32_16x16x32_bf16 v[164:167], v[240:243], v[236:239], v[164:167]
    ds_read_b64_tr_b16 v[240:241], v251 offset:33792
    ds_read_b64_tr_b16 v[242:243], v251 offset:34304
    s_waitcnt lgkmcnt(2)
    s_add_u32 m0, s52, 34592
    v_mfma_f32_16x16x32_bf16 v[168:171], v[244:247], v[216:219], v[168:171]
    buffer_load_dwordx4 v248, s[12:15], s42 offen offset:256 nt lds
    v_mfma_f32_16x16x32_bf16 v[172:175], v[244:247], v[220:223], v[172:175]
    v_mfma_f32_16x16x32_bf16 v[176:179], v[244:247], v[224:227], v[176:179]
    s_add_u32 m0, s52, 35392
    v_mfma_f32_16x16x32_bf16 v[180:183], v[244:247], v[228:231], v[180:183]
    buffer_load_dwordx4 v248, s[12:15], s42 offen offset:512 nt lds
    v_mfma_f32_16x16x32_bf16 v[184:187], v[244:247], v[232:235], v[184:187]
    s_add_u32 m0, s52, 36192
    v_mfma_f32_16x16x32_bf16 v[188:191], v[244:247], v[236:239], v[188:191]
    buffer_load_dwordx4 v248, s[12:15], s42 offen offset:768 nt lds
    s_add_u32 s42, s42, 8192
    s_add_u32 s41, s41, s44
    s_add_u32 s42, s42, s44
LP_jB_87:
    s_waitcnt vmcnt(12) lgkmcnt(0)
    s_add_u32 s34, s32, 1
    s_cmp_eq_u32 s34, 4
    s_cbranch_scc1 LP_ETB
    s_barrier
    s_cmp_eq_u32 s32, 0
    s_cbranch_scc1 LP_r0B_88
    ds_read_b64_tr_b16 v[244:245], v251 offset:0
    ds_read_b64_tr_b16 v[246:247], v251 offset:512
    s_add_u32 s35, s47, s97
    s_add_u32 m0, s50, 29568
    s_nop 0
    buffer_load_dwordx4 v249, s[24:27], s35 offen lds
    v_mfma_f32_16x16x32_bf16 v[192:195], v[240:243], v[216:219], v[192:195]
    ds_read_b128 v[216:219], v252 offset:6144
    v_mfma_f32_16x16x32_bf16 v[196:199], v[240:243], v[220:223], v[196:199]
    ds_read_b128 v[220:223], v252 offset:7168
    v_mfma_f32_16x16x32_bf16 v[200:203], v[240:243], v[224:227], v[200:203]
    ds_read_b128 v[224:227], v252 offset:8192
    v_mfma_f32_16x16x32_bf16 v[204:207], v[240:243], v[228:231], v[204:207]
    ds_read_b128 v[228:231], v252 offset:9216
    v_mfma_f32_16x16x32_bf16 v[208:211], v[240:243], v[232:235], v[208:211]
    ds_read_b128 v[232:235], v252 offset:10240
    v_mfma_f32_16x16x32_bf16 v[212:215], v[240:243], v[236:239], v[212:215]
    ds_read_b128 v[236:239], v252 offset:11264
    ds_read_b64_tr_b16 v[240:241], v251 offset:4224
    ds_read_b64_tr_b16 v[242:243], v251 offset:4736
    v_add_u32 v252, 6144, v252
    s_waitcnt lgkmcnt(8)
    s_waitcnt lgkmcnt(6)
    v_mfma_f32_16x16x32_bf16 v[0:3], v[244:247], v[216:219], v[0:3]
    v_mfma_f32_16x16x32_bf16 v[4:7], v[244:247], v[220:223], v[4:7]
    s_waitcnt lgkmcnt(4)
    v_mfma_f32_16x16x32_bf16 v[8:11], v[244:247], v[224:227], v[8:11]
    v_mfma_f32_16x16x32_bf16 v[12:15], v[244:247], v[228:231], v[12:15]
    s_waitcnt lgkmcnt(2)
    v_mfma_f32_16x16x32_bf16 v[16:19], v[244:247], v[232:235], v[16:19]
    v_mfma_f32_16x16x32_bf16 v[20:23], v[244:247], v[236:239], v[20:23]
    ds_read_b64_tr_b16 v[244:245], v251 offset:8448
    ds_read_b64_tr_b16 v[246:247], v251 offset:8960
    s_waitcnt lgkmcnt(2)
    v_mfma_f32_16x16x32_bf16 v[24:27], v[240:243], v[216:219], v[24:27]
    v_mfma_f32_16x16x32_bf16 v[28:31], v[240:243], v[220:223], v[28:31]
    v_mfma_f32_16x16x32_bf16 v[32:35], v[240:243], v[224:227], v[32:35]
    v_mfma_f32_16x16x32_bf16 v[36:39], v[240:243], v[228:231], v[36:39]
    v_mfma_f32_16x16x32_bf16 v[40:43], v[240:243], v[232:235], v[40:43]
    s_add_u32 s35, s47, s98
    s_add_u32 m0, s50, 33792
    v_mfma_f32_16x16x32_bf16 v[44:47], v[240:243], v[236:239], v[44:47]
    buffer_load_dwordx4 v249, s[24:27], s35 offen lds
    s_add_u32 s47, s47, 36864
LP_jB_89:
    s_waitcnt vmcnt(8) lgkmcnt(0)
    s_barrier
    s_cmp_eq_u32 s32, 0
    s_cbranch_scc1 LP_r0B_90
    ds_read_b64_tr_b16 v[240:241], v251 offset:12672
    ds_read_b64_tr_b16 v[242:243], v251 offset:13184
    s_add_u32 s35, s46, 0
    s_add_u32 m0, s45, 0
    s_nop 0
    buffer_load_dwordx4 v250, s[20:23], s35 offen lds
    v_mfma_f32_16x16x32_bf16 v[48:51], v[244:247], v[216:219], v[48:51]
    s_add_u32 s35, s46, 8192
    s_add_u32 m0, s45, 1032
    v_mfma_f32_16x16x32_bf16 v[52:55], v[244:247], v[220:223], v[52:55]
    buffer_load_dwordx4 v250, s[20:23], s35 offen lds
    v_mfma_f32_16x16x32_bf16 v[56:59], v[244:247], v[224:227], v[56:59]
    s_add_u32 s35, s46, 16384
    s_add_u32 m0, s45, 2112
    v_mfma_f32_16x16x32_bf16 v[60:63], v[244:247], v[228:231], v[60:63]
    buffer_load_dwordx4 v250, s[20:23], s35 offen lds
    v_mfma_f32_16x16x32_bf16 v[64:67], v[244:247], v[232:235], v[64:67]
    s_add_u32 s35, s46, 24576
    s_add_u32 m0, s45, 3144
    v_mfma_f32_16x16x32_bf16 v[68:71], v[244:247], v[236:239], v[68:71]
    ds_read_b64_tr_b16 v[244:245], v251 offset:16896
    ds_read_b64_tr_b16 v[246:247], v251 offset:17408
    buffer_load_dwordx4 v250, s[20:23], s35 offen lds
    s_add_u32 s46, s46, 262144
    s_waitcnt lgkmcnt(2)
    v_mfma_f32_16x16x32_bf16 v[72:75], v[240:243], v[216:219], v[72:75]
    s_add_u32 s35, s43, 0
    s_add_u32 m0, s50, 0
    v_mfma_f32_16x16x32_bf16 v[76:79], v[240:243], v[220:223], v[76:79]
    buffer_load_dwordx4 v249, s[16:19], s35 offen lds
    v_mfma_f32_16x16x32_bf16 v[80:83], v[240:243], v[224:227], v[80:83]
    s_add_u32 s35, s43, 36864
    s_add_u32 m0, s50, 4224
    v_mfma_f32_16x16x32_bf16 v[84:87], v[240:243], v[228:231], v[84:87]
    buffer_load_dwordx4 v249, s[16:19], s35 offen lds
    v_mfma_f32_16x16x32_bf16 v[88:91], v[240:243], v[232:235], v[88:91]
    s_add_u32 s35, s43, 73728
    s_add_u32 m0, s50, 8448
    v_mfma_f32_16x16x32_bf16 v[92:95], v[240:243], v[236:239], v[92:95]
    buffer_load_dwordx4 v249, s[16:19], s35 offen lds
    s_add_u32 s43, s43, 128
LP_jB_91:
    s_waitcnt vmcnt(7) lgkmcnt(0)
    s_barrier
    s_cmp_eq_u32 s32, 0
    s_cbranch_scc1 LP_r0B_92
    ds_read_b64_tr_b16 v[240:241], v251 offset:21120
    ds_read_b64_tr_b16 v[242:243], v251 offset:21632
    s_add_u32 s35, s46, 0
    s_add_u32 m0, s45, 16896
    s_nop 0
    buffer_load_dwordx4 v250, s[20:23], s35 offen lds
    v_mfma_f32_16x16x32_bf16 v[96:99], v[244:247], v[216:219], v[96:99]
    v_mfma_f32_16x16x32_bf16 v[100:103], v[244:247], v[220:223], v[100:103]
    v_mfma_f32_16x16x32_bf16 v[104:107], v[244:247], v[224:227], v[104:107]
    v_mfma_f32_16x16x32_bf16 v[108:111], v[244:247], v[228:231], v[108:111]
    v_mfma_f32_16x16x32_bf16 v[112:115], v[244:247], v[232:235], v[112:115]
    v_mfma_f32_16x16x32_bf16 v[116:119], v[244:247], v[236:239], v[116:119]
    ds_read_b64_tr_b16 v[244:245], v251 offset:25344
    ds_read_b64_tr_b16 v[246:247], v251 offset:25856
    s_waitcnt lgkmcnt(2)
    v_mfma_f32_16x16x32_bf16 v[120:123], v[240:243], v[216:219], v[120:123]
    v_mfma_f32_16x16x32_bf16 v[124:127], v[240:243], v[220:223], v[124:127]
    v_mfma_f32_16x16x32_bf16 v[128:131], v[240:243], v[224:227], v[128:131]
    s_add_u32 s35, s46, 8192
    s_add_u32 m0, s45, 17928
    v_mfma_f32_16x16x32_bf16 v[132:135], v[240:243], v[228:231], v[132:135]
    buffer_load_dwordx4 v250, s[20:23], s35 offen lds
    v_mfma_f32_16x16x32_bf16 v[136:139], v[240:243], v[232:235], v[136:139]
    v_mfma_f32_16x16x32_bf16 v[140:143], v[240:243], v[236:239], v[140:143]
    ds_read_b64_tr_b16 v[240:241], v251 offset:29568
    ds_read_b64_tr_b16 v[242:243], v251 offset:30080
    s_waitcnt lgkmcnt(2)
    v_mfma_f32_16x16x32_bf16 v[144:147], v[244:247], v[216:219], v[144:147]
    v_mfma_f32_16x16x32_bf16 v[148:151], v[244:247], v[220:223], v[148:151]
    v_mfma_f32_16x16x32_bf16 v[152:155], v[244:247], v[224:227], v[152:155]
    v_mfma_f32_16x16x32_bf16 v[156:159], v[244:247], v[228:231], v[156:159]
    v_mfma_f32_16x16x32_bf16 v[160:163], v[244:247], v[232:235], v[160:163]
    v_mfma_f32_16x16x32_bf16 v[164:167], v[244:247], v[236:239], v[164:167]
    ds_read_b64_tr_b16 v[244:245], v251 offset:33792
    ds_read_b64_tr_b16 v[246:247], v251 offset:34304
    s_waitcnt lgkmcnt(2)
    v_mfma_f32_16x16x32_bf16 v[168:171], v[240:243], v[216:219], v[168:171]
    s_add_u32 s35, s46, 16384
    s_add_u32 m0, s45, 19008
    v_mfma_f32_16x16x32_bf16 v[172:175], v[240:243], v[220:223], v[172:175]
    buffer_load_dwordx4 v250, s[20:23], s35 offen lds
    v_mfma_f32_16x16x32_bf16 v[176:179], v[240:243], v[224:227], v[176:179]
    v_mfma_f32_16x16x32_bf16 v[180:183], v[240:243], v[228:231], v[180:183]
    v_mfma_f32_16x16x32_bf16 v[184:187], v[240:243], v[232:235], v[184:187]
    v_mfma_f32_16x16x32_bf16 v[188:191], v[240:243], v[236:239], v[188:191]
    s_waitcnt lgkmcnt(0)
    v_mfma_f32_16x16x32_bf16 v[192:195], v[244:247], v[216:219], v[192:195]
    v_mfma_f32_16x16x32_bf16 v[196:199], v[244:247], v[220:223], v[196:199]
    v_mfma_f32_16x16x32_bf16 v[200:203], v[244:247], v[224:227], v[200:203]
    v_mfma_f32_16x16x32_bf16 v[204:207], v[244:247], v[228:231], v[204:207]
    v_mfma_f32_16x16x32_bf16 v[208:211], v[244:247], v[232:235], v[208:211]
    s_add_u32 s35, s46, 24576
    s_add_u32 m0, s45, 20040
    v_mfma_f32_16x16x32_bf16 v[212:215], v[244:247], v[236:239], v[212:215]
    buffer_load_dwordx4 v250, s[20:23], s35 offen lds
    s_add_u32 s46, s46, 262144
LP_jB_93:
    s_waitcnt vmcnt(4) lgkmcnt(0)
    s_add_u32 s32, s32, 1
    s_branch LP_ROUNDB
LP_ETB:
    s_barrier
    s_cmp_eq_u32 s32, 0
    s_cbranch_scc1 LP_r0B_94
    ds_read_b64_tr_b16 v[244:245], v251 offset:0
    ds_read_b64_tr_b16 v[246:247], v251 offset:512
    s_add_u32 s35, s47, s97
    s_add_u32 m0, s50, 29568
    s_nop 0
    buffer_load_dwordx4 v249, s[24:27], s35 offen lds
    v_mfma_f32_16x16x32_bf16 v[192:195], v[240:243], v[216:219], v[192:195]
    ds_read_b128 v[216:219], v252 offset:6144
    v_mfma_f32_16x16x32_bf16 v[196:199], v[240:243], v[220:223], v[196:199]
    ds_read_b128 v[220:223], v252 offset:7168
    v_mfma_f32_16x16x32_bf16 v[200:203], v[240:243], v[224:227], v[200:203]
    ds_read_b128 v[224:227], v252 offset:8192
    s_add_u32 s35, s47, s98
    s_add_u32 m0, s50, 33792
    v_mfma_f32_16x16x32_bf16 v[204:207], v[240:243], v[228:231], v[204:207]
    ds_read_b128 v[228:231], v252 offset:9216
    buffer_load_dwordx4 v249, s[24:27], s35 offen lds
    s_add_u32 s47, s47, 36864
    v_mfma_f32_16x16x32_bf16 v[208:211], v[240:243], v[232:235], v[208:211]
    ds_read_b128 v[232:235], v252 offset:10240
    v_mfma_f32_16x16x32_bf16 v[212:215], v[240:243], v[236:239], v[212:215]
    ds_read_b128 v[236:239], v252 offset:11264
    ds_read_b64_tr_b16 v[240:241], v251 offset:4224
    ds_read_b64_tr_b16 v[242:243], v251 offset:4736
    v_add_u32 v252, 6144, v252
    s_waitcnt lgkmcnt(8)
    s_add_u32 s35, s47, s95
    s_add_u32 m0, s50, 88704
    s_waitcnt lgkmcnt(6)
    v_mfma_f32_16x16x32_bf16 v[0:3], v[244:247], v[216:219], v[0:3]
    buffer_load_dwordx4 v249, s[24:27], s35 offen lds
    v_mfma_f32_16x16x32_bf16 v[4:7], v[244:247], v[220:223], v[4:7]
    s_waitcnt lgkmcnt(4)
    v_mfma_f32_16x16x32_bf16 v[8:11], v[244:247], v[224:227], v[8:11]
    v_mfma_f32_16x16x32_bf16 v[12:15], v[244:247], v[228:231], v[12:15]
    s_add_u32 s35, s47, s96
    s_add_u32 m0, s50, 92928
    s_waitcnt lgkmcnt(2)
    v_mfma_f32_16x16x32_bf16 v[16:19], v[244:247], v[232:235], v[16:19]
    buffer_load_dwordx4 v249, s[24:27], s35 offen lds
    v_mfma_f32_16x16x32_bf16 v[20:23], v[244:247], v[236:239], v[20:23]
    ds_read_b64_tr_b16 v[244:245], v251 offset:8448
    ds_read_b64_tr_b16 v[246:247], v251 offset:8960
    s_waitcnt lgkmcnt(2)
    v_mfma_f32_16x16x32_bf16 v[24:27], v[240:243], v[216:219], v[24:27]
    s_add_u32 s35, s47, s97
    s_add_u32 m0, s50, 97152
    v_mfma_f32_16x16x32_bf16 v[28:31], v[240:243], v[220:223], v[28:31]
    buffer_load_dwordx4 v249, s[24:27], s35 offen lds
    v_mfma_f32_16x16x32_bf16 v[32:35], v[240:243], v[224:227], v[32:35]
    v_mfma_f32_16x16x32_bf16 v[36:39], v[240:243], v[228:231], v[36:39]
    v_mfma_f32_16x16x32_bf16 v[40:43], v[240:243], v[232:235], v[40:43]
    s_add_u32 s35, s47, s98
    s_add_u32 m0, s50, 101376
    v_mfma_f32_16x16x32_bf16 v[44:47], v[240:243], v[236:239], v[44:47]
    buffer_load_dwordx4 v249, s[24:27], s35 offen lds
LP_jB_95:
    s_waitcnt vmcnt(12) lgkmcnt(0)
    s_barrier
    s_cmp_eq_u32 s32, 0
    s_cbranch_scc1 LP_r0B_96
    ds_read_b64_tr_b16 v[240:241], v251 offset:12672
    ds_read_b64_tr_b16 v[242:243], v251 offset:13184
    s_add_u32 s35, s47, s90
    s_add_u32 m0, s50, 0
    s_nop 0
    buffer_load_dwordx4 v249, s[24:27], s35 offen lds
    v_mfma_f32_16x16x32_bf16 v[48:51], v[244:247], v[216:219], v[48:51]
    v_mfma_f32_16x16x32_bf16 v[52:55], v[244:247], v[220:223], v[52:55]
    v_mfma_f32_16x16x32_bf16 v[56:59], v[244:247], v[224:227], v[56:59]
    v_mfma_f32_16x16x32_bf16 v[60:63], v[244:247], v[228:231], v[60:63]
    v_mfma_f32_16x16x32_bf16 v[64:67], v[244:247], v[232:235], v[64:67]
    s_add_u32 s35, s47, s91
    s_add_u32 m0, s50, 4224
    v_mfma_f32_16x16x32_bf16 v[68:71], v[244:247], v[236:239], v[68:71]
    ds_read_b64_tr_b16 v[244:245], v251 offset:16896
    ds_read_b64_tr_b16 v[246:247], v251 offset:17408
    buffer_load_dwordx4 v249, s[24:27], s35 offen lds
    s_waitcnt lgkmcnt(2)
    v_mfma_f32_16x16x32_bf16 v[72:75], v[240:243], v[216:219], v[72:75]
    v_mfma_f32_16x16x32_bf16 v[76:79], v[240:243], v[220:223], v[76:79]
    v_mfma_f32_16x16x32_bf16 v[80:83], v[240:243], v[224:227], v[80:83]
    v_mfma_f32_16x16x32_bf16 v[84:87], v[240:243], v[228:231], v[84:87]
    v_mfma_f32_16x16x32_bf16 v[88:91], v[240:243], v[232:235], v[88:91]
    s_add_u32 s35, s47, s92
    s_add_u32 m0, s50, 8448
    v_mfma_f32_16x16x32_bf16 v[92:95], v[240:243], v[236:239], v[92:95]
    buffer_load_dwordx4 v249, s[24:27], s35 offen lds
LP_jB_97:
    s_waitcnt vmcnt(7) lgkmcnt(0)
    s_barrier
    s_cmp_eq_u32 s32, 0
    s_cbranch_scc1 LP_r0B_98
    ds_read_b64_tr_b16 v[240:241], v251 offset:21120
    ds_read_b64_tr_b16 v[242:243], v251 offset:21632
    s_add_u32 s35, s47, s93
    s_add_u32 m0, s50, 12672
    s_nop 0
    buffer_load_dwordx4 v249, s[24:27], s35 offen lds
    v_mfma_f32_16x16x32_bf16 v[96:99], v[244:247], v[216:219], v[96:99]
    v_mfma_f32_16x16x32_bf16 v[100:103], v[244:247], v[220:223], v[100:103]
    v_mfma_f32_16x16x32_bf16 v[104:107], v[244:247], v[224:227], v[104:107]
    v_mfma_f32_16x16x32_bf16 v[108:111], v[244:247], v[228:231], v[108:111]
    v_mfma_f32_16x16x32_bf16 v[112:115], v[244:247], v[232:235], v[112:115]
    v_mfma_f32_16x16x32_bf16 v[116:119], v[244:247], v[236:239], v[116:119]
    ds_read_b64_tr_b16 v[244:245], v251 offset:25344
    ds_read_b64_tr_b16 v[246:247], v251 offset:25856
    s_waitcnt lgkmcnt(2)
    v_mfma_f32_16x16x32_bf16 v[120:123], v[240:243], v[216:219], v[120:123]
    v_mfma_f32_16x16x32_bf16 v[124:127], v[240:243], v[220:223], v[124:127]
    v_mfma_f32_16x16x32_bf16 v[128:131], v[240:243], v[224:227], v[128:131]
    v_mfma_f32_16x16x32_bf16 v[132:135], v[240:243], v[228:231], v[132:135]
    v_mfma_f32_16x16x32_bf16 v[136:139], v[240:243], v[232:235], v[136:139]
    v_mfma_f32_16x16x32_bf16 v[140:143], v[240:243], v[236:239], v[140:143]
    ds_read_b64_tr_b16 v[240:241], v251 offset:29568
    ds_read_b64_tr_b16 v[242:243], v251 offset:30080
    s_waitcnt lgkmcnt(2)
    v_mfma_f32_16x16x32_bf16 v[144:147], v[244:247], v[216:219], v[144:147]
    v_mfma_f32_16x16x32_bf16 v[148:151], v[244:247], v[220:223], v[148:151]
    v_mfma_f32_16x16x32_bf16 v[152:155], v[244:247], v[224:227], v[152:155]
    v_mfma_f32_16x16x32_bf16 v[156:159], v[244:247], v[228:231], v[156:159]
    v_mfma_f32_16x16x32_bf16 v[160:163], v[244:247], v[232:235], v[160:163]
    v_mfma_f32_16x16x32_bf16 v[164:167], v[244:247], v[236:239], v[164:167]
    ds_read_b64_tr_b16 v[244:245], v251 offset:33792
    ds_read_b64_tr_b16 v[246:247], v251 offset:34304
    s_waitcnt lgkmcnt(2)
    v_mfma_f32_16x16x32_bf16 v[168:171], v[240:243], v[216:219], v[168:171]
    v_mfma_f32_16x16x32_bf16 v[172:175], v[240:243], v[220:223], v[172:175]
    v_mfma_f32_16x16x32_bf16 v[176:179], v[240:243], v[224:227], v[176:179]
    v_mfma_f32_16x16x32_bf16 v[180:183], v[240:243], v[228:231], v[180:183]
    v_mfma_f32_16x16x32_bf16 v[184:187], v[240:243], v[232:235], v[184:187]
    v_mfma_f32_16x16x32_bf16 v[188:191], v[240:243], v[236:239], v[188:191]
    s_waitcnt lgkmcnt(0)
    v_mfma_f32_16x16x32_bf16 v[192:195], v[244:247], v[216:219], v[192:195]
    v_mfma_f32_16x16x32_bf16 v[196:199], v[244:247], v[220:223], v[196:199]
    v_mfma_f32_16x16x32_bf16 v[200:203], v[244:247], v[224:227], v[200:203]
    v_mfma_f32_16x16x32_bf16 v[204:207], v[244:247], v[228:231], v[204:207]
    v_mfma_f32_16x16x32_bf16 v[208:211], v[244:247], v[232:235], v[208:211]
    s_add_u32 s35, s47, s94
    s_add_u32 m0, s50, 16896
    v_mfma_f32_16x16x32_bf16 v[212:215], v[244:247], v[236:239], v[212:215]
    buffer_load_dwordx4 v249, s[24:27], s35 offen lds
LP_jB_99:
    s_waitcnt vmcnt(0) lgkmcnt(0)
    s_barrier
LP_TAIL0:
    v_mov_b32 v220, 0
    ds_read_b128 v[216:219], v220
    s_waitcnt lgkmcnt(0)
    v_or_b32 v216, v216, v217
    v_or3_b32 v216, v216, v218, v219
    s_nop 0
    v_readfirstlane_b32 s34, v216
    s_nop 1
    s_cmp_lg_u32 s34, 0
    s_cbranch_scc1 LP_SAFE
    v_add_u32 v248, 88704, v251
    v_mov_b32 v249, v253
    ds_read_b64_tr_b16 v[240:241], v251 offset:0
    ds_read_b64_tr_b16 v[242:243], v251 offset:512
    ds_read_b128 v[216:219], v249 offset:0
    ds_read_b128 v[220:223], v249 offset:1024
    ds_read_b128 v[224:227], v249 offset:2048
    ds_read_b128 v[228:231], v249 offset:3072
    ds_read_b128 v[232:235], v249 offset:4096
    ds_read_b128 v[236:239], v249 offset:5120
    ds_read_b64_tr_b16 v[244:245], v251 offset:4224
    ds_read_b64_tr_b16 v[246:247], v251 offset:4736
    s_waitcnt lgkmcnt(8)
    s_waitcnt lgkmcnt(6)
    v_mfma_f32_16x16x32_bf16 v[0:3], v[240:243], v[216:219], v[0:3]
    ds_read_b64_tr_b16 v[252:253], v251 offset:8448
    v_mfma_f32_16x16x32_bf16 v[4:7], v[240:243], v[220:223], v[4:7]
    ds_read_b64_tr_b16 v[254:255], v251 offset:8960
    s_waitcnt lgkmcnt(6)
    v_mfma_f32_16x16x32_bf16 v[8:11], v[240:243], v[224:227], v[8:11]
    v_mfma_f32_16x16x32_bf16 v[12:15], v[240:243], v[228:231], v[12:15]
    s_waitcnt lgkmcnt(4)
    v_mfma_f32_16x16x32_bf16 v[16:19], v[240:243], v[232:235], v[16:19]
    v_mfma_f32_16x16x32_bf16 v[20:23], v[240:243], v[236:239], v[20:23]
    s_waitcnt lgkmcnt(2)
    v_mfma_f32_16x16x32_bf16 v[24:27], v[244:247], v[216:219], v[24:27]
    ds_read_b64_tr_b16 v[240:241], v251 offset:12672
    v_mfma_f32_16x16x32_bf16 v[28:31], v[244:247], v[220:223], v[28:31]
    ds_read_b64_tr_b16 v[242:243], v251 offset:13184
    v_mfma_f32_16x16x32_bf16 v[32:35], v[244:247], v[224:227], v[32:35]
    v_mfma_f32_16x16x32_bf16 v[36:39], v[244:247], v[228:231], v[36:39]
    v_mfma_f32_16x16x32_bf16 v[40:43], v[244:247], v[232:235], v[40:43]
    v_mfma_f32_16x16x32_bf16 v[44:47], v[244:247], v[236:239], v[44:47]
    s_waitcnt lgkmcnt(2)
    v_mfma_f32_16x16x32_bf16 v[48:51], v[252:255], v[216:219], v[48:51]
    ds_read_b64_tr_b16 v[244:245], v251 offset:16896
    v_mfma_f32_16x16x32_bf16 v[52:55], v[252:255], v[220:223], v[52:55]
    ds_read_b64_tr_b16 v[246:247], v251 offset:17408
    v_mfma_f32_16x16x32_bf16 v[56:59], v[252:255], v[224:227], v[56:59]
    v_mfma_f32_16x16x32_bf16 v[60:63], v[252:255], v[228:231], v[60:63]
    v_mfma_f32_16x16x32_bf16 v[64:67], v[252:255], v[232:235], v[64:67]
    v_mfma_f32_16x16x32_bf16 v[68:71], v[252:255], v[236:239], v[68:71]
    s_waitcnt lgkmcnt(2)
    v_mfma_f32_16x16x32_bf16 v[72:75], v[240:243], v[216:219], v[72:75]
    ds_read_b64_tr_b16 v[252:253], v248 offset:0
    v_mfma_f32_16x16x32_bf16 v[76:79], v[240:243], v[220:223], v[76:79]
    ds_read_b64_tr_b16 v[254:255], v248 offset:512
    v_mfma_f32_16x16x32_bf16 v[80:83], v[240:243], v[224:227], v[80:83]
    v_mfma_f32_16x16x32_bf16 v[84:87], v[240:243], v[228:231], v[84:87]
    v_mfma_f32_16x16x32_bf16 v[88:91], v[240:243], v[232:235], v[88:91]
    v_mfma_f32_16x16x32_bf16 v[92:95], v[240:243], v[236:239], v[92:95]
    s_waitcnt lgkmcnt(2)
    v_mfma_f32_16x16x32_bf16 v[96:99], v[244:247], v[216:219], v[96:99]
    ds_read_b64_tr_b16 v[240:241], v248 offset:4224
    v_mfma_f32_16x16x32_bf16 v[100:103], v[244:247], v[220:223], v[100:103]
    ds_read_b64_tr_b16 v[242:243], v248 offset:4736
    v_mfma_f32_16x16x32_bf16 v[104:107], v[244:247], v[224:227], v[104:107]
    v_mfma_f32_16x16x32_bf16 v[108:111], v[244:247], v[228:231], v[108:111]
    v_mfma_f32_16x16x32_bf16 v[112:115], v[244:247], v[232:235], v[112:115]
    v_mfma_f32_16x16x32_bf16 v[116:119], v[244:247], v[236:239], v[116:119]
    s_waitcnt lgkmcnt(2)
    v_mfma_f32_16x16x32_bf16 v[120:123], v[252:255], v[216:219], v[120:123]
    ds_read_b64_tr_b16 v[244:245], v248 offset:8448
    v_mfma_f32_16x16x32_bf16 v[124:127], v[252:255], v[220:223], v[124:127]
    ds_read_b64_tr_b16 v[246:247], v248 offset:8960
    v_mfma_f32_16x16x32_bf16 v[128:131], v[252:255], v[224:227], v[128:131]
    v_mfma_f32_16x16x32_bf16 v[132:135], v[252:255], v[228:231], v[132:135]
    v_mfma_f32_16x16x32_bf16 v[136:139], v[252:255], v[232:235], v[136:139]
    v_mfma_f32_16x16x32_bf16 v[140:143], v[252:255], v[236:239], v[140:143]
    s_waitcnt lgkmcnt(2)
    v_mfma_f32_16x16x32_bf16 v[144:147], v[240:243], v[216:219], v[144:147]
    ds_read_b64_tr_b16 v[252:253], v248 offset:12672
    v_mfma_f32_16x16x32_bf16 v[148:151], v[240:243], v[220:223], v[148:151]
    ds_read_b64_tr_b16 v[254:255], v248 offset:13184
    v_mfma_f32_16x16x32_bf16 v[152:155], v[240:243], v[224:227], v[152:155]
    v_mfma_f32_16x16x32_bf16 v[156:159], v[240:243], v[228:231], v[156:159]
    v_mfma_f32_16x16x32_bf16 v[160:163], v[240:243], v[232:235], v[160:163]
    v_mfma_f32_16x16x32_bf16 v[164:167], v[240:243], v[236:239], v[164:167]
    s_waitcnt lgkmcnt(2)
    v_mfma_f32_16x16x32_bf16 v[168:171], v[244:247], v[216:219], v[168:171]
    v_mfma_f32_16x16x32_bf16 v[172:175], v[244:247], v[220:223], v[172:175]
    v_mfma_f32_16x16x32_bf16 v[176:179], v[244:247], v[224:227], v[176:179]
    v_mfma_f32_16x16x32_bf16 v[180:183], v[244:247], v[228:231], v[180:183]
    v_mfma_f32_16x16x32_bf16 v[184:187], v[244:247], v[232:235], v[184:187]
    v_mfma_f32_16x16x32_bf16 v[188:191], v[244:247], v[236:239], v[188:191]
    s_mov_b32 s33, 3
LP_TAIL:
    s_waitcnt lgkmcnt(0)
    s_barrier
    v_mfma_f32_16x16x32_bf16 v[192:195], v[252:255], v[216:219], v[192:195]
    ds_read_b64_tr_b16 v[240:241], v251 offset:21120
    ds_read_b64_tr_b16 v[242:243], v251 offset:21632
    ds_read_b128 v[216:219], v249 offset:6144
    v_mfma_f32_16x16x32_bf16 v[196:199], v[252:255], v[220:223], v[196:199]
    ds_read_b128 v[220:223], v249 offset:7168
    v_mfma_f32_16x16x32_bf16 v[200:203], v[252:255], v[224:227], v[200:203]
    ds_read_b128 v[224:227], v249 offset:8192
    v_mfma_f32_16x16x32_bf16 v[204:207], v[252:255], v[228:231], v[204:207]
    ds_read_b128 v[228:231], v249 offset:9216
    ds_read_b64_tr_b16 v[244:245], v251 offset:25344
    v_mfma_f32_16x16x32_bf16 v[208:211], v[252:255], v[232:235], v[208:211]
    ds_read_b128 v[232:235], v249 offset:10240
    ds_read_b64_tr_b16 v[246:247], v251 offset:25856
    v_mfma_f32_16x16x32_bf16 v[212:215], v[252:255], v[236:239], v[212:215]
    ds_read_b128 v[236:239], v249 offset:11264
    v_add_u32 v249, 6144, v249
    s_waitcnt lgkmcnt(8)
    s_waitcnt lgkmcnt(6)
    v_mfma_f32_16x16x32_bf16 v[0:3], v[240:243], v[216:219], v[0:3]
    ds_read_b64_tr_b16 v[252:253], v251 offset:29568
    v_mfma_f32_16x16x32_bf16 v[4:7], v[240:243], v[220:223], v[4:7]
    ds_read_b64_tr_b16 v[254:255], v251 offset:30080
    s_waitcnt lgkmcnt(6)
    v_mfma_f32_16x16x32_bf16 v[8:11], v[240:243], v[224:227], v[8:11]
    v_mfma_f32_16x16x32_bf16 v[12:15], v[240:243], v[228:231], v[12:15]
    s_waitcnt lgkmcnt(2)
    v_mfma_f32_16x16x32_bf16 v[16:19], v[240:243], v[232:235], v[16:19]
    v_mfma_f32_16x16x32_bf16 v[20:23], v[240:243], v[236:239], v[20:23]
    v_mfma_f32_16x16x32_bf16 v[24:27], v[244:247], v[216:219], v[24:27]
    ds_read_b64_tr_b16 v[240:241], v251 offset:33792
    v_mfma_f32_16x16x32_bf16 v[28:31], v[244:247], v[220:223], v[28:31]
    ds_read_b64_tr_b16 v[242:243], v251 offset:34304
    v_mfma_f32_16x16x32_bf16 v[32:35], v[244:247], v[224:227], v[32:35]
    v_mfma_f32_16x16x32_bf16 v[36:39], v[244:247], v[228:231], v[36:39]
    v_mfma_f32_16x16x32_bf16 v[40:43], v[244:247], v[232:235], v[40:43]
    v_mfma_f32_16x16x32_bf16 v[44:47], v[244:247], v[236:239], v[44:47]
    s_waitcnt lgkmcnt(2)
    v_mfma_f32_16x16x32_bf16 v[48:51], v[252:255], v[216:219], v[48:51]
    ds_read_b64_tr_b16 v[244:245], v251 offset:38016
    v_mfma_f32_16x16x32_bf16 v[52:55], v[252:255], v[220:223], v[52:55]
    ds_read_b64_tr_b16 v[246:247], v251 offset:38528
    v_mfma_f32_16x16x32_bf16 v[56:59], v[252:255], v[224:227], v[56:59]
    v_mfma_f32_16x16x32_bf16 v[60:63], v[252:255], v[228:231], v[60:63]
    v_mfma_f32_16x16x32_bf16 v[64:67], v[252:255], v[232:235], v[64:67]
    v_mfma_f32_16x16x32_bf16 v[68:71], v[252:255], v[236:239], v[68:71]
    s_waitcnt lgkmcnt(2)
    v_mfma_f32_16x16x32_bf16 v[72:75], v[240:243], v[216:219], v[72:75]
    ds_read_b64_tr_b16 v[252:253], v251 offset:42240
    v_mfma_f32_16x16x32_bf16 v[76:79], v[240:243], v[220:223], v[76:79]
    ds_read_b64_tr_b16 v[254:255], v251 offset:42752
    v_mfma_f32_16x16x32_bf16 v[80:83], v[240:243], v[224:227], v[80:83]
    v_mfma_f32_16x16x32_bf16 v[84:87], v[240:243], v[228:231], v[84:87]
    v_mfma_f32_16x16x32_bf16 v[88:91], v[240:243], v[232:235], v[88:91]
    v_mfma_f32_16x16x32_bf16 v[92:95], v[240:243], v[236:239], v[92:95]
    s_waitcnt lgkmcnt(2)
    v_mfma_f32_16x16x32_bf16 v[96:99], v[244:247], v[216:219], v[96:99]
    ds_read_b64_tr_b16 v[240:241], v251 offset:46464
    v_mfma_f32_16x16x32_bf16 v[100:103], v[244:247], v[220:223], v[100:103]
    ds_read_b64_tr_b16 v[242:243], v251 offset:46976
    v_mfma_f32_16x16x32_bf16 v[104:107], v[244:247], v[224:227], v[104:107]
    v_mfma_f32_16x16x32_bf16 v[108:111], v[244:247], v[228:231], v[108:111]
    v_mfma_f32_16x16x32_bf16 v[112:115], v[244:247], v[232:235], v[112:115]
    v_mfma_f32_16x16x32_bf16 v[116:119], v[244:247], v[236:239], v[116:119]
    s_waitcnt lgkmcnt(2)
    v_mfma_f32_16x16x32_bf16 v[120:123], v[252:255], v[216:219], v[120:123]
    ds_read_b64_tr_b16 v[244:245], v251 offset:50688
    v_mfma_f32_16x16x32_bf16 v[124:127], v[252:255], v[220:223], v[124:127]
    ds_read_b64_tr_b16 v[246:247], v251 offset:51200
    v_mfma_f32_16x16x32_bf16 v[128:131], v[252:255], v[224:227], v[128:131]
    v_mfma_f32_16x16x32_bf16 v[132:135], v[252:255], v[228:231], v[132:135]
    v_mfma_f32_16x16x32_bf16 v[136:139], v[252:255], v[232:235], v[136:139]
    v_mfma_f32_16x16x32_bf16 v[140:143], v[252:255], v[236:239], v[140:143]
    s_waitcnt lgkmcnt(2)
    v_mfma_f32_16x16x32_bf16 v[144:147], v[240:243], v[216:219], v[144:147]
    ds_read_b64_tr_b16 v[252:253], v251 offset:54912
    v_mfma_f32_16x16x32_bf16 v[148:151], v[240:243], v[220:223], v[148:151]
    ds_read_b64_tr_b16 v[254:255], v251 offset:55424
    v_mfma_f32_16x16x32_bf16 v[152:155], v[240:243], v[224:227], v[152:155]
    v_mfma_f32_16x16x32_bf16 v[156:159], v[240:243], v[228:231], v[156:159]
    v_mfma_f32_16x16x32_bf16 v[160:163], v[240:243], v[232:235], v[160:163]
    v_mfma_f32_16x16x32_bf16 v[164:167], v[240:243], v[236:239], v[164:167]
    s_waitcnt lgkmcnt(2)
    v_mfma_f32_16x16x32_bf16 v[168:171], v[244:247], v[216:219], v[168:171]
    v_mfma_f32_16x16x32_bf16 v[172:175], v[244:247], v[220:223], v[172:175]
    v_mfma_f32_16x16x32_bf16 v[176:179], v[244:247], v[224:227], v[176:179]
    v_mfma_f32_16x16x32_bf16 v[180:183], v[244:247], v[228:231], v[180:183]
    v_mfma_f32_16x16x32_bf16 v[184:187], v[244:247], v[232:235], v[184:187]
    v_mfma_f32_16x16x32_bf16 v[188:191], v[244:247], v[236:239], v[188:191]
    s_waitcnt lgkmcnt(0)
    s_barrier
    v_mfma_f32_16x16x32_bf16 v[192:195], v[252:255], v[216:219], v[192:195]
    ds_read_b64_tr_b16 v[240:241], v251 offset:0
    ds_read_b64_tr_b16 v[242:243], v251 offset:512
    ds_read_b128 v[216:219], v249 offset:6144
    v_mfma_f32_16x16x32_bf16 v[196:199], v[252:255], v[220:223], v[196:199]
    ds_read_b128 v[220:223], v249 offset:7168
    v_mfma_f32_16x16x32_bf16 v[200:203], v[252:255], v[224:227], v[200:203]
    ds_read_b128 v[224:227], v249 offset:8192
    v_mfma_f32_16x16x32_bf16 v[204:207], v[252:255], v[228:231], v[204:207]
    ds_read_b128 v[228:231], v249 offset:9216
    ds_read_b64_tr_b16 v[244:245], v251 offset:4224
    v_mfma_f32_16x16x32_bf16 v[208:211], v[252:255], v[232:235], v[208:211]
    ds_read_b128 v[232:235], v249 offset:10240
    ds_read_b64_tr_b16 v[246:247], v251 offset:4736
    v_mfma_f32_16x16x32_bf16 v[212:215], v[252:255], v[236:239], v[212:215]
    ds_read_b128 v[236:239], v249 offset:11264
    v_add_u32 v249, 6144, v249
    s_waitcnt lgkmcnt(8)
    s_waitcnt lgkmcnt(6)
    v_mfma_f32_16x16x32_bf16 v[0:3], v[240:243], v[216:219], v[0:3]
    ds_read_b64_tr_b16 v[252:253], v251 offset:8448
    v_mfma_f32_16x16x32_bf16 v[4:7], v[240:243], v[220:223], v[4:7]
    ds_read_b64_tr_b16 v[254:255], v251 offset:8960
    s_waitcnt lgkmcnt(6)
    v_mfma_f32_16x16x32_bf16 v[8:11], v[240:243], v[224:227], v[8:11]
    v_mfma_f32_16x16x32_bf16 v[12:15], v[240:243], v[228:231], v[12:15]
    s_waitcnt lgkmcnt(2)
    v_mfma_f32_16x16x32_bf16 v[16:19], v[240:243], v[232:235], v[16:19]
    v_mfma_f32_16x16x32_bf16 v[20:23], v[240:243], v[236:239], v[20:23]
    v_mfma_f32_16x16x32_bf16 v[24:27], v[244:247], v[216:219], v[24:27]
    ds_read_b64_tr_b16 v[240:241], v251 offset:12672
    v_mfma_f32_16x16x32_bf16 v[28:31], v[244:247], v[220:223], v[28:31]
    ds_read_b64_tr_b16 v[242:243], v251 offset:13184
    v_mfma_f32_16x16x32_bf16 v[32:35], v[244:247], v[224:227], v[32:35]
    v_mfma_f32_16x16x32_bf16 v[36:39], v[244:247], v[228:231], v[36:39]
    v_mfma_f32_16x16x32_bf16 v[40:43], v[244:247], v[232:235], v[40:43]
    v_mfma_f32_16x16x32_bf16 v[44:47], v[244:247], v[236:239], v[44:47]
    s_waitcnt lgkmcnt(2)
    v_mfma_f32_16x16x32_bf16 v[48:51], v[252:255], v[216:219], v[48:51]
    ds_read_b64_tr_b16 v[244:245], v251 offset:16896
    v_mfma_f32_16x16x32_bf16 v[52:55], v[252:255], v[220:223], v[52:55]
    ds_read_b64_tr_b16 v[246:247], v251 offset:17408
    v_mfma_f32_16x16x32_bf16 v[56:59], v[252:255], v[224:227], v[56:59]
    v_mfma_f32_16x16x32_bf16 v[60:63], v[252:255], v[228:231], v[60:63]
    v_mfma_f32_16x16x32_bf16 v[64:67], v[252:255], v[232:235], v[64:67]
    v_mfma_f32_16x16x32_bf16 v[68:71], v[252:255], v[236:239], v[68:71]
    s_waitcnt lgkmcnt(2)
    v_mfma_f32_16x16x32_bf16 v[72:75], v[240:243], v[216:219], v[72:75]
    ds_read_b64_tr_b16 v[252:253], v248 offset:0
    v_mfma_f32_16x16x32_bf16 v[76:79], v[240:243], v[220:223], v[76:79]
    ds_read_b64_tr_b16 v[254:255], v248 offset:512
    v_mfma_f32_16x16x32_bf16 v[80:83], v[240:243], v[224:227], v[80:83]
    v_mfma_f32_16x16x32_bf16 v[84:87], v[240:243], v[228:231], v[84:87]
    v_mfma_f32_16x16x32_bf16 v[88:91], v[240:243], v[232:235], v[88:91]
    v_mfma_f32_16x16x32_bf16 v[92:95], v[240:243], v[236:239], v[92:95]
    s_waitcnt lgkmcnt(2)
    v_mfma_f32_16x16x32_bf16 v[96:99], v[244:247], v[216:219], v[96:99]
    ds_read_b64_tr_b16 v[240:241], v248 offset:4224
    v_mfma_f32_16x16x32_bf16 v[100:103], v[244:247], v[220:223], v[100:103]
    ds_read_b64_tr_b16 v[242:243], v248 offset:4736
    v_mfma_f32_16x16x32_bf16 v[104:107], v[244:247], v[224:227], v[104:107]
    v_mfma_f32_16x16x32_bf16 v[108:111], v[244:247], v[228:231], v[108:111]
    v_mfma_f32_16x16x32_bf16 v[112:115], v[244:247], v[232:235], v[112:115]
    v_mfma_f32_16x16x32_bf16 v[116:119], v[244:247], v[236:239], v[116:119]
    s_waitcnt lgkmcnt(2)
    v_mfma_f32_16x16x32_bf16 v[120:123], v[252:255], v[216:219], v[120:123]
    ds_read_b64_tr_b16 v[244:245], v248 offset:8448
    v_mfma_f32_16x16x32_bf16 v[124:127], v[252:255], v[220:223], v[124:127]
    ds_read_b64_tr_b16 v[246:247], v248 offset:8960
    v_mfma_f32_16x16x32_bf16 v[128:131], v[252:255], v[224:227], v[128:131]
    v_mfma_f32_16x16x32_bf16 v[132:135], v[252:255], v[228:231], v[132:135]
    v_mfma_f32_16x16x32_bf16 v[136:139], v[252:255], v[232:235], v[136:139]
    v_mfma_f32_16x16x32_bf16 v[140:143], v[252:255], v[236:239], v[140:143]
    s_waitcnt lgkmcnt(2)
    v_mfma_f32_16x16x32_bf16 v[144:147], v[240:243], v[216:219], v[144:147]
    ds_read_b64_tr_b16 v[252:253], v248 offset:12672
    v_mfma_f32_16x16x32_bf16 v[148:151], v[240:243], v[220:223], v[148:151]
    ds_read_b64_tr_b16 v[254:255], v248 offset:13184
    v_mfma_f32_16x16x32_bf16 v[152:155], v[240:243], v[224:227], v[152:155]
    v_mfma_f32_16x16x32_bf16 v[156:159], v[240:243], v[228:231], v[156:159]
    v_mfma_f32_16x16x32_bf16 v[160:163], v[240:243], v[232:235], v[160:163]
    v_mfma_f32_16x16x32_bf16 v[164:167], v[240:243], v[236:239], v[164:167]
    s_waitcnt lgkmcnt(2)
    v_mfma_f32_16x16x32_bf16 v[168:171], v[244:247], v[216:219], v[168:171]
    v_mfma_f32_16x16x32_bf16 v[172:175], v[244:247], v[220:223], v[172:175]
    v_mfma_f32_16x16x32_bf16 v[176:179], v[244:247], v[224:227], v[176:179]
    v_mfma_f32_16x16x32_bf16 v[180:183], v[244:247], v[228:231], v[180:183]
    v_mfma_f32_16x16x32_bf16 v[184:187], v[244:247], v[232:235], v[184:187]
    v_mfma_f32_16x16x32_bf16 v[188:191], v[244:247], v[236:239], v[188:191]
    s_sub_u32 s33, s33, 1
    s_cmp_lg_u32 s33, 0
    s_cbranch_scc1 LP_TAIL
    s_lshl_b32 s34, s4, 5
    s_add_u32 s34, s34, s5
    s_mul_i32 s34, s34, 442368
    s_add_u32 s28, s68, s34
    s_addc_u32 s29, s69, 0
    s_and_b32 s29, s29, 0xffff
    s_mov_b32 s30, 442368
    s_mov_b32 s31, 0x20000
    v_mbcnt_lo_u32_b32 v250, -1, 0
    v_mbcnt_hi_u32_b32 v250, -1, v250
    v_lshlrev_b32 v250, 4, v250
    s_lshl_b32 s34, s6, 2
    s_add_u32 s34, s34, s36
    s_lshl_b32 s34, s34, 10
    v_add_u32 v250, s34, v250
    s_waitcnt lgkmcnt(0)
    s_barrier
    v_mfma_f32_16x16x32_bf16 v[192:195], v[252:255], v[216:219], v[192:195]
    ds_read_b64_tr_b16 v[240:241], v251 offset:21120
    ds_read_b64_tr_b16 v[242:243], v251 offset:21632
    ds_read_b128 v[216:219], v249 offset:6144
    v_mfma_f32_16x16x32_bf16 v[196:199], v[252:255], v[220:223], v[196:199]
    ds_read_b128 v[220:223], v249 offset:7168
    v_mfma_f32_16x16x32_bf16 v[200:203], v[252:255], v[224:227], v[200:203]
    ds_read_b128 v[224:227], v249 offset:8192
    v_mfma_f32_16x16x32_bf16 v[204:207], v[252:255], v[228:231], v[204:207]
    ds_read_b128 v[228:231], v249 offset:9216
    ds_read_b64_tr_b16 v[244:245], v251 offset:25344
    v_mfma_f32_16x16x32_bf16 v[208:211], v[252:255], v[232:235], v[208:211]
    ds_read_b128 v[232:235], v249 offset:10240
    ds_read_b64_tr_b16 v[246:247], v251 offset:25856
    v_mfma_f32_16x16x32_bf16 v[212:215], v[252:255], v[236:239], v[212:215]
    ds_read_b128 v[236:239], v249 offset:11264
    v_add_u32 v249, 6144, v249
    s_waitcnt lgkmcnt(8)
    s_waitcnt lgkmcnt(6)
    v_mfma_f32_16x16x32_bf16 v[0:3], v[240:243], v[216:219], v[0:3]
    ds_read_b64_tr_b16 v[252:253], v251 offset:29568
    v_mfma_f32_16x16x32_bf16 v[4:7], v[240:243], v[220:223], v[4:7]
    ds_read_b64_tr_b16 v[254:255], v251 offset:30080
    s_waitcnt lgkmcnt(6)
    v_mfma_f32_16x16x32_bf16 v[8:11], v[240:243], v[224:227], v[8:11]
    v_mfma_f32_16x16x32_bf16 v[12:15], v[240:243], v[228:231], v[12:15]
    s_waitcnt lgkmcnt(2)
    v_mfma_f32_16x16x32_bf16 v[16:19], v[240:243], v[232:235], v[16:19]
    v_mfma_f32_16x16x32_bf16 v[20:23], v[240:243], v[236:239], v[20:23]
    v_mfma_f32_16x16x32_bf16 v[24:27], v[244:247], v[216:219], v[24:27]
    ds_read_b64_tr_b16 v[240:241], v251 offset:33792
    v_mfma_f32_16x16x32_bf16 v[28:31], v[244:247], v[220:223], v[28:31]
    ds_read_b64_tr_b16 v[242:243], v251 offset:34304
    v_mfma_f32_16x16x32_bf16 v[32:35], v[244:247], v[224:227], v[32:35]
    v_mfma_f32_16x16x32_bf16 v[36:39], v[244:247], v[228:231], v[36:39]
    v_mfma_f32_16x16x32_bf16 v[40:43], v[244:247], v[232:235], v[40:43]
    v_mfma_f32_16x16x32_bf16 v[44:47], v[244:247], v[236:239], v[44:47]
    s_waitcnt lgkmcnt(2)
    v_mfma_f32_16x16x32_bf16 v[48:51], v[252:255], v[216:219], v[48:51]
    ds_read_b64_tr_b16 v[244:245], v251 offset:38016
    v_mfma_f32_16x16x32_bf16 v[52:55], v[252:255], v[220:223], v[52:55]
    ds_read_b64_tr_b16 v[246:247], v251 offset:38528
    v_mfma_f32_16x16x32_bf16 v[56:59], v[252:255], v[224:227], v[56:59]
    v_mfma_f32_16x16x32_bf16 v[60:63], v[252:255], v[228:231], v[60:63]
    v_mfma_f32_16x16x32_bf16 v[64:67], v[252:255], v[232:235], v[64:67]
    v_mfma_f32_16x16x32_bf16 v[68:71], v[252:255], v[236:239], v[68:71]
    s_waitcnt lgkmcnt(2)
    v_mfma_f32_16x16x32_bf16 v[72:75], v[240:243], v[216:219], v[72:75]
    ds_read_b64_tr_b16 v[252:253], v251 offset:42240
    v_mfma_f32_16x16x32_bf16 v[76:79], v[240:243], v[220:223], v[76:79]
    ds_read_b64_tr_b16 v[254:255], v251 offset:42752
    v_mfma_f32_16x16x32_bf16 v[80:83], v[240:243], v[224:227], v[80:83]
    v_mfma_f32_16x16x32_bf16 v[84:87], v[240:243], v[228:231], v[84:87]
    v_mfma_f32_16x16x32_bf16 v[88:91], v[240:243], v[232:235], v[88:91]
    v_mfma_f32_16x16x32_bf16 v[92:95], v[240:243], v[236:239], v[92:95]
    s_waitcnt lgkmcnt(2)
    v_mfma_f32_16x16x32_bf16 v[96:99], v[244:247], v[216:219], v[96:99]
    ds_read_b64_tr_b16 v[240:241], v251 offset:46464
    v_mfma_f32_16x16x32_bf16 v[100:103], v[244:247], v[220:223], v[100:103]
    ds_read_b64_tr_b16 v[242:243], v251 offset:46976
    v_mfma_f32_16x16x32_bf16 v[104:107], v[244:247], v[224:227], v[104:107]
    v_mfma_f32_16x16x32_bf16 v[108:111], v[244:247], v[228:231], v[108:111]
    v_mfma_f32_16x16x32_bf16 v[112:115], v[244:247], v[232:235], v[112:115]
    v_mfma_f32_16x16x32_bf16 v[116:119], v[244:247], v[236:239], v[116:119]
    s_waitcnt lgkmcnt(2)
    v_mfma_f32_16x16x32_bf16 v[120:123], v[252:255], v[216:219], v[120:123]
    ds_read_b64_tr_b16 v[244:245], v251 offset:50688
    v_mfma_f32_16x16x32_bf16 v[124:127], v[252:255], v[220:223], v[124:127]
    ds_read_b64_tr_b16 v[246:247], v251 offset:51200
    v_mfma_f32_16x16x32_bf16 v[128:131], v[252:255], v[224:227], v[128:131]
    v_mfma_f32_16x16x32_bf16 v[132:135], v[252:255], v[228:231], v[132:135]
    v_mfma_f32_16x16x32_bf16 v[136:139], v[252:255], v[232:235], v[136:139]
    v_mfma_f32_16x16x32_bf16 v[140:143], v[252:255], v[236:239], v[140:143]
    s_waitcnt lgkmcnt(2)
    v_mfma_f32_16x16x32_bf16 v[144:147], v[240:243], v[216:219], v[144:147]
    ds_read_b64_tr_b16 v[252:253], v251 offset:54912
    v_mfma_f32_16x16x32_bf16 v[148:151], v[240:243], v[220:223], v[148:151]
    ds_read_b64_tr_b16 v[254:255], v251 offset:55424
    v_mfma_f32_16x16x32_bf16 v[152:155], v[240:243], v[224:227], v[152:155]
    v_mfma_f32_16x16x32_bf16 v[156:159], v[240:243], v[228:231], v[156:159]
    v_mfma_f32_16x16x32_bf16 v[160:163], v[240:243], v[232:235], v[160:163]
    v_mfma_f32_16x16x32_bf16 v[164:167], v[240:243], v[236:239], v[164:167]
    s_waitcnt lgkmcnt(2)
    v_mfma_f32_16x16x32_bf16 v[168:171], v[244:247], v[216:219], v[168:171]
    v_mfma_f32_16x16x32_bf16 v[172:175], v[244:247], v[220:223], v[172:175]
    v_mfma_f32_16x16x32_bf16 v[176:179], v[244:247], v[224:227], v[176:179]
    v_mfma_f32_16x16x32_bf16 v[180:183], v[244:247], v[228:231], v[180:183]
    v_mfma_f32_16x16x32_bf16 v[184:187], v[244:247], v[232:235], v[184:187]
    v_mfma_f32_16x16x32_bf16 v[188:191], v[244:247], v[236:239], v[188:191]
    s_waitcnt lgkmcnt(0)
    v_mfma_f32_16x16x32_bf16 v[192:195], v[252:255], v[216:219], v[192:195]
    v_mfma_f32_16x16x32_bf16 v[196:199], v[252:255], v[220:223], v[196:199]
    v_mfma_f32_16x16x32_bf16 v[200:203], v[252:255], v[224:227], v[200:203]
    v_mfma_f32_16x16x32_bf16 v[204:207], v[252:255], v[228:231], v[204:207]
    v_mfma_f32_16x16x32_bf16 v[208:211], v[252:255], v[232:235], v[208:211]
    v_mfma_f32_16x16x32_bf16 v[212:215], v[252:255], v[236:239], v[212:215]
    s_waitcnt lgkmcnt(0)
    s_barrier
    v_cvt_pk_bf16_f32 v48, v48, v49
    v_cvt_pk_bf16_f32 v49, v50, v51
    v_cvt_pk_bf16_f32 v50, v52, v53
    v_cvt_pk_bf16_f32 v51, v54, v55
    s_mul_i32 s34, s92, 384
    s_add_u32 s34, s34, 0
    buffer_store_dwordx4 v[48:51], v250, s[28:31], s34 offen sc1
    v_cvt_pk_bf16_f32 v56, v56, v57
    v_cvt_pk_bf16_f32 v57, v58, v59
    v_cvt_pk_bf16_f32 v58, v60, v61
    v_cvt_pk_bf16_f32 v59, v62, v63
    s_mul_i32 s34, s92, 384
    s_add_u32 s34, s34, 16384
    buffer_store_dwordx4 v[56:59], v250, s[28:31], s34 offen sc1
    v_cvt_pk_bf16_f32 v64, v64, v65
    v_cvt_pk_bf16_f32 v65, v66, v67
    v_cvt_pk_bf16_f32 v66, v68, v69
    v_cvt_pk_bf16_f32 v67, v70, v71
    s_mul_i32 s34, s92, 384
    s_add_u32 s34, s34, 32768
    buffer_store_dwordx4 v[64:67], v250, s[28:31], s34 offen sc1
    v_cvt_pk_bf16_f32 v72, v72, v73
    v_cvt_pk_bf16_f32 v73, v74, v75
    v_cvt_pk_bf16_f32 v74, v76, v77
    v_cvt_pk_bf16_f32 v75, v78, v79
    s_mul_i32 s34, s93, 384
    s_add_u32 s34, s34, 0
    buffer_store_dwordx4 v[72:75], v250, s[28:31], s34 offen sc1
    v_cvt_pk_bf16_f32 v80, v80, v81
    v_cvt_pk_bf16_f32 v81, v82, v83
    v_cvt_pk_bf16_f32 v82, v84, v85
    v_cvt_pk_bf16_f32 v83, v86, v87
    s_mul_i32 s34, s93, 384
    s_add_u32 s34, s34, 16384
    buffer_store_dwordx4 v[80:83], v250, s[28:31], s34 offen sc1
    v_cvt_pk_bf16_f32 v88, v88, v89
    v_cvt_pk_bf16_f32 v89, v90, v91
    v_cvt_pk_bf16_f32 v90, v92, v93
    v_cvt_pk_bf16_f32 v91, v94, v95
    s_mul_i32 s34, s93, 384
    s_add_u32 s34, s34, 32768
    buffer_store_dwordx4 v[88:91], v250, s[28:31], s34 offen sc1
    v_cvt_pk_bf16_f32 v96, v96, v97
    v_cvt_pk_bf16_f32 v97, v98, v99
    v_cvt_pk_bf16_f32 v98, v100, v101
    v_cvt_pk_bf16_f32 v99, v102, v103
    s_mul_i32 s34, s94, 384
    s_add_u32 s34, s34, 0
    buffer_store_dwordx4 v[96:99], v250, s[28:31], s34 offen sc1
    v_cvt_pk_bf16_f32 v104, v104, v105
    v_cvt_pk_bf16_f32 v105, v106, v107
    v_cvt_pk_bf16_f32 v106, v108, v109
    v_cvt_pk_bf16_f32 v107, v110, v111
    s_mul_i32 s34, s94, 384
    s_add_u32 s34, s34, 16384
    buffer_store_dwordx4 v[104:107], v250, s[28:31], s34 offen sc1
    v_cvt_pk_bf16_f32 v112, v112, v113
    v_cvt_pk_bf16_f32 v113, v114, v115
    v_cvt_pk_bf16_f32 v114, v116, v117
    v_cvt_pk_bf16_f32 v115, v118, v119
    s_mul_i32 s34, s94, 384
    s_add_u32 s34, s34, 32768
    buffer_store_dwordx4 v[112:115], v250, s[28:31], s34 offen sc1
    v_cvt_pk_bf16_f32 v120, v120, v121
    v_cvt_pk_bf16_f32 v121, v122, v123
    v_cvt_pk_bf16_f32 v122, v124, v125
    v_cvt_pk_bf16_f32 v123, v126, v127
    s_mul_i32 s34, s95, 384
    s_add_u32 s34, s34, 0
    buffer_store_dwordx4 v[120:123], v250, s[28:31], s34 offen sc1
    v_cvt_pk_bf16_f32 v128, v128, v129
    v_cvt_pk_bf16_f32 v129, v130, v131
    v_cvt_pk_bf16_f32 v130, v132, v133
    v_cvt_pk_bf16_f32 v131, v134, v135
    s_mul_i32 s34, s95, 384
    s_add_u32 s34, s34, 16384
    buffer_store_dwordx4 v[128:131], v250, s[28:31], s34 offen sc1
    v_cvt_pk_bf16_f32 v136, v136, v137
    v_cvt_pk_bf16_f32 v137, v138, v139
    v_cvt_pk_bf16_f32 v138, v140, v141
    v_cvt_pk_bf16_f32 v139, v142, v143
    s_mul_i32 s34, s95, 384
    s_add_u32 s34, s34, 32768
    buffer_store_dwordx4 v[136:139], v250, s[28:31], s34 offen sc1
    v_cvt_pk_bf16_f32 v144, v144, v145
    v_cvt_pk_bf16_f32 v145, v146, v147
    v_cvt_pk_bf16_f32 v146, v148, v149
    v_cvt_pk_bf16_f32 v147, v150, v151
    s_mul_i32 s34, s96, 384
    s_add_u32 s34, s34, 0
    buffer_store_dwordx4 v[144:147], v250, s[28:31], s34 offen sc1
    v_cvt_pk_bf16_f32 v152, v152, v153
    v_cvt_pk_bf16_f32 v153, v154, v155
    v_cvt_pk_bf16_f32 v154, v156, v157
    v_cvt_pk_bf16_f32 v155, v158, v159
    s_mul_i32 s34, s96, 384
    s_add_u32 s34, s34, 16384
    buffer_store_dwordx4 v[152:155], v250, s[28:31], s34 offen sc1
    v_cvt_pk_bf16_f32 v160, v160, v161
    v_cvt_pk_bf16_f32 v161, v162, v163
    v_cvt_pk_bf16_f32 v162, v164, v165
    v_cvt_pk_bf16_f32 v163, v166, v167
    s_mul_i32 s34, s96, 384
    s_add_u32 s34, s34, 32768
    buffer_store_dwordx4 v[160:163], v250, s[28:31], s34 offen sc1
    v_cvt_pk_bf16_f32 v168, v168, v169
    v_cvt_pk_bf16_f32 v169, v170, v171
    v_cvt_pk_bf16_f32 v170, v172, v173
    v_cvt_pk_bf16_f32 v171, v174, v175
    s_mul_i32 s34, s97, 384
    s_add_u32 s34, s34, 0
    buffer_store_dwordx4 v[168:171], v250, s[28:31], s34 offen sc1
    v_cvt_pk_bf16_f32 v176, v176, v177
    v_cvt_pk_bf16_f32 v177, v178, v179
    v_cvt_pk_bf16_f32 v178, v180, v181
    v_cvt_pk_bf16_f32 v179, v182, v183
    s_mul_i32 s34, s97, 384
    s_add_u32 s34, s34, 16384
    buffer_store_dwordx4 v[176:179], v250, s[28:31], s34 offen sc1
    v_cvt_pk_bf16_f32 v184, v184, v185
    v_cvt_pk_bf16_f32 v185, v186, v187
    v_cvt_pk_bf16_f32 v186, v188, v189
    v_cvt_pk_bf16_f32 v187, v190, v191
    s_mul_i32 s34, s97, 384
    s_add_u32 s34, s34, 32768
    buffer_store_dwordx4 v[184:187], v250, s[28:31], s34 offen sc1
    v_cvt_pk_bf16_f32 v192, v192, v193
    v_cvt_pk_bf16_f32 v193, v194, v195
    v_cvt_pk_bf16_f32 v194, v196, v197
    v_cvt_pk_bf16_f32 v195, v198, v199
    s_mul_i32 s34, s98, 384
    s_add_u32 s34, s34, 0
    buffer_store_dwordx4 v[192:195], v250, s[28:31], s34 offen sc1
    v_cvt_pk_bf16_f32 v200, v200, v201
    v_cvt_pk_bf16_f32 v201, v202, v203
    v_cvt_pk_bf16_f32 v202, v204, v205
    v_cvt_pk_bf16_f32 v203, v206, v207
    s_mul_i32 s34, s98, 384
    s_add_u32 s34, s34, 16384
    buffer_store_dwordx4 v[200:203], v250, s[28:31], s34 offen sc1
    v_cvt_pk_bf16_f32 v208, v208, v209
    v_cvt_pk_bf16_f32 v209, v210, v211
    v_cvt_pk_bf16_f32 v210, v212, v213
    v_cvt_pk_bf16_f32 v211, v214, v215
    s_mul_i32 s34, s98, 384
    s_add_u32 s34, s34, 32768
    buffer_store_dwordx4 v[208:211], v250, s[28:31], s34 offen sc1
LP_XCHG:
    s_waitcnt vmcnt(0)
    s_barrier
    s_cmp_lg_u32 s36, 0
    s_cbranch_scc1 LP_nopoll
    s_lshl_b32 s34, s4, 5
    s_add_u32 s34, s34, s5
    s_lshl_b32 s34, s34, 2
    s_lshl_b32 s34, s34, 9
    s_add_u32 s34, s34, 100663296
    s_add_u32 s28, s68, s34
    s_addc_u32 s29, s69, 0
    s_and_b32 s29, s29, 0xffff
    s_mov_b32 s30, 512
    s_mov_b32 s31, 0x20000
    s_lshl_b32 s34, s6, 7
    v_mov_b32 v218, s34
    v_mov_b32 v217, s85
    v_mov_b32 v216, s84
    s_mov_b64 exec, 1
    buffer_store_dwordx2 v[216:217], v218, s[28:31], 0 offen sc1
    s_mov_b64 exec, -1
    s_lshl_b32 s34, s4, 5
    s_add_u32 s34, s34, s5
    s_lshl_b32 s34, s34, 2
    s_lshl_b32 s34, s34, 9
    s_add_u32 s34, s34, 100663296
    s_add_u32 s28, s68, s34
    s_addc_u32 s29, s69, 0
    s_and_b32 s29, s29, 0xffff
    s_mov_b32 s30, 512
    s_mov_b32 s31, 0x20000
    v_mbcnt_lo_u32_b32 v218, -1, 0
    v_mbcnt_hi_u32_b32 v218, -1, v218
    v_min_u32 v218, 3, v218
    v_lshlrev_b32 v218, 7, v218
    s_mov_b32 s53, 0
    s_mov_b32 s40, 200000
LP_poll:
    buffer_load_dwordx2 v[216:217], v218, s[28:31], 0 offen sc1
    s_waitcnt vmcnt(0)
    v_cmp_ne_u32 vcc, s84, v216
    v_cmp_ne_u32 s[54:55], s85, v217
    s_nop 1
    s_or_b64 vcc, vcc, s[54:55]
    s_cmp_eq_u64 vcc, 0
    s_cbranch_scc1 LP_poll_ok
    s_sleep 2
    s_sub_u32 s40, s40, 1
    s_cmp_lg_u32 s40, 0
    s_cbranch_scc1 LP_poll
LP_poll_ok:
LP_nopoll:
    s_barrier
    v_mbcnt_lo_u32_b32 v216, -1, 0
    v_mbcnt_hi_u32_b32 v216, -1, v216
    s_lshl_b32 s35, s36, 10
    v_lshlrev_b32 v217, 4, v216
    v_add_u32 v217, s35, v217
    s_lshl_b32 s34, s4, 5
    s_add_u32 s34, s34, s5
    s_mul_i32 s34, s34, 442368
    s_add_u32 s28, s68, s34
    s_addc_u32 s29, s69, 0
    s_and_b32 s29, s29, 0xffff
    s_mov_b32 s30, 442368
    s_mov_b32 s31, 0x20000
    s_add_u32 s41, s6, 1
    s_and_b32 s41, s41, 3
    s_lshl_b32 s41, s41, 12
    s_add_u32 s42, s6, 2
    s_and_b32 s42, s42, 3
    s_lshl_b32 s42, s42, 12
    s_add_u32 s43, s6, 3
    s_and_b32 s43, s43, 3
    s_lshl_b32 s43, s43, 12
    s_mul_i32 s44, s6, 98304
    s_add_u32 s34, s44, s41
    s_add_u32 s34, s34, 0
    buffer_load_dwordx4 v[48:51], v217, s[28:31], s34 offen sc1
    s_add_u32 s34, s44, s42
    s_add_u32 s34, s34, 0
    buffer_load_dwordx4 v[52:55], v217, s[28:31], s34 offen sc1
    s_add_u32 s34, s44, s43
    s_add_u32 s34, s34, 0
    buffer_load_dwordx4 v[56:59], v217, s[28:31], s34 offen sc1
    s_add_u32 s34, s44, s41
    s_add_u32 s34, s34, 16384
    buffer_load_dwordx4 v[60:63], v217, s[28:31], s34 offen sc1
    s_add_u32 s34, s44, s42
    s_add_u32 s34, s34, 16384
    buffer_load_dwordx4 v[64:67], v217, s[28:31], s34 offen sc1
    s_add_u32 s34, s44, s43
    s_add_u32 s34, s34, 16384
    buffer_load_dwordx4 v[68:71], v217, s[28:31], s34 offen sc1
    s_add_u32 s34, s44, s41
    s_add_u32 s34, s34, 32768
    buffer_load_dwordx4 v[72:75], v217, s[28:31], s34 offen sc1
    s_add_u32 s34, s44, s42
    s_add_u32 s34, s34, 32768
    buffer_load_dwordx4 v[76:79], v217, s[28:31], s34 offen sc1
    s_add_u32 s34, s44, s43
    s_add_u32 s34, s34, 32768
    buffer_load_dwordx4 v[80:83], v217, s[28:31], s34 offen sc1
    s_add_u32 s34, s44, s41
    s_add_u32 s34, s34, 49152
    buffer_load_dwordx4 v[84:87], v217, s[28:31], s34 offen sc1
    s_add_u32 s34, s44, s42
    s_add_u32 s34, s34, 49152
    buffer_load_dwordx4 v[88:91], v217, s[28:31], s34 offen sc1
    s_add_u32 s34, s44, s43
    s_add_u32 s34, s34, 49152
    buffer_load_dwordx4 v[92:95], v217, s[28:31], s34 offen sc1
    s_add_u32 s34, s44, s41
    s_add_u32 s34, s34, 65536
    buffer_load_dwordx4 v[96:99], v217, s[28:31], s34 offen sc1
    s_add_u32 s34, s44, s42
    s_add_u32 s34, s34, 65536
    buffer_load_dwordx4 v[100:103], v217, s[28:31], s34 offen sc1
    s_add_u32 s34, s44, s43
    s_add_u32 s34, s34, 65536
    buffer_load_dwordx4 v[104:107], v217, s[28:31], s34 offen sc1
    s_add_u32 s34, s44, s41
    s_add_u32 s34, s34, 81920
    buffer_load_dwordx4 v[108:111], v217, s[28:31], s34 offen sc1
    s_add_u32 s34, s44, s42
    s_add_u32 s34, s34, 81920
    buffer_load_dwordx4 v[112:115], v217, s[28:31], s34 offen sc1
    s_add_u32 s34, s44, s43
    s_add_u32 s34, s34, 81920
    buffer_load_dwordx4 v[116:119], v217, s[28:31], s34 offen sc1
    s_lshl_b32 s44, s6, 14
    s_add_u32 s44, s44, 393216
    s_cmp_lt_u32 s6, 3
    s_cselect_b32 s30, s30, 0
    s_add_u32 s34, s44, 0
    buffer_load_dwordx4 v[120:123], v217, s[28:31], s34 offen sc1
    s_add_u32 s34, s44, 4096
    buffer_load_dwordx4 v[124:127], v217, s[28:31], s34 offen sc1
    s_add_u32 s34, s44, 8192
    buffer_load_dwordx4 v[128:131], v217, s[28:31], s34 offen sc1
    s_add_u32 s34, s44, 12288
    buffer_load_dwordx4 v[132:135], v217, s[28:31], s34 offen sc1
    v_and_b32 v218, 15, v216
    v_mul_u32_u24 v217, 144, v218
    v_lshrrev_b32 v218, 4, v216
    v_lshl_add_u32 v217, v218, 3, v217
    s_lshl_b32 s34, s36, 5
    s_add_u32 s34, s34, 640
    v_add_u32 v217, s34, v217
    s_waitcnt vmcnt(21)
    v_lshlrev_b32 v220, 16, v48
    v_and_b32 v221, 0xffff0000, v48
    v_lshlrev_b32 v222, 16, v49
    v_and_b32 v223, 0xffff0000, v49
    v_lshlrev_b32 v224, 16, v50
    v_and_b32 v225, 0xffff0000, v50
    v_lshlrev_b32 v226, 16, v51
    v_and_b32 v227, 0xffff0000, v51
    v_pk_add_f32 v[0:1], v[0:1], v[220:221]
    v_pk_add_f32 v[2:3], v[2:3], v[222:223]
    v_pk_add_f32 v[4:5], v[4:5], v[224:225]
    v_pk_add_f32 v[6:7], v[6:7], v[226:227]
    s_waitcnt vmcnt(20)
    v_lshlrev_b32 v220, 16, v52
    v_and_b32 v221, 0xffff0000, v52
    v_lshlrev_b32 v222, 16, v53
    v_and_b32 v223, 0xffff0000, v53
    v_lshlrev_b32 v224, 16, v54
    v_and_b32 v225, 0xffff0000, v54
    v_lshlrev_b32 v226, 16, v55
    v_and_b32 v227, 0xffff0000, v55
    v_pk_add_f32 v[0:1], v[0:1], v[220:221]
    v_pk_add_f32 v[2:3], v[2:3], v[222:223]
    v_pk_add_f32 v[4:5], v[4:5], v[224:225]
    v_pk_add_f32 v[6:7], v[6:7], v[226:227]
    s_waitcnt vmcnt(19)
    v_lshlrev_b32 v220, 16, v56
    v_and_b32 v221, 0xffff0000, v56
    v_lshlrev_b32 v222, 16, v57
    v_and_b32 v223, 0xffff0000, v57
    v_lshlrev_b32 v224, 16, v58
    v_and_b32 v225, 0xffff0000, v58
    v_lshlrev_b32 v226, 16, v59
    v_and_b32 v227, 0xffff0000, v59
    v_pk_add_f32 v[0:1], v[0:1], v[220:221]
    v_pk_add_f32 v[2:3], v[2:3], v[222:223]
    v_pk_add_f32 v[4:5], v[4:5], v[224:225]
    v_pk_add_f32 v[6:7], v[6:7], v[226:227]
    v_cvt_pk_bf16_f32 v0, v0, v1
    v_cvt_pk_bf16_f32 v1, v2, v3
    v_cvt_pk_bf16_f32 v2, v4, v5
    v_cvt_pk_bf16_f32 v3, v6, v7
    ds_write_b64 v217, v[0:1] offset:0
    ds_write_b64 v217, v[2:3] offset:2304
    s_waitcnt vmcnt(18)
    v_lshlrev_b32 v220, 16, v60
    v_and_b32 v221, 0xffff0000, v60
    v_lshlrev_b32 v222, 16, v61
    v_and_b32 v223, 0xffff0000, v61
    v_lshlrev_b32 v224, 16, v62
    v_and_b32 v225, 0xffff0000, v62
    v_lshlrev_b32 v226, 16, v63
    v_and_b32 v227, 0xffff0000, v63
    v_pk_add_f32 v[8:9], v[8:9], v[220:221]
    v_pk_add_f32 v[10:11], v[10:11], v[222:223]
    v_pk_add_f32 v[12:13], v[12:13], v[224:225]
    v_pk_add_f32 v[14:15], v[14:15], v[226:227]
    s_waitcnt vmcnt(17)
    v_lshlrev_b32 v220, 16, v64
    v_and_b32 v221, 0xffff0000, v64
    v_lshlrev_b32 v222, 16, v65
    v_and_b32 v223, 0xffff0000, v65
    v_lshlrev_b32 v224, 16, v66
    v_and_b32 v225, 0xffff0000, v66
    v_lshlrev_b32 v226, 16, v67
    v_and_b32 v227, 0xffff0000, v67
    v_pk_add_f32 v[8:9], v[8:9], v[220:221]
    v_pk_add_f32 v[10:11], v[10:11], v[222:223]
    v_pk_add_f32 v[12:13], v[12:13], v[224:225]
    v_pk_add_f32 v[14:15], v[14:15], v[226:227]
    s_waitcnt vmcnt(16)
    v_lshlrev_b32 v220, 16, v68
    v_and_b32 v221, 0xffff0000, v68
    v_lshlrev_b32 v222, 16, v69
    v_and_b32 v223, 0xffff0000, v69
    v_lshlrev_b32 v224, 16, v70
    v_and_b32 v225, 0xffff0000, v70
    v_lshlrev_b32 v226, 16, v71
    v_and_b32 v227, 0xffff0000, v71
    v_pk_add_f32 v[8:9], v[8:9], v[220:221]
    v_pk_add_f32 v[10:11], v[10:11], v[222:223]
    v_pk_add_f32 v[12:13], v[12:13], v[224:225]
    v_pk_add_f32 v[14:15], v[14:15], v[226:227]
    v_cvt_pk_bf16_f32 v8, v8, v9
    v_cvt_pk_bf16_f32 v9, v10, v11
    v_cvt_pk_bf16_f32 v10, v12, v13
    v_cvt_pk_bf16_f32 v11, v14, v15
    ds_write_b64 v217, v[8:9] offset:4608
    ds_write_b64 v217, v[10:11] offset:6912
    s_waitcnt vmcnt(15)
    v_lshlrev_b32 v220, 16, v72
    v_and_b32 v221, 0xffff0000, v72
    v_lshlrev_b32 v222, 16, v73
    v_and_b32 v223, 0xffff0000, v73
    v_lshlrev_b32 v224, 16, v74
    v_and_b32 v225, 0xffff0000, v74
    v_lshlrev_b32 v226, 16, v75
    v_and_b32 v227, 0xffff0000, v75
    v_pk_add_f32 v[16:17], v[16:17], v[220:221]
    v_pk_add_f32 v[18:19], v[18:19], v[222:223]
    v_pk_add_f32 v[20:21], v[20:21], v[224:225]
    v_pk_add_f32 v[22:23], v[22:23], v[226:227]
    s_waitcnt vmcnt(14)
    v_lshlrev_b32 v220, 16, v76
    v_and_b32 v221, 0xffff0000, v76
    v_lshlrev_b32 v222, 16, v77
    v_and_b32 v223, 0xffff0000, v77
    v_lshlrev_b32 v224, 16, v78
    v_and_b32 v225, 0xffff0000, v78
    v_lshlrev_b32 v226, 16, v79
    v_and_b32 v227, 0xffff0000, v79
    v_pk_add_f32 v[16:17], v[16:17], v[220:221]
    v_pk_add_f32 v[18:19], v[18:19], v[222:223]
    v_pk_add_f32 v[20:21], v[20:21], v[224:225]
    v_pk_add_f32 v[22:23], v[22:23], v[226:227]
    s_waitcnt vmcnt(13)
    v_lshlrev_b32 v220, 16, v80
    v_and_b32 v221, 0xffff0000, v80
    v_lshlrev_b32 v222, 16, v81
    v_and_b32 v223, 0xffff0000, v81
    v_lshlrev_b32 v224, 16, v82
    v_and_b32 v225, 0xffff0000, v82
    v_lshlrev_b32 v226, 16, v83
    v_and_b32 v227, 0xffff0000, v83
    v_pk_add_f32 v[16:17], v[16:17], v[220:221]
    v_pk_add_f32 v[18:19], v[18:19], v[222:223]
    v_pk_add_f32 v[20:21], v[20:21], v[224:225]
    v_pk_add_f32 v[22:23], v[22:23], v[226:227]
    v_cvt_pk_bf16_f32 v16, v16, v17
    v_cvt_pk_bf16_f32 v17, v18, v19
    v_cvt_pk_bf16_f32 v18, v20, v21
    v_cvt_pk_bf16_f32 v19, v22, v23
    ds_write_b64 v217, v[16:17] offset:9216
    ds_write_b64 v217, v[18:19] offset:11520
    s_waitcnt vmcnt(12)
    v_lshlrev_b32 v220, 16, v84
    v_and_b32 v221, 0xffff0000, v84
    v_lshlrev_b32 v222, 16, v85
    v_and_b32 v223, 0xffff0000, v85
    v_lshlrev_b32 v224, 16, v86
    v_and_b32 v225, 0xffff0000, v86
    v_lshlrev_b32 v226, 16, v87
    v_and_b32 v227, 0xffff0000, v87
    v_pk_add_f32 v[24:25], v[24:25], v[220:221]
    v_pk_add_f32 v[26:27], v[26:27], v[222:223]
    v_pk_add_f32 v[28:29], v[28:29], v[224:225]
    v_pk_add_f32 v[30:31], v[30:31], v[226:227]
    s_waitcnt vmcnt(11)
    v_lshlrev_b32 v220, 16, v88
    v_and_b32 v221, 0xffff0000, v88
    v_lshlrev_b32 v222, 16, v89
    v_and_b32 v223, 0xffff0000, v89
    v_lshlrev_b32 v224, 16, v90
    v_and_b32 v225, 0xffff0000, v90
    v_lshlrev_b32 v226, 16, v91
    v_and_b32 v227, 0xffff0000, v91
    v_pk_add_f32 v[24:25], v[24:25], v[220:221]
    v_pk_add_f32 v[26:27], v[26:27], v[222:223]
    v_pk_add_f32 v[28:29], v[28:29], v[224:225]
    v_pk_add_f32 v[30:31], v[30:31], v[226:227]
    s_waitcnt vmcnt(10)
    v_lshlrev_b32 v220, 16, v92
    v_and_b32 v221, 0xffff0000, v92
    v_lshlrev_b32 v222, 16, v93
    v_and_b32 v223, 0xffff0000, v93
    v_lshlrev_b32 v224, 16, v94
    v_and_b32 v225, 0xffff0000, v94
    v_lshlrev_b32 v226, 16, v95
    v_and_b32 v227, 0xffff0000, v95
    v_pk_add_f32 v[24:25], v[24:25], v[220:221]
    v_pk_add_f32 v[26:27], v[26:27], v[222:223]
    v_pk_add_f32 v[28:29], v[28:29], v[224:225]
    v_pk_add_f32 v[30:31], v[30:31], v[226:227]
    v_cvt_pk_bf16_f32 v24, v24, v25
    v_cvt_pk_bf16_f32 v25, v26, v27
    v_cvt_pk_bf16_f32 v26, v28, v29
    v_cvt_pk_bf16_f32 v27, v30, v31
    ds_write_b64 v217, v[24:25] offset:13824
    ds_write_b64 v217, v[26:27] offset:16128
    s_waitcnt vmcnt(9)
    v_lshlrev_b32 v220, 16, v96
    v_and_b32 v221, 0xffff0000, v96
    v_lshlrev_b32 v222, 16, v97
    v_and_b32 v223, 0xffff0000, v97
    v_lshlrev_b32 v224, 16, v98
    v_and_b32 v225, 0xffff0000, v98
    v_lshlrev_b32 v226, 16, v99
    v_and_b32 v227, 0xffff0000, v99
    v_pk_add_f32 v[32:33], v[32:33], v[220:221]
    v_pk_add_f32 v[34:35], v[34:35], v[222:223]
    v_pk_add_f32 v[36:37], v[36:37], v[224:225]
    v_pk_add_f32 v[38:39], v[38:39], v[226:227]
    s_waitcnt vmcnt(8)
    v_lshlrev_b32 v220, 16, v100
    v_and_b32 v221, 0xffff0000, v100
    v_lshlrev_b32 v222, 16, v101
    v_and_b32 v223, 0xffff0000, v101
    v_lshlrev_b32 v224, 16, v102
    v_and_b32 v225, 0xffff0000, v102
    v_lshlrev_b32 v226, 16, v103
    v_and_b32 v227, 0xffff0000, v103
    v_pk_add_f32 v[32:33], v[32:33], v[220:221]
    v_pk_add_f32 v[34:35], v[34:35], v[222:223]
    v_pk_add_f32 v[36:37], v[36:37], v[224:225]
    v_pk_add_f32 v[38:39], v[38:39], v[226:227]
    s_waitcnt vmcnt(7)
    v_lshlrev_b32 v220, 16, v104
    v_and_b32 v221, 0xffff0000, v104
    v_lshlrev_b32 v222, 16, v105
    v_and_b32 v223, 0xffff0000, v105
    v_lshlrev_b32 v224, 16, v106
    v_and_b32 v225, 0xffff0000, v106
    v_lshlrev_b32 v226, 16, v107
    v_and_b32 v227, 0xffff0000, v107
    v_pk_add_f32 v[32:33], v[32:33], v[220:221]
    v_pk_add_f32 v[34:35], v[34:35], v[222:223]
    v_pk_add_f32 v[36:37], v[36:37], v[224:225]
    v_pk_add_f32 v[38:39], v[38:39], v[226:227]
    v_cvt_pk_bf16_f32 v32, v32, v33
    v_cvt_pk_bf16_f32 v33, v34, v35
    v_cvt_pk_bf16_f32 v34, v36, v37
    v_cvt_pk_bf16_f32 v35, v38, v39
    ds_write_b64 v217, v[32:33] offset:18432
    ds_write_b64 v217, v[34:35] offset:20736
    s_waitcnt vmcnt(6)
    v_lshlrev_b32 v220, 16, v108
    v_and_b32 v221, 0xffff0000, v108
    v_lshlrev_b32 v222, 16, v109
    v_and_b32 v223, 0xffff0000, v109
    v_lshlrev_b32 v224, 16, v110
    v_and_b32 v225, 0xffff0000, v110
    v_lshlrev_b32 v226, 16, v111
    v_and_b32 v227, 0xffff0000, v111
    v_pk_add_f32 v[40:41], v[40:41], v[220:221]
    v_pk_add_f32 v[42:43], v[42:43], v[222:223]
    v_pk_add_f32 v[44:45], v[44:45], v[224:225]
    v_pk_add_f32 v[46:47], v[46:47], v[226:227]
    s_waitcnt vmcnt(5)
    v_lshlrev_b32 v220, 16, v112
    v_and_b32 v221, 0xffff0000, v112
    v_lshlrev_b32 v222, 16, v113
    v_and_b32 v223, 0xffff0000, v113
    v_lshlrev_b32 v224, 16, v114
    v_and_b32 v225, 0xffff0000, v114
    v_lshlrev_b32 v226, 16, v115
    v_and_b32 v227, 0xffff0000, v115
    v_pk_add_f32 v[40:41], v[40:41], v[220:221]
    v_pk_add_f32 v[42:43], v[42:43], v[222:223]
    v_pk_add_f32 v[44:45], v[44:45], v[224:225]
    v_pk_add_f32 v[46:47], v[46:47], v[226:227]
    s_waitcnt vmcnt(4)
    v_lshlrev_b32 v220, 16, v116
    v_and_b32 v221, 0xffff0000, v116
    v_lshlrev_b32 v222, 16, v117
    v_and_b32 v223, 0xffff0000, v117
    v_lshlrev_b32 v224, 16, v118
    v_and_b32 v225, 0xffff0000, v118
    v_lshlrev_b32 v226, 16, v119
    v_and_b32 v227, 0xffff0000, v119
    v_pk_add_f32 v[40:41], v[40:41], v[220:221]
    v_pk_add_f32 v[42:43], v[42:43], v[222:223]
    v_pk_add_f32 v[44:45], v[44:45], v[224:225]
    v_pk_add_f32 v[46:47], v[46:47], v[226:227]
    v_cvt_pk_bf16_f32 v40, v40, v41
    v_cvt_pk_bf16_f32 v41, v42, v43
    v_cvt_pk_bf16_f32 v42, v44, v45
    v_cvt_pk_bf16_f32 v43, v46, v47
    ds_write_b64 v217, v[40:41] offset:23040
    ds_write_b64 v217, v[42:43] offset:25344
    s_waitcnt vmcnt(3)
    v_lshlrev_b32 v136, 16, v120
    v_and_b32 v137, 0xffff0000, v120
    v_lshlrev_b32 v138, 16, v121
    v_and_b32 v139, 0xffff0000, v121
    v_lshlrev_b32 v140, 16, v122
    v_and_b32 v141, 0xffff0000, v122
    v_lshlrev_b32 v142, 16, v123
    v_and_b32 v143, 0xffff0000, v123
    s_waitcnt vmcnt(2)
    v_lshlrev_b32 v220, 16, v124
    v_and_b32 v221, 0xffff0000, v124
    v_lshlrev_b32 v222, 16, v125
    v_and_b32 v223, 0xffff0000, v125
    v_lshlrev_b32 v224, 16, v126
    v_and_b32 v225, 0xffff0000, v126
    v_lshlrev_b32 v226, 16, v127
    v_and_b32 v227, 0xffff0000, v127
    v_pk_add_f32 v[136:137], v[136:137], v[220:221]
    v_pk_add_f32 v[138:139], v[138:139], v[222:223]
    v_pk_add_f32 v[140:141], v[140:141], v[224:225]
    v_pk_add_f32 v[142:143], v[142:143], v[226:227]
    s_waitcnt vmcnt(1)
    v_lshlrev_b32 v220, 16, v128
    v_and_b32 v221, 0xffff0000, v128
    v_lshlrev_b32 v222, 16, v129
    v_and_b32 v223, 0xffff0000, v129
    v_lshlrev_b32 v224, 16, v130
    v_and_b32 v225, 0xffff0000, v130
    v_lshlrev_b32 v226, 16, v131
    v_and_b32 v227, 0xffff0000, v131
    v_pk_add_f32 v[136:137], v[136:137], v[220:221]
    v_pk_add_f32 v[138:139], v[138:139], v[222:223]
    v_pk_add_f32 v[140:141], v[140:141], v[224:225]
    v_pk_add_f32 v[142:143], v[142:143], v[226:227]
    s_waitcnt vmcnt(0)
    v_lshlrev_b32 v220, 16, v132
    v_and_b32 v221, 0xffff0000, v132
    v_lshlrev_b32 v222, 16, v133
    v_and_b32 v223, 0xffff0000, v133
    v_lshlrev_b32 v224, 16, v134
    v_and_b32 v225, 0xffff0000, v134
    v_lshlrev_b32 v226, 16, v135
    v_and_b32 v227, 0xffff0000, v135
    v_pk_add_f32 v[136:137], v[136:137], v[220:221]
    v_pk_add_f32 v[138:139], v[138:139], v[222:223]
    v_pk_add_f32 v[140:141], v[140:141], v[224:225]
    v_pk_add_f32 v[142:143], v[142:143], v[226:227]
    v_cvt_pk_bf16_f32 v136, v136, v137
    v_cvt_pk_bf16_f32 v137, v138, v139
    v_cvt_pk_bf16_f32 v138, v140, v141
    v_cvt_pk_bf16_f32 v139, v142, v143
    ds_write_b64 v217, v[136:137] offset:27648
    ds_write_b64 v217, v[138:139] offset:29952
    v_lshrrev_b32 v218, 3, v216
    s_lshl_b32 s34, s36, 3
    v_add_u32 v218, s34, v218
    v_and_b32 v216, 7, v216
    v_lshlrev_b32 v216, 4, v216
    v_mul_u32_u24 v217, 144, v218
    v_add_u32 v217, v217, v216
    v_add_u32 v217, 640, v217
    v_mul_u32_u24 v219, 2304, v218
    v_add_u32 v219, v219, v216
    s_mov_b32 s28, s70
    s_and_b32 s29, s71, 0xffff
    s_mov_b32 s30, 7077888
    s_mov_b32 s31, 0x20000
    s_mul_i32 s40, s5, 221184
    s_mul_i32 s34, s4, 1152
    s_add_u32 s40, s40, s34
    s_lshl_b32 s41, s6, 8
    s_add_u32 s41, s41, s40
    s_waitcnt lgkmcnt(0)
    s_barrier
    ds_read_b128 v[48:51], v217 offset:0
    ds_read_b128 v[52:55], v217 offset:4608
    ds_read_b128 v[56:59], v217 offset:9216
    ds_read_b128 v[60:63], v217 offset:13824
    ds_read_b128 v[64:67], v217 offset:18432
    ds_read_b128 v[68:71], v217 offset:23040
    ds_read_b128 v[72:75], v217 offset:27648
    s_add_u32 s42, s41, 0
    s_waitcnt lgkmcnt(6)
    buffer_store_dwordx4 v[48:51], v219, s[28:31], s42 offen
    s_add_u32 s42, s41, 73728
    s_waitcnt lgkmcnt(5)
    buffer_store_dwordx4 v[52:55], v219, s[28:31], s42 offen
    s_add_u32 s42, s41, 147456
    s_waitcnt lgkmcnt(4)
    buffer_store_dwordx4 v[56:59], v219, s[28:31], s42 offen
    s_add_u32 s42, s41, 128
    s_waitcnt lgkmcnt(3)
    buffer_store_dwordx4 v[60:63], v219, s[28:31], s42 offen
    s_add_u32 s42, s41, 73856
    s_waitcnt lgkmcnt(2)
    buffer_store_dwordx4 v[64:67], v219, s[28:31], s42 offen
    s_add_u32 s42, s41, 147584
    s_waitcnt lgkmcnt(1)
    buffer_store_dwordx4 v[68:71], v219, s[28:31], s42 offen
    s_mul_i32 s42, s6, 73728
    s_add_u32 s42, s42, s40
    s_add_u32 s42, s42, 1024
    s_cmp_lt_u32 s6, 3
    s_cselect_b32 s30, s30, 0
    s_waitcnt lgkmcnt(0)
    buffer_store_dwordx4 v[72:75], v219, s[28:31], s42 offen
    s_endpgm
LP_SAFE:
    v_mbcnt_lo_u32_b32 v216, -1, 0
    v_mbcnt_hi_u32_b32 v216, -1, v216
    v_lshrrev_b32 v217, 3, v216
    v_and_b32 v218, 7, v216
    v_lshlrev_b32 v218, 4, v218
    s_lshr_b32 s34, s36, 1
    s_mul_i32 s34, s34, s4
    s_lshl_b32 s34, s34, 17
    s_lshl_b32 s35, s37, 7
    s_add_u32 s34, s34, s35
    v_lshlrev_b32 v248, 10, v217
    v_add3_u32 v248, v248, v218, s34
    s_mov_b32 s52, s45
    v_mov_b32 v0, 0
    v_mov_b32 v1, 0
    v_mov_b32 v2, 0
    v_mov_b32 v3, 0
    v_mov_b32 v4, 0
    v_mov_b32 v5, 0
    v_mov_b32 v6, 0
    v_mov_b32 v7, 0
    v_mov_b32 v8, 0
    v_mov_b32 v9, 0
    v_mov_b32 v10, 0
    v_mov_b32 v11, 0
    v_mov_b32 v12, 0
    v_mov_b32 v13, 0
    v_mov_b32 v14, 0
    v_mov_b32 v15, 0
    v_mov_b32 v16, 0
    v_mov_b32 v17, 0
    v_mov_b32 v18, 0
    v_mov_b32 v19, 0
    v_mov_b32 v20, 0
    v_mov_b32 v21, 0
    v_mov_b32 v22, 0
    v_mov_b32 v23, 0
    v_mov_b32 v24, 0
    v_mov_b32 v25, 0
    v_mov_b32 v26, 0
    v_mov_b32 v27, 0
    v_mov_b32 v28, 0
    v_mov_b32 v29, 0
    v_mov_b32 v30, 0
    v_mov_b32 v31, 0
    v_mov_b32 v32, 0
    v_mov_b32 v33, 0
    v_mov_b32 v34, 0
    v_mov_b32 v35, 0
    v_mov_b32 v36, 0
    v_mov_b32 v37, 0
    v_mov_b32 v38, 0
    v_mov_b32 v39, 0
    v_mov_b32 v40, 0
    v_mov_b32 v41, 0
    v_mov_b32 v42, 0
    v_mov_b32 v43, 0
    v_mov_b32 v44, 0
    v_mov_b32 v45, 0
    v_mov_b32 v46, 0
    v_mov_b32 v47, 0
    v_mov_b32 v48, 0
    v_mov_b32 v49, 0
    v_mov_b32 v50, 0
    v_mov_b32 v51, 0
    v_mov_b32 v52, 0
    v_mov_b32 v53, 0
    v_mov_b32 v54, 0
    v_mov_b32 v55, 0
    v_mov_b32 v56, 0
    v_mov_b32 v57, 0
    v_mov_b32 v58, 0
    v_mov_b32 v59, 0
    v_mov_b32 v60, 0
    v_mov_b32 v61, 0
    v_mov_b32 v62, 0
    v_mov_b32 v63, 0
    v_mov_b32 v64, 0
    v_mov_b32 v65, 0
    v_mov_b32 v66, 0
    v_mov_b32 v67, 0
    v_mov_b32 v68, 0
    v_mov_b32 v69, 0
    v_mov_b32 v70, 0
    v_mov_b32 v71, 0
    v_mov_b32 v72, 0
    v_mov_b32 v73, 0
    v_mov_b32 v74, 0
    v_mov_b32 v75, 0
    v_mov_b32 v76, 0
    v_mov_b32 v77, 0
    v_mov_b32 v78, 0
    v_mov_b32 v79, 0
    v_mov_b32 v80, 0
    v_mov_b32 v81, 0
    v_mov_b32 v82, 0
    v_mov_b32 v83, 0
    v_mov_b32 v84, 0
    v_mov_b32 v85, 0
    v_mov_b32 v86, 0
    v_mov_b32 v87, 0
    v_mov_b32 v88, 0
    v_mov_b32 v89, 0
    v_mov_b32 v90, 0
    v_mov_b32 v91, 0
    v_mov_b32 v92, 0
    v_mov_b32 v93, 0
    v_mov_b32 v94, 0
    v_mov_b32 v95, 0
    v_mov_b32 v96, 0
    v_mov_b32 v97, 0
    v_mov_b32 v98, 0
    v_mov_b32 v99, 0
    v_mov_b32 v100, 0
    v_mov_b32 v101, 0
    v_mov_b32 v102, 0
    v_mov_b32 v103, 0
    v_mov_b32 v104, 0
    v_mov_b32 v105, 0
    v_mov_b32 v106, 0
    v_mov_b32 v107, 0
    v_mov_b32 v108, 0
    v_mov_b32 v109, 0
    v_mov_b32 v110, 0
    v_mov_b32 v111, 0
    v_mov_b32 v112, 0
    v_mov_b32 v113, 0
    v_mov_b32 v114, 0
    v_mov_b32 v115, 0
    v_mov_b32 v116, 0
    v_mov_b32 v117, 0
    v_mov_b32 v118, 0
    v_mov_b32 v119, 0
    v_mov_b32 v120, 0
    v_mov_b32 v121, 0
    v_mov_b32 v122, 0
    v_mov_b32 v123, 0
    v_mov_b32 v124, 0
    v_mov_b32 v125, 0
    v_mov_b32 v126, 0
    v_mov_b32 v127, 0
    v_mov_b32 v128, 0
    v_mov_b32 v129, 0
    v_mov_b32 v130, 0
    v_mov_b32 v131, 0
    v_mov_b32 v132, 0
    v_mov_b32 v133, 0
    v_mov_b32 v134, 0
    v_mov_b32 v135, 0
    v_mov_b32 v136, 0
    v_mov_b32 v137, 0
    v_mov_b32 v138, 0
    v_mov_b32 v139, 0
    v_mov_b32 v140, 0
    v_mov_b32 v141, 0
    v_mov_b32 v142, 0
    v_mov_b32 v143, 0
    v_mov_b32 v144, 0
    v_mov_b32 v145, 0
    v_mov_b32 v146, 0
    v_mov_b32 v147, 0
    v_mov_b32 v148, 0
    v_mov_b32 v149, 0
    v_mov_b32 v150, 0
    v_mov_b32 v151, 0
    v_mov_b32 v152, 0
    v_mov_b32 v153, 0
    v_mov_b32 v154, 0
    v_mov_b32 v155, 0
    v_mov_b32 v156, 0
    v_mov_b32 v157, 0
    v_mov_b32 v158, 0
    v_mov_b32 v159, 0
    v_mov_b32 v160, 0
    v_mov_b32 v161, 0
    v_mov_b32 v162, 0
    v_mov_b32 v163, 0
    v_mov_b32 v164, 0
    v_mov_b32 v165, 0
    v_mov_b32 v166, 0
    v_mov_b32 v167, 0
    v_mov_b32 v168, 0
    v_mov_b32 v169, 0
    v_mov_b32 v170, 0
    v_mov_b32 v171, 0
    v_mov_b32 v172, 0
    v_mov_b32 v173, 0
    v_mov_b32 v174, 0
    v_mov_b32 v175, 0
    v_mov_b32 v176, 0
    v_mov_b32 v177, 0
    v_mov_b32 v178, 0
    v_mov_b32 v179, 0
    v_mov_b32 v180, 0
    v_mov_b32 v181, 0
    v_mov_b32 v182, 0
    v_mov_b32 v183, 0
    v_mov_b32 v184, 0
    v_mov_b32 v185, 0
    v_mov_b32 v186, 0
    v_mov_b32 v187, 0
    v_mov_b32 v188, 0
    v_mov_b32 v189, 0
    v_mov_b32 v190, 0
    v_mov_b32 v191, 0
    v_mov_b32 v192, 0
    v_mov_b32 v193, 0
    v_mov_b32 v194, 0
    v_mov_b32 v195, 0
    v_mov_b32 v196, 0
    v_mov_b32 v197, 0
    v_mov_b32 v198, 0
    v_mov_b32 v199, 0
    v_mov_b32 v200, 0
    v_mov_b32 v201, 0
    v_mov_b32 v202, 0
    v_mov_b32 v203, 0
    v_mov_b32 v204, 0
    v_mov_b32 v205, 0
    v_mov_b32 v206, 0
    v_mov_b32 v207, 0
    v_mov_b32 v208, 0
    v_mov_b32 v209, 0
    v_mov_b32 v210, 0
    v_mov_b32 v211, 0
    v_mov_b32 v212, 0
    v_mov_b32 v213, 0
    v_mov_b32 v214, 0
    v_mov_b32 v215, 0
    s_mov_b32 s46, 0
    s_mov_b32 s47, 0
    s_mov_b32 s26, 1179648
    s_mov_b32 s32, 0
    s_mov_b32 s53, 0
LS_PR:
    s_mov_b32 s43, 0
    s_mov_b32 s33, 9
LS_PQ:
    s_add_u32 s35, s43, 0
    s_add_u32 m0, s50, 0
    s_nop 0
    buffer_load_dwordx4 v249, s[16:19], s35 offen lds
    s_add_u32 s35, s43, 36864
    s_add_u32 m0, s50, 4224
    s_nop 0
    buffer_load_dwordx4 v249, s[16:19], s35 offen lds
    s_add_u32 s35, s43, 73728
    s_add_u32 m0, s50, 8448
    s_nop 0
    buffer_load_dwordx4 v249, s[16:19], s35 offen lds
    s_add_u32 s43, s43, 128
    s_add_u32 s35, s46, 0
    s_add_u32 m0, s45, 0
    s_nop 0
    buffer_load_dwordx4 v250, s[20:23], s35 offen lds
    s_add_u32 s35, s46, 8192
    s_add_u32 m0, s45, 1032
    s_nop 0
    buffer_load_dwordx4 v250, s[20:23], s35 offen lds
    s_add_u32 s35, s46, 16384
    s_add_u32 m0, s45, 2112
    s_nop 0
    buffer_load_dwordx4 v250, s[20:23], s35 offen lds
    s_add_u32 s35, s46, 24576
    s_add_u32 m0, s45, 3144
    s_nop 0
    buffer_load_dwordx4 v250, s[20:23], s35 offen lds
    s_add_u32 s46, s46, 262144
    s_add_u32 s35, s46, 0
    s_add_u32 m0, s45, 16896
    s_nop 0
    buffer_load_dwordx4 v250, s[20:23], s35 offen lds
    s_add_u32 s35, s46, 8192
    s_add_u32 m0, s45, 17928
    s_nop 0
    buffer_load_dwordx4 v250, s[20:23], s35 offen lds
    s_add_u32 s35, s46, 16384
    s_add_u32 m0, s45, 19008
    s_nop 0
    buffer_load_dwordx4 v250, s[20:23], s35 offen lds
    s_add_u32 s35, s46, 24576
    s_add_u32 m0, s45, 20040
    s_nop 0
    buffer_load_dwordx4 v250, s[20:23], s35 offen lds
    s_add_u32 s46, s46, 262144
    s_waitcnt vmcnt(0) lgkmcnt(0)
    s_barrier
    s_barrier
    s_sub_u32 s33, s33, 1
    s_cmp_lg_u32 s33, 0
    s_cbranch_scc1 LS_PQ
    s_sub_u32 s46, s46, 4718080
    s_mov_b32 s41, s53
    s_mov_b32 s33, 16
LS_PM:
    s_add_u32 m0, s52, 0
    s_nop 0
    buffer_load_dwordx4 v248, s[8:11], s41 offen offset:0 nt lds
    s_add_u32 m0, s52, 800
    s_nop 0
    buffer_load_dwordx4 v248, s[8:11], s41 offen offset:256 nt lds
    s_add_u32 m0, s52, 1600
    s_nop 0
    buffer_load_dwordx4 v248, s[8:11], s41 offen offset:512 nt lds
    s_add_u32 m0, s52, 2400
    s_nop 0
    buffer_load_dwordx4 v248, s[8:11], s41 offen offset:768 nt lds
    s_add_u32 s41, s41, 8192
    s_waitcnt vmcnt(0) lgkmcnt(0)
    s_barrier
    s_barrier
    s_sub_u32 s33, s33, 1
    s_cmp_lg_u32 s33, 0
    s_cbranch_scc1 LS_PM
    s_mov_b32 s41, s53
    s_mov_b32 s33, 16
LS_PA:
    s_add_u32 m0, s52, 0
    s_nop 0
    buffer_load_dwordx4 v248, s[8:11], s41 offen offset:0 nt lds
    s_add_u32 m0, s52, 800
    s_nop 0
    buffer_load_dwordx4 v248, s[8:11], s41 offen offset:256 nt lds
    s_add_u32 m0, s52, 1600
    s_nop 0
    buffer_load_dwordx4 v248, s[8:11], s41 offen offset:512 nt lds
    s_add_u32 m0, s52, 2400
    s_nop 0
    buffer_load_dwordx4 v248, s[8:11], s41 offen offset:768 nt lds
    s_add_u32 m0, s52, 16896
    s_nop 0
    buffer_load_dwordx4 v248, s[12:15], s41 offen offset:0 nt lds
    s_add_u32 m0, s52, 17696
    s_nop 0
    buffer_load_dwordx4 v248, s[12:15], s41 offen offset:256 nt lds
    s_add_u32 m0, s52, 18496
    s_nop 0
    buffer_load_dwordx4 v248, s[12:15], s41 offen offset:512 nt lds
    s_add_u32 m0, s52, 19296
    s_nop 0
    buffer_load_dwordx4 v248, s[12:15], s41 offen offset:768 nt lds
    s_add_u32 s41, s41, 8192
    s_waitcnt vmcnt(0) lgkmcnt(0)
    s_barrier
    s_barrier
    s_sub_u32 s33, s33, 1
    s_cmp_lg_u32 s33, 0
    s_cbranch_scc1 LS_PA
    s_add_u32 s34, s4, 1
    s_lshl_b32 s34, s34, 17
    s_add_u32 s53, s53, s34
    v_mov_b32 v252, v253
    s_barrier
    s_mov_b32 s33, 8
LS_PO:
    s_add_u32 s35, s47, s90
    s_add_u32 m0, s50, 0
    s_nop 0
    buffer_load_dwordx4 v249, s[24:27], s35 offen lds
    s_add_u32 s35, s47, s91
    s_add_u32 m0, s50, 4224
    s_nop 0
    buffer_load_dwordx4 v249, s[24:27], s35 offen lds
    s_add_u32 s35, s47, s92
    s_add_u32 m0, s50, 8448
    s_nop 0
    buffer_load_dwordx4 v249, s[24:27], s35 offen lds
    s_add_u32 s35, s47, s93
    s_add_u32 m0, s50, 12672
    s_nop 0
    buffer_load_dwordx4 v249, s[24:27], s35 offen lds
    s_add_u32 s35, s47, s94
    s_add_u32 m0, s50, 16896
    s_nop 0
    buffer_load_dwordx4 v249, s[24:27], s35 offen lds
    s_add_u32 s35, s47, s95
    s_add_u32 m0, s50, 21120
    s_nop 0
    buffer_load_dwordx4 v249, s[24:27], s35 offen lds
    s_add_u32 s35, s47, s96
    s_add_u32 m0, s50, 25344
    s_nop 0
    buffer_load_dwordx4 v249, s[24:27], s35 offen lds
    s_add_u32 s35, s47, s97
    s_add_u32 m0, s50, 29568
    s_nop 0
    buffer_load_dwordx4 v249, s[24:27], s35 offen lds
    s_add_u32 s35, s47, s98
    s_add_u32 m0, s50, 33792
    s_nop 0
    buffer_load_dwordx4 v249, s[24:27], s35 offen lds
    s_add_u32 s47, s47, 36864
    s_waitcnt vmcnt(0) lgkmcnt(0)
    s_barrier
    ds_read_b128 v[216:219], v252 offset:0
    ds_read_b128 v[220:223], v252 offset:1024
    ds_read_b128 v[224:227], v252 offset:2048
    ds_read_b128 v[228:231], v252 offset:3072
    ds_read_b128 v[232:235], v252 offset:4096
    ds_read_b128 v[236:239], v252 offset:5120
    ds_read_b64_tr_b16 v[240:241], v251 offset:0
    ds_read_b64_tr_b16 v[242:243], v251 offset:512
    s_waitcnt lgkmcnt(0)
    v_mfma_f32_16x16x32_bf16 v[0:3], v[240:243], v[216:219], v[0:3]
    v_mfma_f32_16x16x32_bf16 v[4:7], v[240:243], v[220:223], v[4:7]
    v_mfma_f32_16x16x32_bf16 v[8:11], v[240:243], v[224:227], v[8:11]
    v_mfma_f32_16x16x32_bf16 v[12:15], v[240:243], v[228:231], v[12:15]
    v_mfma_f32_16x16x32_bf16 v[16:19], v[240:243], v[232:235], v[16:19]
    v_mfma_f32_16x16x32_bf16 v[20:23], v[240:243], v[236:239], v[20:23]
    ds_read_b64_tr_b16 v[240:241], v251 offset:4224
    ds_read_b64_tr_b16 v[242:243], v251 offset:4736
    s_waitcnt lgkmcnt(0)
    v_mfma_f32_16x16x32_bf16 v[24:27], v[240:243], v[216:219], v[24:27]
    v_mfma_f32_16x16x32_bf16 v[28:31], v[240:243], v[220:223], v[28:31]
    v_mfma_f32_16x16x32_bf16 v[32:35], v[240:243], v[224:227], v[32:35]
    v_mfma_f32_16x16x32_bf16 v[36:39], v[240:243], v[228:231], v[36:39]
    v_mfma_f32_16x16x32_bf16 v[40:43], v[240:243], v[232:235], v[40:43]
    v_mfma_f32_16x16x32_bf16 v[44:47], v[240:243], v[236:239], v[44:47]
    ds_read_b64_tr_b16 v[240:241], v251 offset:8448
    ds_read_b64_tr_b16 v[242:243], v251 offset:8960
    s_waitcnt lgkmcnt(0)
    v_mfma_f32_16x16x32_bf16 v[48:51], v[240:243], v[216:219], v[48:51]
    v_mfma_f32_16x16x32_bf16 v[52:55], v[240:243], v[220:223], v[52:55]
    v_mfma_f32_16x16x32_bf16 v[56:59], v[240:243], v[224:227], v[56:59]
    v_mfma_f32_16x16x32_bf16 v[60:63], v[240:243], v[228:231], v[60:63]
    v_mfma_f32_16x16x32_bf16 v[64:67], v[240:243], v[232:235], v[64:67]
    v_mfma_f32_16x16x32_bf16 v[68:71], v[240:243], v[236:239], v[68:71]
    ds_read_b64_tr_b16 v[240:241], v251 offset:12672
    ds_read_b64_tr_b16 v[242:243], v251 offset:13184
    s_waitcnt lgkmcnt(0)
    v_mfma_f32_16x16x32_bf16 v[72:75], v[240:243], v[216:219], v[72:75]
    v_mfma_f32_16x16x32_bf16 v[76:79], v[240:243], v[220:223], v[76:79]
    v_mfma_f32_16x16x32_bf16 v[80:83], v[240:243], v[224:227], v[80:83]
    v_mfma_f32_16x16x32_bf16 v[84:87], v[240:243], v[228:231], v[84:87]
    v_mfma_f32_16x16x32_bf16 v[88:91], v[240:243], v[232:235], v[88:91]
    v_mfma_f32_16x16x32_bf16 v[92:95], v[240:243], v[236:239], v[92:95]
    ds_read_b64_tr_b16 v[240:241], v251 offset:16896
    ds_read_b64_tr_b16 v[242:243], v251 offset:17408
    s_waitcnt lgkmcnt(0)
    v_mfma_f32_16x16x32_bf16 v[96:99], v[240:243], v[216:219], v[96:99]
    v_mfma_f32_16x16x32_bf16 v[100:103], v[240:243], v[220:223], v[100:103]
    v_mfma_f32_16x16x32_bf16 v[104:107], v[240:243], v[224:227], v[104:107]
    v_mfma_f32_16x16x32_bf16 v[108:111], v[240:243], v[228:231], v[108:111]
    v_mfma_f32_16x16x32_bf16 v[112:115], v[240:243], v[232:235], v[112:115]
    v_mfma_f32_16x16x32_bf16 v[116:119], v[240:243], v[236:239], v[116:119]
    ds_read_b64_tr_b16 v[240:241], v251 offset:21120
    ds_read_b64_tr_b16 v[242:243], v251 offset:21632
    s_waitcnt lgkmcnt(0)
    v_mfma_f32_16x16x32_bf16 v[120:123], v[240:243], v[216:219], v[120:123]
    v_mfma_f32_16x16x32_bf16 v[124:127], v[240:243], v[220:223], v[124:127]
    v_mfma_f32_16x16x32_bf16 v[128:131], v[240:243], v[224:227], v[128:131]
    v_mfma_f32_16x16x32_bf16 v[132:135], v[240:243], v[228:231], v[132:135]
    v_mfma_f32_16x16x32_bf16 v[136:139], v[240:243], v[232:235], v[136:139]
    v_mfma_f32_16x16x32_bf16 v[140:143], v[240:243], v[236:239], v[140:143]
    ds_read_b64_tr_b16 v[240:241], v251 offset:25344
    ds_read_b64_tr_b16 v[242:243], v251 offset:25856
    s_waitcnt lgkmcnt(0)
    v_mfma_f32_16x16x32_bf16 v[144:147], v[240:243], v[216:219], v[144:147]
    v_mfma_f32_16x16x32_bf16 v[148:151], v[240:243], v[220:223], v[148:151]
    v_mfma_f32_16x16x32_bf16 v[152:155], v[240:243], v[224:227], v[152:155]
    v_mfma_f32_16x16x32_bf16 v[156:159], v[240:243], v[228:231], v[156:159]
    v_mfma_f32_16x16x32_bf16 v[160:163], v[240:243], v[232:235], v[160:163]
    v_mfma_f32_16x16x32_bf16 v[164:167], v[240:243], v[236:239], v[164:167]
    ds_read_b64_tr_b16 v[240:241], v251 offset:29568
    ds_read_b64_tr_b16 v[242:243], v251 offset:30080
    s_waitcnt lgkmcnt(0)
    v_mfma_f32_16x16x32_bf16 v[168:171], v[240:243], v[216:219], v[168:171]
    v_mfma_f32_16x16x32_bf16 v[172:175], v[240:243], v[220:223], v[172:175]
    v_mfma_f32_16x16x32_bf16 v[176:179], v[240:243], v[224:227], v[176:179]
    v_mfma_f32_16x16x32_bf16 v[180:183], v[240:243], v[228:231], v[180:183]
    v_mfma_f32_16x16x32_bf16 v[184:187], v[240:243], v[232:235], v[184:187]
    v_mfma_f32_16x16x32_bf16 v[188:191], v[240:243], v[236:239], v[188:191]
    ds_read_b64_tr_b16 v[240:241], v251 offset:33792
    ds_read_b64_tr_b16 v[242:243], v251 offset:34304
    s_waitcnt lgkmcnt(0)
    v_mfma_f32_16x16x32_bf16 v[192:195], v[240:243], v[216:219], v[192:195]
    v_mfma_f32_16x16x32_bf16 v[196:199], v[240:243], v[220:223], v[196:199]
    v_mfma_f32_16x16x32_bf16 v[200:203], v[240:243], v[224:227], v[200:203]
    v_mfma_f32_16x16x32_bf16 v[204:207], v[240:243], v[228:231], v[204:207]
    v_mfma_f32_16x16x32_bf16 v[208:211], v[240:243], v[232:235], v[208:211]
    v_mfma_f32_16x16x32_bf16 v[212:215], v[240:243], v[236:239], v[212:215]
    v_add_u32 v252, 6144, v252
    s_barrier
    s_sub_u32 s33, s33, 1
    s_cmp_lg_u32 s33, 0
    s_cbranch_scc1 LS_PO
    s_add_u32 s32, s32, 1
    s_cmp_lt_u32 s32, 4
    s_cbranch_scc1 LS_PR
    s_barrier
    s_nop 7
    v_mbcnt_lo_u32_b32 v239, -1, 0
    v_mbcnt_hi_u32_b32 v239, -1, v239
    v_lshlrev_b32 v239, 4, v239
    s_lshl_b32 s34, s6, 2
    s_add_u32 s34, s34, s36
    s_lshl_b32 s34, s34, 10
    v_add_u32 v239, s34, v239
    s_lshl_b32 s34, s4, 5
    s_add_u32 s34, s34, s5
    s_mul_i32 s34, s34, 442368
    s_add_u32 s28, s68, s34
    s_addc_u32 s29, s69, 0
    s_and_b32 s29, s29, 0xffff
    s_mov_b32 s30, 442368
    s_mov_b32 s31, 0x20000
    v_cvt_pk_bf16_f32 v48, v48, v49
    v_cvt_pk_bf16_f32 v49, v50, v51
    v_cvt_pk_bf16_f32 v50, v52, v53
    v_cvt_pk_bf16_f32 v51, v54, v55
    s_mul_i32 s34, s92, 384
    s_add_u32 s34, s34, 0
    buffer_store_dwordx4 v[48:51], v239, s[28:31], s34 offen sc1
    v_cvt_pk_bf16_f32 v56, v56, v57
    v_cvt_pk_bf16_f32 v57, v58, v59
    v_cvt_pk_bf16_f32 v58, v60, v61
    v_cvt_pk_bf16_f32 v59, v62, v63
    s_mul_i32 s34, s92, 384
    s_add_u32 s34, s34, 16384
    buffer_store_dwordx4 v[56:59], v239, s[28:31], s34 offen sc1
    v_cvt_pk_bf16_f32 v64, v64, v65
    v_cvt_pk_bf16_f32 v65, v66, v67
    v_cvt_pk_bf16_f32 v66, v68, v69
    v_cvt_pk_bf16_f32 v67, v70, v71
    s_mul_i32 s34, s92, 384
    s_add_u32 s34, s34, 32768
    buffer_store_dwordx4 v[64:67], v239, s[28:31], s34 offen sc1
    v_cvt_pk_bf16_f32 v72, v72, v73
    v_cvt_pk_bf16_f32 v73, v74, v75
    v_cvt_pk_bf16_f32 v74, v76, v77
    v_cvt_pk_bf16_f32 v75, v78, v79
    s_mul_i32 s34, s93, 384
    s_add_u32 s34, s34, 0
    buffer_store_dwordx4 v[72:75], v239, s[28:31], s34 offen sc1
    v_cvt_pk_bf16_f32 v80, v80, v81
    v_cvt_pk_bf16_f32 v81, v82, v83
    v_cvt_pk_bf16_f32 v82, v84, v85
    v_cvt_pk_bf16_f32 v83, v86, v87
    s_mul_i32 s34, s93, 384
    s_add_u32 s34, s34, 16384
    buffer_store_dwordx4 v[80:83], v239, s[28:31], s34 offen sc1
    v_cvt_pk_bf16_f32 v88, v88, v89
    v_cvt_pk_bf16_f32 v89, v90, v91
    v_cvt_pk_bf16_f32 v90, v92, v93
    v_cvt_pk_bf16_f32 v91, v94, v95
    s_mul_i32 s34, s93, 384
    s_add_u32 s34, s34, 32768
    buffer_store_dwordx4 v[88:91], v239, s[28:31], s34 offen sc1
    v_cvt_pk_bf16_f32 v96, v96, v97
    v_cvt_pk_bf16_f32 v97, v98, v99
    v_cvt_pk_bf16_f32 v98, v100, v101
    v_cvt_pk_bf16_f32 v99, v102, v103
    s_mul_i32 s34, s94, 384
    s_add_u32 s34, s34, 0
    buffer_store_dwordx4 v[96:99], v239, s[28:31], s34 offen sc1
    v_cvt_pk_bf16_f32 v104, v104, v105
    v_cvt_pk_bf16_f32 v105, v106, v107
    v_cvt_pk_bf16_f32 v106, v108, v109
    v_cvt_pk_bf16_f32 v107, v110, v111
    s_mul_i32 s34, s94, 384
    s_add_u32 s34, s34, 16384
    buffer_store_dwordx4 v[104:107], v239, s[28:31], s34 offen sc1
    v_cvt_pk_bf16_f32 v112, v112, v113
    v_cvt_pk_bf16_f32 v113, v114, v115
    v_cvt_pk_bf16_f32 v114, v116, v117
    v_cvt_pk_bf16_f32 v115, v118, v119
    s_mul_i32 s34, s94, 384
    s_add_u32 s34, s34, 32768
    buffer_store_dwordx4 v[112:115], v239, s[28:31], s34 offen sc1
    v_cvt_pk_bf16_f32 v120, v120, v121
    v_cvt_pk_bf16_f32 v121, v122, v123
    v_cvt_pk_bf16_f32 v122, v124, v125
    v_cvt_pk_bf16_f32 v123, v126, v127
    s_mul_i32 s34, s95, 384
    s_add_u32 s34, s34, 0
    buffer_store_dwordx4 v[120:123], v239, s[28:31], s34 offen sc1
    v_cvt_pk_bf16_f32 v128, v128, v129
    v_cvt_pk_bf16_f32 v129, v130, v131
    v_cvt_pk_bf16_f32 v130, v132, v133
    v_cvt_pk_bf16_f32 v131, v134, v135
    s_mul_i32 s34, s95, 384
    s_add_u32 s34, s34, 16384
    buffer_store_dwordx4 v[128:131], v239, s[28:31], s34 offen sc1
    v_cvt_pk_bf16_f32 v136, v136, v137
    v_cvt_pk_bf16_f32 v137, v138, v139
    v_cvt_pk_bf16_f32 v138, v140, v141
    v_cvt_pk_bf16_f32 v139, v142, v143
    s_mul_i32 s34, s95, 384
    s_add_u32 s34, s34, 32768
    buffer_store_dwordx4 v[136:139], v239, s[28:31], s34 offen sc1
    v_cvt_pk_bf16_f32 v144, v144, v145
    v_cvt_pk_bf16_f32 v145, v146, v147
    v_cvt_pk_bf16_f32 v146, v148, v149
    v_cvt_pk_bf16_f32 v147, v150, v151
    s_mul_i32 s34, s96, 384
    s_add_u32 s34, s34, 0
    buffer_store_dwordx4 v[144:147], v239, s[28:31], s34 offen sc1
    v_cvt_pk_bf16_f32 v152, v152, v153
    v_cvt_pk_bf16_f32 v153, v154, v155
    v_cvt_pk_bf16_f32 v154, v156, v157
    v_cvt_pk_bf16_f32 v155, v158, v159
    s_mul_i32 s34, s96, 384
    s_add_u32 s34, s34, 16384
    buffer_store_dwordx4 v[152:155], v239, s[28:31], s34 offen sc1
    v_cvt_pk_bf16_f32 v160, v160, v161
    v_cvt_pk_bf16_f32 v161, v162, v163
    v_cvt_pk_bf16_f32 v162, v164, v165
    v_cvt_pk_bf16_f32 v163, v166, v167
    s_mul_i32 s34, s96, 384
    s_add_u32 s34, s34, 32768
    buffer_store_dwordx4 v[160:163], v239, s[28:31], s34 offen sc1
    v_cvt_pk_bf16_f32 v168, v168, v169
    v_cvt_pk_bf16_f32 v169, v170, v171
    v_cvt_pk_bf16_f32 v170, v172, v173
    v_cvt_pk_bf16_f32 v171, v174, v175
    s_mul_i32 s34, s97, 384
    s_add_u32 s34, s34, 0
    buffer_store_dwordx4 v[168:171], v239, s[28:31], s34 offen sc1
    v_cvt_pk_bf16_f32 v176, v176, v177
    v_cvt_pk_bf16_f32 v177, v178, v179
    v_cvt_pk_bf16_f32 v178, v180, v181
    v_cvt_pk_bf16_f32 v179, v182, v183
    s_mul_i32 s34, s97, 384
    s_add_u32 s34, s34, 16384
    buffer_store_dwordx4 v[176:179], v239, s[28:31], s34 offen sc1
    v_cvt_pk_bf16_f32 v184, v184, v185
    v_cvt_pk_bf16_f32 v185, v186, v187
    v_cvt_pk_bf16_f32 v186, v188, v189
    v_cvt_pk_bf16_f32 v187, v190, v191
    s_mul_i32 s34, s97, 384
    s_add_u32 s34, s34, 32768
    buffer_store_dwordx4 v[184:187], v239, s[28:31], s34 offen sc1
    v_cvt_pk_bf16_f32 v192, v192, v193
    v_cvt_pk_bf16_f32 v193, v194, v195
    v_cvt_pk_bf16_f32 v194, v196, v197
    v_cvt_pk_bf16_f32 v195, v198, v199
    s_mul_i32 s34, s98, 384
    s_add_u32 s34, s34, 0
    buffer_store_dwordx4 v[192:195], v239, s[28:31], s34 offen sc1
    v_cvt_pk_bf16_f32 v200, v200, v201
    v_cvt_pk_bf16_f32 v201, v202, v203
    v_cvt_pk_bf16_f32 v202, v204, v205
    v_cvt_pk_bf16_f32 v203, v206, v207
    s_mul_i32 s34, s98, 384
    s_add_u32 s34, s34, 16384
    buffer_store_dwordx4 v[200:203], v239, s[28:31], s34 offen sc1
    v_cvt_pk_bf16_f32 v208, v208, v209
    v_cvt_pk_bf16_f32 v209, v210, v211
    v_cvt_pk_bf16_f32 v210, v212, v213
    v_cvt_pk_bf16_f32 v211, v214, v215
    s_mul_i32 s34, s98, 384
    s_add_u32 s34, s34, 32768
    buffer_store_dwordx4 v[208:211], v239, s[28:31], s34 offen sc1
    s_branch LP_XCHG
L_END:
    s_endpgm
LP_zA_4:
    v_mov_b32 v0, 0
    v_mov_b32 v1, 0
    v_mov_b32 v2, 0
    v_mov_b32 v3, 0
    v_mov_b32 v4, 0
    v_mov_b32 v5, 0
    v_mov_b32 v6, 0
    v_mov_b32 v7, 0
    v_mov_b32 v8, 0
    v_mov_b32 v9, 0
    v_mov_b32 v10, 0
    v_mov_b32 v11, 0
    v_mov_b32 v12, 0
    v_mov_b32 v13, 0
    v_mov_b32 v14, 0
    v_mov_b32 v15, 0
    v_mov_b32 v16, 0
    v_mov_b32 v17, 0
    v_mov_b32 v18, 0
    v_mov_b32 v19, 0
    v_mov_b32 v20, 0
    v_mov_b32 v21, 0
    v_mov_b32 v22, 0
    v_mov_b32 v23, 0
    v_mov_b32 v24, 0
    v_mov_b32 v25, 0
    v_mov_b32 v26, 0
    v_mov_b32 v27, 0
    v_mov_b32 v28, 0
    v_mov_b32 v29, 0
    v_mov_b32 v30, 0
    v_mov_b32 v31, 0
    v_mov_b32 v32, 0
    v_mov_b32 v33, 0
    v_mov_b32 v34, 0
    v_mov_b32 v35, 0
    v_mov_b32 v36, 0
    v_mov_b32 v37, 0
    v_mov_b32 v38, 0
    v_mov_b32 v39, 0
    v_mov_b32 v40, 0
    v_mov_b32 v41, 0
    v_mov_b32 v42, 0
    v_mov_b32 v43, 0
    v_mov_b32 v44, 0
    v_mov_b32 v45, 0
    v_mov_b32 v46, 0
    v_mov_b32 v47, 0
    v_mov_b32 v48, 0
    v_mov_b32 v49, 0
    v_mov_b32 v50, 0
    v_mov_b32 v51, 0
    v_mov_b32 v52, 0
    v_mov_b32 v53, 0
    s_branch LP_zA_4_r
LP_zA_5:
    v_mov_b32 v54, 0
    v_mov_b32 v55, 0
    v_mov_b32 v56, 0
    v_mov_b32 v57, 0
    v_mov_b32 v58, 0
    v_mov_b32 v59, 0
    v_mov_b32 v60, 0
    v_mov_b32 v61, 0
    v_mov_b32 v62, 0
    v_mov_b32 v63, 0
    v_mov_b32 v64, 0
    v_mov_b32 v65, 0
    v_mov_b32 v66, 0
    v_mov_b32 v67, 0
    v_mov_b32 v68, 0
    v_mov_b32 v69, 0
    v_mov_b32 v70, 0
    v_mov_b32 v71, 0
    v_mov_b32 v72, 0
    v_mov_b32 v73, 0
    v_mov_b32 v74, 0
    v_mov_b32 v75, 0
    v_mov_b32 v76, 0
    v_mov_b32 v77, 0
    v_mov_b32 v78, 0
    v_mov_b32 v79, 0
    v_mov_b32 v80, 0
    v_mov_b32 v81, 0
    v_mov_b32 v82, 0
    v_mov_b32 v83, 0
    v_mov_b32 v84, 0
    v_mov_b32 v85, 0
    v_mov_b32 v86, 0
    v_mov_b32 v87, 0
    v_mov_b32 v88, 0
    v_mov_b32 v89, 0
    v_mov_b32 v90, 0
    v_mov_b32 v91, 0
    v_mov_b32 v92, 0
    v_mov_b32 v93, 0
    v_mov_b32 v94, 0
    v_mov_b32 v95, 0
    v_mov_b32 v96, 0
    v_mov_b32 v97, 0
    v_mov_b32 v98, 0
    v_mov_b32 v99, 0
    v_mov_b32 v100, 0
    v_mov_b32 v101, 0
    v_mov_b32 v102, 0
    v_mov_b32 v103, 0
    v_mov_b32 v104, 0
    v_mov_b32 v105, 0
    v_mov_b32 v106, 0
    v_mov_b32 v107, 0
    s_branch LP_zA_5_r
LP_zA_7:
    v_mov_b32 v108, 0
    v_mov_b32 v109, 0
    v_mov_b32 v110, 0
    v_mov_b32 v111, 0
    v_mov_b32 v112, 0
    v_mov_b32 v113, 0
    v_mov_b32 v114, 0
    v_mov_b32 v115, 0
    v_mov_b32 v116, 0
    v_mov_b32 v117, 0
    v_mov_b32 v118, 0
    v_mov_b32 v119, 0
    v_mov_b32 v120, 0
    v_mov_b32 v121, 0
    v_mov_b32 v122, 0
    v_mov_b32 v123, 0
    v_mov_b32 v124, 0
    v_mov_b32 v125, 0
    v_mov_b32 v126, 0
    v_mov_b32 v127, 0
    v_mov_b32 v128, 0
    v_mov_b32 v129, 0
    v_mov_b32 v130, 0
    v_mov_b32 v131, 0
    v_mov_b32 v132, 0
    v_mov_b32 v133, 0
    v_mov_b32 v134, 0
    v_mov_b32 v135, 0
    v_mov_b32 v136, 0
    v_mov_b32 v137, 0
    v_mov_b32 v138, 0
    v_mov_b32 v139, 0
    v_mov_b32 v140, 0
    v_mov_b32 v141, 0
    v_mov_b32 v142, 0
    v_mov_b32 v143, 0
    v_mov_b32 v144, 0
    v_mov_b32 v145, 0
    v_mov_b32 v146, 0
    v_mov_b32 v147, 0
    v_mov_b32 v148, 0
    v_mov_b32 v149, 0
    v_mov_b32 v150, 0
    v_mov_b32 v151, 0
    v_mov_b32 v152, 0
    v_mov_b32 v153, 0
    v_mov_b32 v154, 0
    v_mov_b32 v155, 0
    v_mov_b32 v156, 0
    v_mov_b32 v157, 0
    v_mov_b32 v158, 0
    v_mov_b32 v159, 0
    v_mov_b32 v160, 0
    v_mov_b32 v161, 0
    s_branch LP_zA_7_r
LP_zA_8:
    v_mov_b32 v162, 0
    v_mov_b32 v163, 0
    v_mov_b32 v164, 0
    v_mov_b32 v165, 0
    v_mov_b32 v166, 0
    v_mov_b32 v167, 0
    v_mov_b32 v168, 0
    v_mov_b32 v169, 0
    v_mov_b32 v170, 0
    v_mov_b32 v171, 0
    v_mov_b32 v172, 0
    v_mov_b32 v173, 0
    v_mov_b32 v174, 0
    v_mov_b32 v175, 0
    v_mov_b32 v176, 0
    v_mov_b32 v177, 0
    v_mov_b32 v178, 0
    v_mov_b32 v179, 0
    v_mov_b32 v180, 0
    v_mov_b32 v181, 0
    v_mov_b32 v182, 0
    v_mov_b32 v183, 0
    v_mov_b32 v184, 0
    v_mov_b32 v185, 0
    v_mov_b32 v186, 0
    v_mov_b32 v187, 0
    v_mov_b32 v188, 0
    v_mov_b32 v189, 0
    v_mov_b32 v190, 0
    v_mov_b32 v191, 0
    v_mov_b32 v192, 0
    v_mov_b32 v193, 0
    v_mov_b32 v194, 0
    v_mov_b32 v195, 0
    v_mov_b32 v196, 0
    v_mov_b32 v197, 0
    v_mov_b32 v198, 0
    v_mov_b32 v199, 0
    v_mov_b32 v200, 0
    v_mov_b32 v201, 0
    v_mov_b32 v202, 0
    v_mov_b32 v203, 0
    v_mov_b32 v204, 0
    v_mov_b32 v205, 0
    v_mov_b32 v206, 0
    v_mov_b32 v207, 0
    v_mov_b32 v208, 0
    v_mov_b32 v209, 0
    v_mov_b32 v210, 0
    v_mov_b32 v211, 0
    v_mov_b32 v212, 0
    v_mov_b32 v213, 0
    v_mov_b32 v214, 0
    v_mov_b32 v215, 0
    s_branch LP_zA_8_r
LP_r0A_9:
    s_add_u32 s35, s47, s95
    s_add_u32 m0, s50, 21120
    s_nop 0
    buffer_load_dwordx4 v249, s[24:27], s35 offen lds
    s_add_u32 s35, s47, s96
    s_add_u32 m0, s50, 25344
    s_nop 0
    buffer_load_dwordx4 v249, s[24:27], s35 offen lds
    s_add_u32 s35, s47, s97
    s_add_u32 m0, s50, 29568
    s_nop 0
    buffer_load_dwordx4 v249, s[24:27], s35 offen lds
    s_add_u32 s35, s47, s98
    s_add_u32 m0, s50, 33792
    s_nop 0
    buffer_load_dwordx4 v249, s[24:27], s35 offen lds
    s_add_u32 s47, s47, 36864
    s_add_u32 m0, s52, 33792
    s_nop 0
    buffer_load_dwordx4 v248, s[8:11], s41 offen offset:0 nt lds
    s_add_u32 m0, s52, 34592
    s_nop 0
    buffer_load_dwordx4 v248, s[8:11], s41 offen offset:256 nt lds
    s_add_u32 s41, s41, 8192
    s_branch LP_jA_10
LP_r0A_11:
    s_add_u32 s35, s47, s90
    s_add_u32 m0, s50, 0
    s_nop 0
    buffer_load_dwordx4 v249, s[24:27], s35 offen lds
    s_add_u32 s35, s47, s91
    s_add_u32 m0, s50, 4224
    s_nop 0
    buffer_load_dwordx4 v249, s[24:27], s35 offen lds
    s_add_u32 s35, s47, s92
    s_add_u32 m0, s50, 8448
    s_nop 0
    buffer_load_dwordx4 v249, s[24:27], s35 offen lds
    s_add_u32 m0, s52, 50688
    s_nop 0
    buffer_load_dwordx4 v248, s[12:15], s42 offen offset:0 nt lds
    s_add_u32 m0, s52, 51488
    s_nop 0
    buffer_load_dwordx4 v248, s[12:15], s42 offen offset:256 nt lds
    s_add_u32 s42, s42, 8192
    s_branch LP_jA_12
LP_r0A_14:
    s_add_u32 s35, s47, s93
    s_add_u32 m0, s50, 12672
    s_nop 0
    buffer_load_dwordx4 v249, s[24:27], s35 offen lds
    s_add_u32 s35, s47, s94
    s_add_u32 m0, s50, 16896
    s_nop 0
    buffer_load_dwordx4 v249, s[24:27], s35 offen lds
    s_add_u32 m0, s52, 16896
    s_nop 0
    buffer_load_dwordx4 v248, s[12:15], s42 offen offset:0 nt lds
    s_add_u32 m0, s52, 17696
    s_nop 0
    buffer_load_dwordx4 v248, s[12:15], s42 offen offset:256 nt lds
    s_add_u32 s42, s42, 8192
    s_branch LP_jA_15
LP_r0A_17:
    s_add_u32 s35, s47, s95
    s_add_u32 m0, s50, 21120
    s_nop 0
    buffer_load_dwordx4 v249, s[24:27], s35 offen lds
    s_add_u32 s35, s47, s96
    s_add_u32 m0, s50, 25344
    s_nop 0
    buffer_load_dwordx4 v249, s[24:27], s35 offen lds
    s_add_u32 m0, s52, 33792
    s_nop 0
    buffer_load_dwordx4 v248, s[8:11], s41 offen offset:0 nt lds
    s_add_u32 m0, s52, 34592
    s_nop 0
    buffer_load_dwordx4 v248, s[8:11], s41 offen offset:256 nt lds
    s_add_u32 s41, s41, 8192
    s_branch LP_jA_18
LP_r0A_20:
    s_add_u32 s35, s47, s97
    s_add_u32 m0, s50, 29568
    s_nop 0
    buffer_load_dwordx4 v249, s[24:27], s35 offen lds
    s_add_u32 s35, s47, s98
    s_add_u32 m0, s50, 33792
    s_nop 0
    buffer_load_dwordx4 v249, s[24:27], s35 offen lds
    s_add_u32 s47, s47, 36864
    s_add_u32 m0, s52, 50688
    s_nop 0
    buffer_load_dwordx4 v248, s[12:15], s42 offen offset:0 nt lds
    s_add_u32 m0, s52, 51488
    s_nop 0
    buffer_load_dwordx4 v248, s[12:15], s42 offen offset:256 nt lds
    s_add_u32 s42, s42, 8192
    s_branch LP_jA_21
LP_r0A_23:
    s_add_u32 s35, s47, s90
    s_add_u32 m0, s50, 0
    s_nop 0
    buffer_load_dwordx4 v249, s[24:27], s35 offen lds
    s_add_u32 s35, s47, s91
    s_add_u32 m0, s50, 4224
    s_nop 0
    buffer_load_dwordx4 v249, s[24:27], s35 offen lds
    s_add_u32 s35, s47, s92
    s_add_u32 m0, s50, 8448
    s_nop 0
    buffer_load_dwordx4 v249, s[24:27], s35 offen lds
    s_add_u32 m0, s52, 0
    s_nop 0
    buffer_load_dwordx4 v248, s[8:11], s41 offen offset:0 nt lds
    s_add_u32 m0, s52, 800
    s_nop 0
    buffer_load_dwordx4 v248, s[8:11], s41 offen offset:256 nt lds
    s_add_u32 s41, s41, 8192
    s_branch LP_jA_24
LP_r0A_26:
    s_add_u32 s35, s47, s93
    s_add_u32 m0, s50, 12672
    s_nop 0
    buffer_load_dwordx4 v249, s[24:27], s35 offen lds
    s_add_u32 s35, s47, s94
    s_add_u32 m0, s50, 16896
    s_nop 0
    buffer_load_dwordx4 v249, s[24:27], s35 offen lds
    s_add_u32 m0, s52, 16896
    s_nop 0
    buffer_load_dwordx4 v248, s[12:15], s42 offen offset:0 nt lds
    s_add_u32 m0, s52, 17696
    s_nop 0
    buffer_load_dwordx4 v248, s[12:15], s42 offen offset:256 nt lds
    s_add_u32 s42, s42, 8192
    s_branch LP_jA_27
LP_r0A_29:
    s_add_u32 s35, s47, s95
    s_add_u32 m0, s50, 21120
    s_nop 0
    buffer_load_dwordx4 v249, s[24:27], s35 offen lds
    s_add_u32 s35, s47, s96
    s_add_u32 m0, s50, 25344
    s_nop 0
    buffer_load_dwordx4 v249, s[24:27], s35 offen lds
    s_add_u32 m0, s52, 33792
    s_nop 0
    buffer_load_dwordx4 v248, s[8:11], s41 offen offset:0 nt lds
    s_add_u32 m0, s52, 34592
    s_nop 0
    buffer_load_dwordx4 v248, s[8:11], s41 offen offset:256 nt lds
    s_add_u32 s41, s41, 8192
    s_branch LP_jA_30
LP_r0A_32:
    s_add_u32 s35, s47, s97
    s_add_u32 m0, s50, 29568
    s_nop 0
    buffer_load_dwordx4 v249, s[24:27], s35 offen lds
    s_add_u32 s35, s47, s98
    s_add_u32 m0, s50, 33792
    s_nop 0
    buffer_load_dwordx4 v249, s[24:27], s35 offen lds
    s_add_u32 s47, s47, 36864
    s_add_u32 m0, s52, 50688
    s_nop 0
    buffer_load_dwordx4 v248, s[12:15], s42 offen offset:0 nt lds
    s_add_u32 m0, s52, 51488
    s_nop 0
    buffer_load_dwordx4 v248, s[12:15], s42 offen offset:256 nt lds
    s_add_u32 s42, s42, 8192
    s_branch LP_jA_33
LP_r0A_35:
    s_add_u32 s35, s47, s90
    s_add_u32 m0, s50, 0
    s_nop 0
    buffer_load_dwordx4 v249, s[24:27], s35 offen lds
    s_add_u32 s35, s47, s91
    s_add_u32 m0, s50, 4224
    s_nop 0
    buffer_load_dwordx4 v249, s[24:27], s35 offen lds
    s_add_u32 s35, s47, s92
    s_add_u32 m0, s50, 8448
    s_nop 0
    buffer_load_dwordx4 v249, s[24:27], s35 offen lds
    s_add_u32 m0, s52, 0
    s_nop 0
    buffer_load_dwordx4 v248, s[8:11], s41 offen offset:0 nt lds
    s_add_u32 m0, s52, 800
    s_nop 0
    buffer_load_dwordx4 v248, s[8:11], s41 offen offset:256 nt lds
    s_add_u32 s41, s41, 8192
    s_branch LP_jA_36
LP_r0A_38:
    s_add_u32 s35, s47, s93
    s_add_u32 m0, s50, 12672
    s_nop 0
    buffer_load_dwordx4 v249, s[24:27], s35 offen lds
    s_add_u32 s35, s47, s94
    s_add_u32 m0, s50, 16896
    s_nop 0
    buffer_load_dwordx4 v249, s[24:27], s35 offen lds
    s_add_u32 m0, s52, 16896
    s_nop 0
    buffer_load_dwordx4 v248, s[12:15], s42 offen offset:0 nt lds
    s_add_u32 m0, s52, 17696
    s_nop 0
    buffer_load_dwordx4 v248, s[12:15], s42 offen offset:256 nt lds
    s_add_u32 s42, s42, 8192
    s_branch LP_jA_39
LP_r0A_41:
    s_add_u32 s35, s47, s95
    s_add_u32 m0, s50, 21120
    s_nop 0
    buffer_load_dwordx4 v249, s[24:27], s35 offen lds
    s_add_u32 s35, s47, s96
    s_add_u32 m0, s50, 25344
    s_nop 0
    buffer_load_dwordx4 v249, s[24:27], s35 offen lds
    s_add_u32 m0, s52, 33792
    s_nop 0
    buffer_load_dwordx4 v248, s[12:15], s42 offen offset:0 nt lds
    s_add_u32 m0, s52, 34592
    s_nop 0
    buffer_load_dwordx4 v248, s[12:15], s42 offen offset:256 nt lds
    s_add_u32 s42, s42, 8192
    s_add_u32 s41, s41, s44
    s_add_u32 s42, s42, s44
    s_branch LP_jA_42
LP_r0A_44:
    s_add_u32 s35, s47, s97
    s_add_u32 m0, s50, 29568
    s_nop 0
    buffer_load_dwordx4 v249, s[24:27], s35 offen lds
    s_add_u32 s35, s47, s98
    s_add_u32 m0, s50, 33792
    s_nop 0
    buffer_load_dwordx4 v249, s[24:27], s35 offen lds
    s_add_u32 s47, s47, 36864
    s_branch LP_jA_45
LP_r0A_47:
    s_add_u32 s35, s46, 0
    s_add_u32 m0, s45, 0
    s_nop 0
    buffer_load_dwordx4 v250, s[20:23], s35 offen lds
    s_add_u32 s35, s46, 8192
    s_add_u32 m0, s45, 1032
    s_nop 0
    buffer_load_dwordx4 v250, s[20:23], s35 offen lds
    s_add_u32 s35, s46, 16384
    s_add_u32 m0, s45, 2112
    s_nop 0
    buffer_load_dwordx4 v250, s[20:23], s35 offen lds
    s_add_u32 s35, s46, 24576
    s_add_u32 m0, s45, 3144
    s_nop 0
    buffer_load_dwordx4 v250, s[20:23], s35 offen lds
    s_add_u32 s46, s46, 262144
    s_add_u32 s35, s43, 0
    s_add_u32 m0, s50, 0
    s_nop 0
    buffer_load_dwordx4 v249, s[16:19], s35 offen lds
    s_add_u32 s35, s43, 36864
    s_add_u32 m0, s50, 4224
    s_nop 0
    buffer_load_dwordx4 v249, s[16:19], s35 offen lds
    s_add_u32 s35, s43, 73728
    s_add_u32 m0, s50, 8448
    s_nop 0
    buffer_load_dwordx4 v249, s[16:19], s35 offen lds
    s_add_u32 s43, s43, 128
    s_branch LP_jA_48
LP_r0A_49:
    s_add_u32 s35, s46, 0
    s_add_u32 m0, s45, 16896
    s_nop 0
    buffer_load_dwordx4 v250, s[20:23], s35 offen lds
    s_add_u32 s35, s46, 8192
    s_add_u32 m0, s45, 17928
    s_nop 0
    buffer_load_dwordx4 v250, s[20:23], s35 offen lds
    s_add_u32 s35, s46, 16384
    s_add_u32 m0, s45, 19008
    s_nop 0
    buffer_load_dwordx4 v250, s[20:23], s35 offen lds
    s_add_u32 s35, s46, 24576
    s_add_u32 m0, s45, 20040
    s_nop 0
    buffer_load_dwordx4 v250, s[20:23], s35 offen lds
    s_add_u32 s46, s46, 262144
    s_branch LP_jA_50
LP_r0A_51:
    s_add_u32 s35, s47, s97
    s_add_u32 m0, s50, 29568
    s_nop 0
    buffer_load_dwordx4 v249, s[24:27], s35 offen lds
    s_add_u32 s35, s47, s98
    s_add_u32 m0, s50, 33792
    s_nop 0
    buffer_load_dwordx4 v249, s[24:27], s35 offen lds
    s_add_u32 s47, s47, 36864
    s_add_u32 s35, s47, s95
    s_add_u32 m0, s50, 88704
    s_nop 0
    buffer_load_dwordx4 v249, s[24:27], s35 offen lds
    s_add_u32 s35, s47, s96
    s_add_u32 m0, s50, 92928
    s_nop 0
    buffer_load_dwordx4 v249, s[24:27], s35 offen lds
    s_add_u32 s35, s47, s97
    s_add_u32 m0, s50, 97152
    s_nop 0
    buffer_load_dwordx4 v249, s[24:27], s35 offen lds
    s_add_u32 s35, s47, s98
    s_add_u32 m0, s50, 101376
    s_nop 0
    buffer_load_dwordx4 v249, s[24:27], s35 offen lds
    s_branch LP_jA_52
LP_r0A_54:
    s_add_u32 s35, s47, s90
    s_add_u32 m0, s50, 0
    s_nop 0
    buffer_load_dwordx4 v249, s[24:27], s35 offen lds
    s_add_u32 s35, s47, s91
    s_add_u32 m0, s50, 4224
    s_nop 0
    buffer_load_dwordx4 v249, s[24:27], s35 offen lds
    s_add_u32 s35, s47, s92
    s_add_u32 m0, s50, 8448
    s_nop 0
    buffer_load_dwordx4 v249, s[24:27], s35 offen lds
    s_branch LP_jA_55
LP_r0A_56:
    s_add_u32 s35, s47, s93
    s_add_u32 m0, s50, 12672
    s_nop 0
    buffer_load_dwordx4 v249, s[24:27], s35 offen lds
    s_add_u32 s35, s47, s94
    s_add_u32 m0, s50, 16896
    s_nop 0
    buffer_load_dwordx4 v249, s[24:27], s35 offen lds
    s_branch LP_jA_57
LP_zB_59:
    v_mov_b32 v0, 0
    v_mov_b32 v1, 0
    v_mov_b32 v2, 0
    v_mov_b32 v3, 0
    v_mov_b32 v4, 0
    v_mov_b32 v5, 0
    v_mov_b32 v6, 0
    v_mov_b32 v7, 0
    v_mov_b32 v8, 0
    v_mov_b32 v9, 0
    v_mov_b32 v10, 0
    v_mov_b32 v11, 0
    v_mov_b32 v12, 0
    v_mov_b32 v13, 0
    v_mov_b32 v14, 0
    v_mov_b32 v15, 0
    v_mov_b32 v16, 0
    v_mov_b32 v17, 0
    v_mov_b32 v18, 0
    v_mov_b32 v19, 0
    v_mov_b32 v20, 0
    v_mov_b32 v21, 0
    v_mov_b32 v22, 0
    v_mov_b32 v23, 0
    v_mov_b32 v24, 0
    v_mov_b32 v25, 0
    v_mov_b32 v26, 0
    v_mov_b32 v27, 0
    v_mov_b32 v28, 0
    v_mov_b32 v29, 0
    v_mov_b32 v30, 0
    v_mov_b32 v31, 0
    v_mov_b32 v32, 0
    v_mov_b32 v33, 0
    v_mov_b32 v34, 0
    v_mov_b32 v35, 0
    v_mov_b32 v36, 0
    v_mov_b32 v37, 0
    v_mov_b32 v38, 0
    v_mov_b32 v39, 0
    v_mov_b32 v40, 0
    v_mov_b32 v41, 0
    v_mov_b32 v42, 0
    v_mov_b32 v43, 0
    v_mov_b32 v44, 0
    v_mov_b32 v45, 0
    v_mov_b32 v46, 0
    v_mov_b32 v47, 0
    v_mov_b32 v48, 0
    v_mov_b32 v49, 0
    v_mov_b32 v50, 0
    v_mov_b32 v51, 0
    v_mov_b32 v52, 0
    v_mov_b32 v53, 0
    s_branch LP_zB_59_r
LP_zB_60:
    v_mov_b32 v54, 0
    v_mov_b32 v55, 0
    v_mov_b32 v56, 0
    v_mov_b32 v57, 0
    v_mov_b32 v58, 0
    v_mov_b32 v59, 0
    v_mov_b32 v60, 0
    v_mov_b32 v61, 0
    v_mov_b32 v62, 0
    v_mov_b32 v63, 0
    v_mov_b32 v64, 0
    v_mov_b32 v65, 0
    v_mov_b32 v66, 0
    v_mov_b32 v67, 0
    v_mov_b32 v68, 0
    v_mov_b32 v69, 0
    v_mov_b32 v70, 0
    v_mov_b32 v71, 0
    v_mov_b32 v72, 0
    v_mov_b32 v73, 0
    v_mov_b32 v74, 0
    v_mov_b32 v75, 0
    v_mov_b32 v76, 0
    v_mov_b32 v77, 0
    v_mov_b32 v78, 0
    v_mov_b32 v79, 0
    v_mov_b32 v80, 0
    v_mov_b32 v81, 0
    v_mov_b32 v82, 0
    v_mov_b32 v83, 0
    v_mov_b32 v84, 0
    v_mov_b32 v85, 0
    v_mov_b32 v86, 0
    v_mov_b32 v87, 0
    v_mov_b32 v88, 0
    v_mov_b32 v89, 0
    v_mov_b32 v90, 0
    v_mov_b32 v91, 0
    v_mov_b32 v92, 0
    v_mov_b32 v93, 0
    v_mov_b32 v94, 0
    v_mov_b32 v95, 0
    v_mov_b32 v96, 0
    v_mov_b32 v97, 0
    v_mov_b32 v98, 0
    v_mov_b32 v99, 0
    v_mov_b32 v100, 0
    v_mov_b32 v101, 0
    v_mov_b32 v102, 0
    v_mov_b32 v103, 0
    v_mov_b32 v104, 0
    v_mov_b32 v105, 0
    v_mov_b32 v106, 0
    v_mov_b32 v107, 0
    s_branch LP_zB_60_r
LP_zB_62:
    v_mov_b32 v108, 0
    v_mov_b32 v109, 0
    v_mov_b32 v110, 0
    v_mov_b32 v111, 0
    v_mov_b32 v112, 0
    v_mov_b32 v113, 0
    v_mov_b32 v114, 0
    v_mov_b32 v115, 0
    v_mov_b32 v116, 0
    v_mov_b32 v117, 0
    v_mov_b32 v118, 0
    v_mov_b32 v119, 0
    v_mov_b32 v120, 0
    v_mov_b32 v121, 0
    v_mov_b32 v122, 0
    v_mov_b32 v123, 0
    v_mov_b32 v124, 0
    v_mov_b32 v125, 0
    v_mov_b32 v126, 0
    v_mov_b32 v127, 0
    v_mov_b32 v128, 0
    v_mov_b32 v129, 0
    v_mov_b32 v130, 0
    v_mov_b32 v131, 0
    v_mov_b32 v132, 0
    v_mov_b32 v133, 0
    v_mov_b32 v134, 0
    v_mov_b32 v135, 0
    v_mov_b32 v136, 0
    v_mov_b32 v137, 0
    v_mov_b32 v138, 0
    v_mov_b32 v139, 0
    v_mov_b32 v140, 0
    v_mov_b32 v141, 0
    v_mov_b32 v142, 0
    v_mov_b32 v143, 0
    v_mov_b32 v144, 0
    v_mov_b32 v145, 0
    v_mov_b32 v146, 0
    v_mov_b32 v147, 0
    v_mov_b32 v148, 0
    v_mov_b32 v149, 0
    v_mov_b32 v150, 0
    v_mov_b32 v151, 0
    v_mov_b32 v152, 0
    v_mov_b32 v153, 0
    v_mov_b32 v154, 0
    v_mov_b32 v155, 0
    v_mov_b32 v156, 0
    v_mov_b32 v157, 0
    v_mov_b32 v158, 0
    v_mov_b32 v159, 0
    v_mov_b32 v160, 0
    v_mov_b32 v161, 0
    s_branch LP_zB_62_r
LP_zB_63:
    v_mov_b32 v162, 0
    v_mov_b32 v163, 0
    v_mov_b32 v164, 0
    v_mov_b32 v165, 0
    v_mov_b32 v166, 0
    v_mov_b32 v167, 0
    v_mov_b32 v168, 0
    v_mov_b32 v169, 0
    v_mov_b32 v170, 0
    v_mov_b32 v171, 0
    v_mov_b32 v172, 0
    v_mov_b32 v173, 0
    v_mov_b32 v174, 0
    v_mov_b32 v175, 0
    v_mov_b32 v176, 0
    v_mov_b32 v177, 0
    v_mov_b32 v178, 0
    v_mov_b32 v179, 0
    v_mov_b32 v180, 0
    v_mov_b32 v181, 0
    v_mov_b32 v182, 0
    v_mov_b32 v183, 0
    v_mov_b32 v184, 0
    v_mov_b32 v185, 0
    v_mov_b32 v186, 0
    v_mov_b32 v187, 0
    v_mov_b32 v188, 0
    v_mov_b32 v189, 0
    v_mov_b32 v190, 0
    v_mov_b32 v191, 0
    v_mov_b32 v192, 0
    v_mov_b32 v193, 0
    v_mov_b32 v194, 0
    v_mov_b32 v195, 0
    v_mov_b32 v196, 0
    v_mov_b32 v197, 0
    v_mov_b32 v198, 0
    v_mov_b32 v199, 0
    v_mov_b32 v200, 0
    v_mov_b32 v201, 0
    v_mov_b32 v202, 0
    v_mov_b32 v203, 0
    v_mov_b32 v204, 0
    v_mov_b32 v205, 0
    v_mov_b32 v206, 0
    v_mov_b32 v207, 0
    v_mov_b32 v208, 0
    v_mov_b32 v209, 0
    v_mov_b32 v210, 0
    v_mov_b32 v211, 0
    v_mov_b32 v212, 0
    v_mov_b32 v213, 0
    v_mov_b32 v214, 0
    v_mov_b32 v215, 0
    s_branch LP_zB_63_r
LP_r0B_64:
    s_add_u32 s35, s47, s95
    s_add_u32 m0, s50, 21120
    s_nop 0
    buffer_load_dwordx4 v249, s[24:27], s35 offen lds
    s_add_u32 s35, s47, s96
    s_add_u32 m0, s50, 25344
    s_nop 0
    buffer_load_dwordx4 v249, s[24:27], s35 offen lds
    s_add_u32 s35, s47, s97
    s_add_u32 m0, s50, 29568
    s_nop 0
    buffer_load_dwordx4 v249, s[24:27], s35 offen lds
    s_add_u32 s35, s47, s98
    s_add_u32 m0, s50, 33792
    s_nop 0
    buffer_load_dwordx4 v249, s[24:27], s35 offen lds
    s_add_u32 s47, s47, 36864
    s_add_u32 m0, s52, 33792
    s_nop 0
    buffer_load_dwordx4 v248, s[8:11], s41 offen offset:0 nt lds
    s_add_u32 m0, s52, 34592
    s_nop 0
    buffer_load_dwordx4 v248, s[8:11], s41 offen offset:256 nt lds
    s_add_u32 m0, s52, 35392
    s_nop 0
    buffer_load_dwordx4 v248, s[8:11], s41 offen offset:512 nt lds
    s_add_u32 m0, s52, 36192
    s_nop 0
    buffer_load_dwordx4 v248, s[8:11], s41 offen offset:768 nt lds
    s_add_u32 s41, s41, 8192
    s_branch LP_jB_65
LP_r0B_66:
    s_add_u32 s35, s47, s90
    s_add_u32 m0, s50, 0
    s_nop 0
    buffer_load_dwordx4 v249, s[24:27], s35 offen lds
    s_add_u32 s35, s47, s91
    s_add_u32 m0, s50, 4224
    s_nop 0
    buffer_load_dwordx4 v249, s[24:27], s35 offen lds
    s_add_u32 s35, s47, s92
    s_add_u32 m0, s50, 8448
    s_nop 0
    buffer_load_dwordx4 v249, s[24:27], s35 offen lds
    s_add_u32 m0, s52, 50688
    s_nop 0
    buffer_load_dwordx4 v248, s[12:15], s42 offen offset:0 nt lds
    s_add_u32 m0, s52, 51488
    s_nop 0
    buffer_load_dwordx4 v248, s[12:15], s42 offen offset:256 nt lds
    s_add_u32 m0, s52, 52288
    s_nop 0
    buffer_load_dwordx4 v248, s[12:15], s42 offen offset:512 nt lds
    s_add_u32 m0, s52, 53088
    s_nop 0
    buffer_load_dwordx4 v248, s[12:15], s42 offen offset:768 nt lds
    s_add_u32 s42, s42, 8192
    s_branch LP_jB_67
LP_r0B_68:
    s_add_u32 s35, s47, s93
    s_add_u32 m0, s50, 12672
    s_nop 0
    buffer_load_dwordx4 v249, s[24:27], s35 offen lds
    s_add_u32 s35, s47, s94
    s_add_u32 m0, s50, 16896
    s_nop 0
    buffer_load_dwordx4 v249, s[24:27], s35 offen lds
    s_add_u32 m0, s52, 16896
    s_nop 0
    buffer_load_dwordx4 v248, s[12:15], s42 offen offset:0 nt lds
    s_add_u32 m0, s52, 17696
    s_nop 0
    buffer_load_dwordx4 v248, s[12:15], s42 offen offset:256 nt lds
    s_add_u32 m0, s52, 18496
    s_nop 0
    buffer_load_dwordx4 v248, s[12:15], s42 offen offset:512 nt lds
    s_add_u32 m0, s52, 19296
    s_nop 0
    buffer_load_dwordx4 v248, s[12:15], s42 offen offset:768 nt lds
    s_add_u32 s42, s42, 8192
    s_branch LP_jB_69
LP_r0B_70:
    s_add_u32 s35, s47, s95
    s_add_u32 m0, s50, 21120
    s_nop 0
    buffer_load_dwordx4 v249, s[24:27], s35 offen lds
    s_add_u32 s35, s47, s96
    s_add_u32 m0, s50, 25344
    s_nop 0
    buffer_load_dwordx4 v249, s[24:27], s35 offen lds
    s_add_u32 m0, s52, 33792
    s_nop 0
    buffer_load_dwordx4 v248, s[8:11], s41 offen offset:0 nt lds
    s_add_u32 m0, s52, 34592
    s_nop 0
    buffer_load_dwordx4 v248, s[8:11], s41 offen offset:256 nt lds
    s_add_u32 m0, s52, 35392
    s_nop 0
    buffer_load_dwordx4 v248, s[8:11], s41 offen offset:512 nt lds
    s_add_u32 m0, s52, 36192
    s_nop 0
    buffer_load_dwordx4 v248, s[8:11], s41 offen offset:768 nt lds
    s_add_u32 s41, s41, 8192
    s_branch LP_jB_71
LP_r0B_72:
    s_add_u32 s35, s47, s97
    s_add_u32 m0, s50, 29568
    s_nop 0
    buffer_load_dwordx4 v249, s[24:27], s35 offen lds
    s_add_u32 s35, s47, s98
    s_add_u32 m0, s50, 33792
    s_nop 0
    buffer_load_dwordx4 v249, s[24:27], s35 offen lds
    s_add_u32 s47, s47, 36864
    s_add_u32 m0, s52, 50688
    s_nop 0
    buffer_load_dwordx4 v248, s[12:15], s42 offen offset:0 nt lds
    s_add_u32 m0, s52, 51488
    s_nop 0
    buffer_load_dwordx4 v248, s[12:15], s42 offen offset:256 nt lds
    s_add_u32 m0, s52, 52288
    s_nop 0
    buffer_load_dwordx4 v248, s[12:15], s42 offen offset:512 nt lds
    s_add_u32 m0, s52, 53088
    s_nop 0
    buffer_load_dwordx4 v248, s[12:15], s42 offen offset:768 nt lds
    s_add_u32 s42, s42, 8192
    s_branch LP_jB_73
LP_r0B_74:
    s_add_u32 s35, s47, s90
    s_add_u32 m0, s50, 0
    s_nop 0
    buffer_load_dwordx4 v249, s[24:27], s35 offen lds
    s_add_u32 s35, s47, s91
    s_add_u32 m0, s50, 4224
    s_nop 0
    buffer_load_dwordx4 v249, s[24:27], s35 offen lds
    s_add_u32 s35, s47, s92
    s_add_u32 m0, s50, 8448
    s_nop 0
    buffer_load_dwordx4 v249, s[24:27], s35 offen lds
    s_add_u32 m0, s52, 0
    s_nop 0
    buffer_load_dwordx4 v248, s[8:11], s41 offen offset:0 nt lds
    s_add_u32 m0, s52, 800
    s_nop 0
    buffer_load_dwordx4 v248, s[8:11], s41 offen offset:256 nt lds
    s_add_u32 m0, s52, 1600
    s_nop 0
    buffer_load_dwordx4 v248, s[8:11], s41 offen offset:512 nt lds
    s_add_u32 m0, s52, 2400
    s_nop 0
    buffer_load_dwordx4 v248, s[8:11], s41 offen offset:768 nt lds
    s_add_u32 s41, s41, 8192
    s_branch LP_jB_75
LP_r0B_76:
    s_add_u32 s35, s47, s93
    s_add_u32 m0, s50, 12672
    s_nop 0
    buffer_load_dwordx4 v249, s[24:27], s35 offen lds
    s_add_u32 s35, s47, s94
    s_add_u32 m0, s50, 16896
    s_nop 0
    buffer_load_dwordx4 v249, s[24:27], s35 offen lds
    s_add_u32 m0, s52, 16896
    s_nop 0
    buffer_load_dwordx4 v248, s[12:15], s42 offen offset:0 nt lds
    s_add_u32 m0, s52, 17696
    s_nop 0
    buffer_load_dwordx4 v248, s[12:15], s42 offen offset:256 nt lds
    s_add_u32 m0, s52, 18496
    s_nop 0
    buffer_load_dwordx4 v248, s[12:15], s42 offen offset:512 nt lds
    s_add_u32 m0, s52, 19296
    s_nop 0
    buffer_load_dwordx4 v248, s[12:15], s42 offen offset:768 nt lds
    s_add_u32 s42, s42, 8192
    s_branch LP_jB_77
LP_r0B_78:
    s_add_u32 s35, s47, s95
    s_add_u32 m0, s50, 21120
    s_nop 0
    buffer_load_dwordx4 v249, s[24:27], s35 offen lds
    s_add_u32 s35, s47, s96
    s_add_u32 m0, s50, 25344
    s_nop 0
    buffer_load_dwordx4 v249, s[24:27], s35 offen lds
    s_add_u32 m0, s52, 33792
    s_nop 0
    buffer_load_dwordx4 v248, s[8:11], s41 offen offset:0 nt lds
    s_add_u32 m0, s52, 34592
    s_nop 0
    buffer_load_dwordx4 v248, s[8:11], s41 offen offset:256 nt lds
    s_add_u32 m0, s52, 35392
    s_nop 0
    buffer_load_dwordx4 v248, s[8:11], s41 offen offset:512 nt lds
    s_add_u32 m0, s52, 36192
    s_nop 0
    buffer_load_dwordx4 v248, s[8:11], s41 offen offset:768 nt lds
    s_add_u32 s41, s41, 8192
    s_branch LP_jB_79
LP_r0B_80:
    s_add_u32 s35, s47, s97
    s_add_u32 m0, s50, 29568
    s_nop 0
    buffer_load_dwordx4 v249, s[24:27], s35 offen lds
    s_add_u32 s35, s47, s98
    s_add_u32 m0, s50, 33792
    s_nop 0
    buffer_load_dwordx4 v249, s[24:27], s35 offen lds
    s_add_u32 s47, s47, 36864
    s_add_u32 m0, s52, 50688
    s_nop 0
    buffer_load_dwordx4 v248, s[12:15], s42 offen offset:0 nt lds
    s_add_u32 m0, s52, 51488
    s_nop 0
    buffer_load_dwordx4 v248, s[12:15], s42 offen offset:256 nt lds
    s_add_u32 m0, s52, 52288
    s_nop 0
    buffer_load_dwordx4 v248, s[12:15], s42 offen offset:512 nt lds
    s_add_u32 m0, s52, 53088
    s_nop 0
    buffer_load_dwordx4 v248, s[12:15], s42 offen offset:768 nt lds
    s_add_u32 s42, s42, 8192
    s_branch LP_jB_81
LP_r0B_82:
    s_add_u32 s35, s47, s90
    s_add_u32 m0, s50, 0
    s_nop 0
    buffer_load_dwordx4 v249, s[24:27], s35 offen lds
    s_add_u32 s35, s47, s91
    s_add_u32 m0, s50, 4224
    s_nop 0
    buffer_load_dwordx4 v249, s[24:27], s35 offen lds
    s_add_u32 s35, s47, s92
    s_add_u32 m0, s50, 8448
    s_nop 0
    buffer_load_dwordx4 v249, s[24:27], s35 offen lds
    s_add_u32 m0, s52, 0
    s_nop 0
    buffer_load_dwordx4 v248, s[8:11], s41 offen offset:0 nt lds
    s_add_u32 m0, s52, 800
    s_nop 0
    buffer_load_dwordx4 v248, s[8:11], s41 offen offset:256 nt lds
    s_add_u32 m0, s52, 1600
    s_nop 0
    buffer_load_dwordx4 v248, s[8:11], s41 offen offset:512 nt lds
    s_add_u32 m0, s52, 2400
    s_nop 0
    buffer_load_dwordx4 v248, s[8:11], s41 offen offset:768 nt lds
    s_add_u32 s41, s41, 8192
    s_branch LP_jB_83
LP_r0B_84:
    s_add_u32 s35, s47, s93
    s_add_u32 m0, s50, 12672
    s_nop 0
    buffer_load_dwordx4 v249, s[24:27], s35 offen lds
    s_add_u32 s35, s47, s94
    s_add_u32 m0, s50, 16896
    s_nop 0
    buffer_load_dwordx4 v249, s[24:27], s35 offen lds
    s_add_u32 m0, s52, 16896
    s_nop 0
    buffer_load_dwordx4 v248, s[12:15], s42 offen offset:0 nt lds
    s_add_u32 m0, s52, 17696
    s_nop 0
    buffer_load_dwordx4 v248, s[12:15], s42 offen offset:256 nt lds
    s_add_u32 m0, s52, 18496
    s_nop 0
    buffer_load_dwordx4 v248, s[12:15], s42 offen offset:512 nt lds
    s_add_u32 m0, s52, 19296
    s_nop 0
    buffer_load_dwordx4 v248, s[12:15], s42 offen offset:768 nt lds
    s_add_u32 s42, s42, 8192
    s_branch LP_jB_85
LP_r0B_86:
    s_add_u32 s35, s47, s95
    s_add_u32 m0, s50, 21120
    s_nop 0
    buffer_load_dwordx4 v249, s[24:27], s35 offen lds
    s_add_u32 s35, s47, s96
    s_add_u32 m0, s50, 25344
    s_nop 0
    buffer_load_dwordx4 v249, s[24:27], s35 offen lds
    s_add_u32 m0, s52, 33792
    s_nop 0
    buffer_load_dwordx4 v248, s[12:15], s42 offen offset:0 nt lds
    s_add_u32 m0, s52, 34592
    s_nop 0
    buffer_load_dwordx4 v248, s[12:15], s42 offen offset:256 nt lds
    s_add_u32 m0, s52, 35392
    s_nop 0
    buffer_load_dwordx4 v248, s[12:15], s42 offen offset:512 nt lds
    s_add_u32 m0, s52, 36192
    s_nop 0
    buffer_load_dwordx4 v248, s[12:15], s42 offen offset:768 nt lds
    s_add_u32 s42, s42, 8192
    s_add_u32 s41, s41, s44
    s_add_u32 s42, s42, s44
    s_branch LP_jB_87
LP_r0B_88:
    s_add_u32 s35, s47, s97
    s_add_u32 m0, s50, 29568
    s_nop 0
    buffer_load_dwordx4 v249, s[24:27], s35 offen lds
    s_add_u32 s35, s47, s98
    s_add_u32 m0, s50, 33792
    s_nop 0
    buffer_load_dwordx4 v249, s[24:27], s35 offen lds
    s_add_u32 s47, s47, 36864
    s_branch LP_jB_89
LP_r0B_90:
    s_add_u32 s35, s46, 0
    s_add_u32 m0, s45, 0
    s_nop 0
    buffer_load_dwordx4 v250, s[20:23], s35 offen lds
    s_add_u32 s35, s46, 8192
    s_add_u32 m0, s45, 1032
    s_nop 0
    buffer_load_dwordx4 v250, s[20:23], s35 offen lds
    s_add_u32 s35, s46, 16384
    s_add_u32 m0, s45, 2112
    s_nop 0
    buffer_load_dwordx4 v250, s[20:23], s35 offen lds
    s_add_u32 s35, s46, 24576
    s_add_u32 m0, s45, 3144
    s_nop 0
    buffer_load_dwordx4 v250, s[20:23], s35 offen lds
    s_add_u32 s46, s46, 262144
    s_add_u32 s35, s43, 0
    s_add_u32 m0, s50, 0
    s_nop 0
    buffer_load_dwordx4 v249, s[16:19], s35 offen lds
    s_add_u32 s35, s43, 36864
    s_add_u32 m0, s50, 4224
    s_nop 0
    buffer_load_dwordx4 v249, s[16:19], s35 offen lds
    s_add_u32 s35, s43, 73728
    s_add_u32 m0, s50, 8448
    s_nop 0
    buffer_load_dwordx4 v249, s[16:19], s35 offen lds
    s_add_u32 s43, s43, 128
    s_branch LP_jB_91
LP_r0B_92:
    s_add_u32 s35, s46, 0
    s_add_u32 m0, s45, 16896
    s_nop 0
    buffer_load_dwordx4 v250, s[20:23], s35 offen lds
    s_add_u32 s35, s46, 8192
    s_add_u32 m0, s45, 17928
    s_nop 0
    buffer_load_dwordx4 v250, s[20:23], s35 offen lds
    s_add_u32 s35, s46, 16384
    s_add_u32 m0, s45, 19008
    s_nop 0
    buffer_load_dwordx4 v250, s[20:23], s35 offen lds
    s_add_u32 s35, s46, 24576
    s_add_u32 m0, s45, 20040
    s_nop 0
    buffer_load_dwordx4 v250, s[20:23], s35 offen lds
    s_add_u32 s46, s46, 262144
    s_branch LP_jB_93
LP_r0B_94:
    s_add_u32 s35, s47, s97
    s_add_u32 m0, s50, 29568
    s_nop 0
    buffer_load_dwordx4 v249, s[24:27], s35 offen lds
    s_add_u32 s35, s47, s98
    s_add_u32 m0, s50, 33792
    s_nop 0
    buffer_load_dwordx4 v249, s[24:27], s35 offen lds
    s_add_u32 s47, s47, 36864
    s_add_u32 s35, s47, s95
    s_add_u32 m0, s50, 88704
    s_nop 0
    buffer_load_dwordx4 v249, s[24:27], s35 offen lds
    s_add_u32 s35, s47, s96
    s_add_u32 m0, s50, 92928
    s_nop 0
    buffer_load_dwordx4 v249, s[24:27], s35 offen lds
    s_add_u32 s35, s47, s97
    s_add_u32 m0, s50, 97152
    s_nop 0
    buffer_load_dwordx4 v249, s[24:27], s35 offen lds
    s_add_u32 s35, s47, s98
    s_add_u32 m0, s50, 101376
    s_nop 0
    buffer_load_dwordx4 v249, s[24:27], s35 offen lds
    s_branch LP_jB_95
LP_r0B_96:
    s_add_u32 s35, s47, s90
    s_add_u32 m0, s50, 0
    s_nop 0
    buffer_load_dwordx4 v249, s[24:27], s35 offen lds
    s_add_u32 s35, s47, s91
    s_add_u32 m0, s50, 4224
    s_nop 0
    buffer_load_dwordx4 v249, s[24:27], s35 offen lds
    s_add_u32 s35, s47, s92
    s_add_u32 m0, s50, 8448
    s_nop 0
    buffer_load_dwordx4 v249, s[24:27], s35 offen lds
    s_branch LP_jB_97
LP_r0B_98:
    s_add_u32 s35, s47, s93
    s_add_u32 m0, s50, 12672
    s_nop 0
    buffer_load_dwordx4 v249, s[24:27], s35 offen lds
    s_add_u32 s35, s47, s94
    s_add_u32 m0, s50, 16896
    s_nop 0
    buffer_load_dwordx4 v249, s[24:27], s35 offen lds
    s_branch LP_jB_99
L_CODE_END:
.section .rodata,"a"
.p2align 6
.amdhsa_kernel concat_heads__gqa_block_cached__mha_block_cached__near_ridge_kernel
  .amdhsa_next_free_vgpr 256
  .amdhsa_next_free_sgpr 102
  .amdhsa_accum_offset 256
  .amdhsa_group_segment_fixed_size 0
  .amdhsa_kernarg_size 104
  .amdhsa_user_sgpr_count 2
  .amdhsa_user_sgpr_kernarg_segment_ptr 1
  .amdhsa_system_sgpr_workgroup_id_x 1
  .amdhsa_float_denorm_mode_32 3
.end_amdhsa_kernel
```
